```python
import torch

def _softmax(x, axis=-1):
    return torch.softmax(x, dim=axis)
def _gelu(x):
    return torch.nn.functional.gelu(x, approximate="tanh")
def _silu(x):
    return torch.nn.functional.silu(x)
def _sigmoid(x):
    return torch.sigmoid(x)
def _layernorm(x, axis=-1, eps=1e-5):
    m = x.mean(dim=axis, keepdim=True)
    v = x.var(dim=axis, keepdim=True, unbiased=False)
    return (x - m) / torch.sqrt(v + eps)
def _scatter_add(tgt, idx, src, axis=0):
    return tgt.clone().index_add_(axis, idx, src)
def _segment_sum(src, seg, n):
    out = torch.zeros((n,) + src.shape[1:], dtype=src.dtype)
    return out.index_add_(0, seg, src)
def _pad(x, pw):
    flat = tuple(v for pair in reversed(pw) for v in pair)
    return torch.nn.functional.pad(x, flat)

kernel_name = 'concat_heads__spectral_gfnet__ssm_conv_s4__prompt'

def setup_inputs():

    _w = (lambda a: (lambda t: t.to(torch.bfloat16) if t.is_floating_point() else t)(torch.as_tensor(a)))
    def _A_setup():
        B, S, D = 1, 2048, 640
        Df = D // 2 + 1
        return {
            "x": _w((lambda *s: torch.randn(*s, dtype=torch.bfloat16) * 0.05)(B, S, D)),
            "w_r": _w((lambda *s: torch.randn(*s, dtype=torch.bfloat16) * 0.8)(S, Df) * 0.02),
            "w_i": _w((lambda *s: torch.randn(*s, dtype=torch.bfloat16) * 1.6)(S, Df) * 0.02),
        }
    _A_in = _A_setup()

    def _B_setup():
        B, L, D, N = 1, 2048, 640, 128
        A_re = -(lambda _x: torch.exp(torch.as_tensor(_x)))((lambda *s: torch.randn(*s, dtype=torch.bfloat16) * 3.2)(D, N))
        A_im = torch.pi * (lambda *s: torch.randn(*s, dtype=torch.bfloat16) * 0.05)(D, N)
        B_re = (lambda *s: torch.randn(*s, dtype=torch.bfloat16) * 0.1)(D, N)
        B_im = (lambda *s: torch.randn(*s, dtype=torch.bfloat16) * 0.1)(D, N)
        C_re = (lambda *s: torch.randn(*s, dtype=torch.bfloat16) * 0.1)(D, N)
        C_im = (lambda *s: torch.randn(*s, dtype=torch.bfloat16) * 0.1)(D, N)
        log_dt = (lambda *s: torch.randn(*s, dtype=torch.bfloat16) * 0.05)(D) * 0.5 - 4.0
        Dskip = (lambda *s: torch.randn(*s, dtype=torch.bfloat16) * 0.05)(D)
        return {
            "u": _w((lambda *s: torch.randn(*s, dtype=torch.bfloat16) * 0.05)(B, L, D)),
            "A_re": _w(A_re),
            "A_im": _w(A_im),
            "B_re": _w(B_re),
            "B_im": _w(B_im),
            "C_re": _w(C_re),
            "C_im": _w(C_im),
            "log_dt": _w(log_dt),
            "Dskip": _w(Dskip),
        }
    _B_in = _B_setup()

    return {
        "A_x": _A_in["x"],
        "A_w_r": _A_in["w_r"],
        "A_w_i": _A_in["w_i"],
        "B_u": _B_in["u"],
        "B_A_re": _B_in["A_re"],
        "B_A_im": _B_in["A_im"],
        "B_B_re": _B_in["B_re"],
        "B_B_im": _B_in["B_im"],
        "B_C_re": _B_in["C_re"],
        "B_C_im": _B_in["C_im"],
        "B_log_dt": _B_in["log_dt"],
        "B_Dskip": _B_in["Dskip"],
    }

def reference(A_x, A_w_r, A_w_i, B_u, B_A_re, B_A_im, B_B_re, B_B_im, B_C_re, B_C_im, B_log_dt, B_Dskip):
    def _A_ref(x, w_r, w_i):
        B, S, D = x.shape
        X = (lambda x, axes=(-2,-1): torch.fft.rfft2(x.float(), dim=axes))(x, axes=(-2, -1))
        W = w_r + 1j * w_i
        X = X * W
        y = (lambda x, s, axes=(-2,-1): torch.fft.irfft2(x, s=s, dim=axes).to(torch.bfloat16))(X, (S, D), axes=(-2, -1))
        return y

    def _B_ref(u, A_re, A_im, B_re, B_im, C_re, C_im, log_dt, Dskip):
        Bsz, L, D = u.shape
        dt = torch.exp(log_dt)[:, None]
        A = A_re + 1j * A_im
        Bc = B_re + 1j * B_im
        Cc = C_re + 1j * C_im
        logdA = dt * A
        dB = dt * Bc
        l = (lambda x, dt: x.to(dt))(torch.arange(L), A_re.dtype)
        P = torch.exp(logdA[:, :, None] * l[None, None, :])
        K = torch.einsum("dn,dnl,dn->dl", Cc, P, dB).real
        L2 = 2 * L
        Kp = _pad(K, ((0, 0), (0, L)))
        up = (lambda x, *d: x.permute(*d))(u, 0, 2, 1)
        up = _pad(up, ((0, 0), (0, 0), (0, L)))
        Kf = (lambda x, axes=(-2,-1): torch.fft.rfft2(x.float(), dim=axes))(Kp[:, None, :], axes=(-2, -1))
        Uf = (lambda x, axes=(-2,-1): torch.fft.rfft2(x.float(), dim=axes))(up[:, :, None, :], axes=(-2, -1))
        Yf = Uf * Kf[None, :, :, :]
        y = (lambda x, s, axes=(-2,-1): torch.fft.irfft2(x, s=s, dim=axes).to(torch.bfloat16))(Yf, (1, L2), axes=(-2, -1))[:, :, 0, :L]
        y = (lambda x, *d: x.permute(*d))(y, 0, 2, 1) + u * Dskip[None, None, :]
        return y

    a = _A_ref(A_x, A_w_r, A_w_i)
    b = _B_ref(B_u, B_A_re, B_A_im, B_B_re, B_B_im, B_C_re, B_C_im, B_log_dt, B_Dskip)
    return torch.concatenate([a, b], axis=-1)
```

```asm
; @launch grid=(256,1,1) block=(768,1,1) lds=163840
.amdgcn_target "amdgcn-amd-amdhsa--gfx950"
.text
.globl concat_heads__spectral_gfnet__ssm_conv_s4__prompt_kernel
.p2align 8
.type concat_heads__spectral_gfnet__ssm_conv_s4__prompt_kernel,@function
concat_heads__spectral_gfnet__ssm_conv_s4__prompt_kernel:
    s_cmp_ge_u32 s2, 256
    s_cbranch_scc1 L_exit
    v_lshrrev_b32 v4, 6, v0
    v_and_b32 v1, 63, v0
    v_readfirstlane_b32 s28, v4
    v_lshlrev_b32 v40, 2, v1
    v_mov_b32 v41, 0
    s_cmp_lg_u32 s28, 0
    s_nop 1
    s_cbranch_scc1 L_nz
    ds_write_b32 v40, v41 offset:28960
    s_waitcnt lgkmcnt(0)
L_nz:
    s_load_dwordx4 s[64:67], s[0:1], 0
    s_load_dwordx4 s[68:71], s[0:1], 16
    s_load_dwordx8 s[76:83], s[0:1], 32
    s_load_dwordx8 s[84:91], s[0:1], 64
    s_load_dwordx2 s[72:73], s[0:1], 112
    s_load_dwordx2 s[92:93], s[0:1], 96
    v_and_b32 v2, 15, v0
    v_lshrrev_b32 v3, 4, v1
    s_getpc_b64 s[24:25]
L_pc:
    s_cmp_lg_u32 s28, 10
    s_cbranch_scc1 L_nopf
    s_bfe_u32 s35, s2, 0x50003
    s_mul_i32 s35, s35, ((L_tend-L_pc)/128+31)/32*128
    v_lshl_add_u32 v4, v1, 7, s35
    v_min_u32 v4, L_tend-L_pc-4, v4
    global_load_dword v167, v4, s[24:25]
    s_nop 0
L_nopf:
    s_add_u32 s24, s24, L_table-L_pc
    s_addc_u32 s25, s25, 0
    s_and_b32 s25, s25, 0xffff
    s_mov_b32 s26, L_tend-L_table
    s_mov_b32 s27, 0x00020000
    s_and_b32 s29, s2, 127
    s_and_b32 s32, s2, 127
    s_cmp_lt_u32 s2, 128
    s_cbranch_scc0 L_Btop
    s_barrier
    s_cmp_lt_u32 s28, 8
    s_cbranch_scc1 A_body
    s_lshl_b32 s35, s28, 8
    s_mul_i32 s36, s29, 1280
    s_add_u32 s35, s35, s36
    v_and_b32 v4, 3, v2
    v_lshlrev_b32 v4, 6, v4
    v_lshrrev_b32 v5, 2, v2
    v_lshl_add_u32 v4, v5, 4, v4
    v_mul_u32_u24 v5, 655360, v3
    s_sub_u32 s35, s35, 2048
    v_add3_u32 v4, v5, v4, s35
    v_add_u32 v5, 163840, v4
    v_add_u32 v6, 327680, v4
    v_add_u32 v7, 491520, v4
    s_mul_i32 s35, s28, 252
    s_sub_u32 s35, 3040, s35
    v_add_u32 v8, s35, v4
    v_add_u32 v9, s35, v5
    v_add_u32 v10, s35, v6
    v_add_u32 v11, s35, v7
    s_waitcnt lgkmcnt(0)
    global_load_dwordx4 v[16:19], v4, s[64:65] nt
    global_load_dwordx4 v[20:23], v5, s[64:65] nt
    global_load_dwordx4 v[24:27], v6, s[64:65] nt
    global_load_dwordx4 v[28:31], v7, s[64:65] nt
    global_load_dword v12, v8, s[64:65] nt
    global_load_dword v13, v9, s[64:65] nt
    global_load_dword v14, v10, s[64:65] nt
    global_load_dword v15, v11, s[64:65] nt
    s_branch A_body
L_Btop:
    s_and_b32 s31, s2, 7
    s_lshr_b32 s29, s29, 3
    s_mul_i32 s58, s31, 80
    s_mul_i32 s37, s29, 5
    s_add_u32 s58, s58, s37
    s_cmp_gt_u32 s28, 9
    s_cbranch_scc1 B_topu
    s_cmp_gt_u32 s28, 5
    s_cbranch_scc1 B_body
    s_lshl_b32 s37, s58, 8
    v_lshl_add_u32 v4, v1, 4, s37
    s_mul_i32 s38, s28, 1280
    s_add_u32 m0, s38, 133440
    s_waitcnt lgkmcnt(0)
    s_mov_b64 s[54:55], s[76:77]
    s_cmp_eq_u32 s28, 1
    s_cselect_b64 s[54:55], s[78:79], s[54:55]
    s_cmp_eq_u32 s28, 2
    s_cselect_b64 s[54:55], s[80:81], s[54:55]
    s_cmp_eq_u32 s28, 3
    s_cselect_b64 s[54:55], s[82:83], s[54:55]
    s_cmp_eq_u32 s28, 4
    s_cselect_b64 s[54:55], s[84:85], s[54:55]
    s_cmp_eq_u32 s28, 5
    s_cselect_b64 s[54:55], s[86:87], s[54:55]
    global_load_lds_dwordx4 v4, s[54:55] nt
    s_mov_b32 exec_lo, 0xffff
    s_mov_b32 exec_hi, 0x0
    global_load_lds_dwordx4 v4, s[54:55] offset:1024 nt
    s_branch B_body
B_topu:
    v_mul_u32_u24 v5, 47, v1
    v_lshrrev_b32 v5, 9, v5
    v_mul_u32_u24 v6, 1104, v5
    v_lshl_add_u32 v8, v1, 4, v6
    s_mul_i32 s35, s29, 163840
    s_mul_i32 s36, s31, 160
    s_add_u32 s35, s35, s36
    s_sub_u32 s37, s28, 10
    s_mul_i32 s36, s37, 83200
    s_add_u32 s35, s35, s36
    s_mul_i32 s37, s37, 11440
    s_add_u32 m0, s37, 110400
    s_waitcnt lgkmcnt(0)
    s_lshl_b32 s15, s31, 8
    s_add_u32 s15, s15, 256
    s_load_dword s59, s[72:73], s15
    s_mov_b32 s4, s70
    s_and_b32 s5, s71, 0xffff
    s_mov_b32 s6, 2621440
    s_mov_b32 s7, 0x00020000
    s_mov_b32 s8, s72
    s_and_b32 s9, s73, 0xffff
    s_mov_b32 s10, 268435456
    s_mov_b32 s11, 0x00020000
    s_mov_b32 s14, s35
    s_waitcnt lgkmcnt(0)
    s_add_u32 s30, s59, 1
    s_cmp_lg_u32 s28, 10
    s_cbranch_scc1 B_nopub
    s_getreg_b32 s36, hwreg(HW_REG_XCC_ID)
    s_and_b32 s35, s2, 7
    s_lshl_b32 s35, s35, 5
    s_add_u32 s35, s35, s29
    s_lshl_b32 s35, s35, 3
    s_add_u32 s35, s35, 4096
    v_mov_b32 v4, s30
    v_mov_b32 v5, s36
    v_mov_b32 v6, 0
    s_mov_b32 exec_lo, 0x1
    s_mov_b32 exec_hi, 0x0
    buffer_store_dwordx2 v[4:5], v6, s[8:11], s35 offen sc1
    s_mov_b64 exec, -1
B_nopub:
    s_mov_b32 s35, s14
    s_mov_b32 exec_lo, 0xffdffbff
    s_mov_b32 exec_hi, 0x3ff7fe
    buffer_load_dwordx4 v8, s[4:7], s35 offen nt lds
    s_add_u32 m0, m0, 880
    s_add_u32 s35, s35, 6400
    buffer_load_dwordx4 v8, s[4:7], s35 offen nt lds
    s_add_u32 m0, m0, 880
    s_add_u32 s35, s35, 6400
    buffer_load_dwordx4 v8, s[4:7], s35 offen nt lds
    s_add_u32 m0, m0, 880
    s_add_u32 s35, s35, 6400
    buffer_load_dwordx4 v8, s[4:7], s35 offen nt lds
    s_add_u32 m0, m0, 880
    s_add_u32 s35, s35, 6400
    buffer_load_dwordx4 v8, s[4:7], s35 offen nt lds
    s_add_u32 m0, m0, 880
    s_add_u32 s35, s35, 6400
    buffer_load_dwordx4 v8, s[4:7], s35 offen nt lds
    s_add_u32 m0, m0, 880
    s_add_u32 s35, s35, 6400
    buffer_load_dwordx4 v8, s[4:7], s35 offen nt lds
    s_add_u32 m0, m0, 880
    s_add_u32 s35, s35, 6400
    buffer_load_dwordx4 v8, s[4:7], s35 offen nt lds
    s_add_u32 m0, m0, 880
    s_add_u32 s35, s35, 6400
    buffer_load_dwordx4 v8, s[4:7], s35 offen nt lds
    s_add_u32 m0, m0, 880
    s_add_u32 s35, s35, 6400
    buffer_load_dwordx4 v8, s[4:7], s35 offen nt lds
    s_add_u32 m0, m0, 880
    s_add_u32 s35, s35, 6400
    buffer_load_dwordx4 v8, s[4:7], s35 offen nt lds
    s_add_u32 m0, m0, 880
    s_add_u32 s35, s35, 6400
    buffer_load_dwordx4 v8, s[4:7], s35 offen nt lds
    s_add_u32 m0, m0, 880
    s_add_u32 s35, s35, 6400
    s_cmp_eq_u32 s28, 11
    s_cselect_b32 exec_hi, 0, exec_hi
    buffer_load_dwordx4 v8, s[4:7], s35 offen nt lds
    s_branch B_body
A_body:
    s_and_b32 s31, s2, 7
    s_lshr_b32 s32, s29, 3
    s_add_u32 s33, s31, 1
    s_and_b32 s35, s32, 8
    s_and_b32 s36, s32, 7
    s_cmp_eq_u32 s31, 7
    s_cselect_b32 s33, s35, s33
    s_cselect_b32 s34, s36, s32
    v_mov_b32 v152, 0
    v_mov_b32 v158, 0
    v_mov_b32 v159, 0
    v_mov_b32 v160, 0
    v_mov_b32 v161, 0
    v_mov_b32 v164, 0
    v_mov_b32 v165, 0
    v_mov_b32 v166, 0
    s_mov_b32 s96, 0x3fff3fff
    s_mov_b32 s97, 0x3fff3fff
    s_cmp_lt_u32 s28, 8
    s_cbranch_scc1 A_tj
    s_waitcnt lgkmcnt(0)
    s_mov_b32 s8, s72
    s_and_b32 s9, s73, 0xffff
    s_mov_b32 s10, 268435456
    s_mov_b32 s11, 0x00020000
    s_mov_b32 s12, s66
    s_and_b32 s13, s67, 0xffff
    s_mov_b32 s14, 1314816
    s_mov_b32 s15, 0x00020000
    s_mov_b32 s16, s68
    s_and_b32 s17, s69, 0xffff
    s_mov_b32 s18, 1314816
    s_mov_b32 s19, 0x00020000
    s_mov_b32 s20, s92
    s_and_b32 s21, s93, 0xffff
    s_mov_b32 s22, 5242880
    s_mov_b32 s23, 0x00020000
    s_cmp_eq_u32 s28, 11
    s_cbranch_scc1 A_nowpf
    s_sub_u32 s35, s28, 8
    s_lshl_b32 s35, s35, 5
    v_lshrrev_b32 v4, 1, v1
    v_add_u32 v4, s35, v4
    v_mul_u32_u24 v5, 171, v4
    v_lshrrev_b32 v5, 10, v5
    v_mul_u32_u24 v6, 6, v5
    v_sub_u32 v4, v4, v6
    v_lshrrev_b32 v6, 1, v5
    s_lshl_b32 s35, s34, 3
    s_cmp_eq_u32 s31, 7
    s_cselect_b32 s37, 1, 0
    s_lshl_b32 s35, s35, s37
    v_lshlrev_b32 v6, s37, v6
    v_add_u32 v6, s35, v6
    v_lshlrev_b32 v6, 4, v6
    v_add_u32 v6, s33, v6
    v_sub_u32 v7, 2048, v6
    v_add_u32 v8, 16, v6
    s_cmp_eq_u32 s31, 7
    s_cselect_b64 vcc, -1, 0
    v_cndmask_b32 v7, v7, v8, vcc
    v_and_b32 v7, 2047, v7
    v_and_b32 v8, 1, v5
    v_cmp_eq_u32 vcc, 0, v8
    s_nop 1
    v_cndmask_b32 v6, v7, v6, vcc
    v_mul_u32_u24 v6, 642, v6
    v_and_b32 v6, 0xffffff80, v6
    v_lshl_add_u32 v6, v4, 7, v6
    v_and_b32 v4, 1, v1
    v_lshl_add_u32 v152, v4, 6, v6
    buffer_load_dword v148, v152, s[12:15], 0 offen nt
    buffer_load_dword v149, v152, s[16:19], 0 offen nt
A_nowpf:
    v_lshlrev_b32 v8, 3, v1
    s_lshl_b32 s37, s28, 9
    s_lshl_b32 s38, s28, 10
    s_sub_u32 s38, s38, 2560
    buffer_load_dwordx2 v[150:151], v8, s[24:27], s37 offen
    buffer_load_dwordx2 v[154:155], v8, s[24:27], s38 offen
    buffer_load_dwordx2 v[156:157], v8, s[24:27], s38 offen offset:512
    s_branch A_s1
A_tj:
    s_mov_b32 s51, s28
A_tj0:
    s_mov_b32 s54, 16781312
    s_mov_b32 s52, 0x3fff3fff
    s_mov_b32 s53, 0x3fff3fff
    s_cmp_eq_u32 s51, 1
    s_cselect_b32 s54, 16908288, s54
    s_cselect_b32 s52, 0x3fff, s52
    s_cselect_b32 s53, 0x0, s53
    s_cmp_eq_u32 s51, 2
    s_cselect_b32 s54, 16908288, s54
    s_cselect_b32 s52, 0x3fff0000, s52
    s_cselect_b32 s53, 0x0, s53
    s_cmp_eq_u32 s51, 3
    s_cselect_b32 s54, 16781774, s54
    s_cselect_b32 s52, 0x7f007f, s52
    s_cselect_b32 s53, 0x7f007f, s53
    s_cmp_eq_u32 s51, 4
    s_cselect_b32 s54, 16781543, s54
    s_cselect_b32 s52, 0x3f803f80, s52
    s_cselect_b32 s53, 0x3f803f80, s53
    s_cmp_eq_u32 s51, 5
    s_cselect_b32 s54, 16908526, s54
    s_cselect_b32 s52, 0x3f80007f, s52
    s_cselect_b32 s53, 0x0, s53
    s_cmp_eq_u32 s51, 6
    s_cselect_b32 s54, 1052672, s54
    s_cselect_b32 s52, 0x3fff3fff, s52
    s_cselect_b32 s53, 0x3fff3fff, s53
    s_cmp_eq_u32 s51, 7
    s_cselect_b32 s54, 1052910, s54
    s_cselect_b32 s52, 0x3fff3fff, s52
    s_cselect_b32 s53, 0x3fff3fff, s53
    s_cmp_eq_u32 s51, 8
    s_cselect_b32 s54, 20975616, s54
    s_cselect_b32 s52, 0xffffffff, s52
    s_cselect_b32 s53, 0xffffffff, s53
    s_and_b32 s55, s54, 31
    s_bfe_u32 s56, s54, 0x50005
    s_bfe_u32 s57, s54, 0x3000a
    s_bfe_u32 s58, s54, 0x5000d
    s_lshr_b32 s54, s54, 18
    v_mov_b32 v4, s56
    v_mov_b32 v5, s55
    v_cmp_gt_u32 vcc, 7, v2
    s_nop 1
    v_cndmask_b32 v4, v4, v5, vcc
    v_add_u32 v4, v4, v2
    v_mul_u32_u24 v4, s54, v4
    v_mul_u32_u24 v5, s57, v3
    v_add_u32 v5, s58, v5
    v_mov_b32 v6, 0x7fffffff
    v_add_u32 v64, 0, v5
    v_mul_u32_u24 v64, v64, v4
    v_cndmask_b32 v64, v6, v64, s[52:53]
    v_add_u32 v65, 1, v5
    v_mul_u32_u24 v65, v65, v4
    v_cndmask_b32 v65, v6, v65, s[52:53]
    v_add_u32 v66, 2, v5
    v_mul_u32_u24 v66, v66, v4
    v_cndmask_b32 v66, v6, v66, s[52:53]
    v_add_u32 v67, 3, v5
    v_mul_u32_u24 v67, v67, v4
    v_cndmask_b32 v67, v6, v67, s[52:53]
    s_mov_b32 s36, 0x7fffffff
    v_cmp_gt_u32 s[40:41], s36, v64
    v_cmp_gt_u32 s[42:43], s36, v65
    v_cmp_gt_u32 s[44:45], s36, v66
    v_cmp_gt_u32 s[46:47], s36, v67
    v_cvt_f32_u32 v64, v64
    v_cvt_f32_u32 v65, v65
    v_cvt_f32_u32 v66, v66
    v_cvt_f32_u32 v67, v67
    v_mul_f32 v64, 0x3a4ccccd, v64
    v_mul_f32 v65, 0x3a4ccccd, v65
    v_mul_f32 v66, 0x3a4ccccd, v66
    v_mul_f32 v67, 0x3a4ccccd, v67
    v_fract_f32 v64, v64
    v_fract_f32 v65, v65
    v_fract_f32 v66, v66
    v_fract_f32 v67, v67
    v_cos_f32 v68, v64
    v_sin_f32 v72, v64
    v_cos_f32 v69, v65
    v_sin_f32 v73, v65
    v_cos_f32 v70, v66
    v_sin_f32 v74, v66
    v_cos_f32 v71, v67
    v_sin_f32 v75, v67
    s_lshl_b32 s35, s51, 11
    v_cndmask_b32 v68, 0, v68, s[40:41]
    s_add_u32 s35, s35, 53760
    v_cndmask_b32 v72, 0, -v72, s[40:41]
    v_cndmask_b32 v69, 0, v69, s[42:43]
    v_cndmask_b32 v73, 0, -v73, s[42:43]
    v_cndmask_b32 v70, 0, v70, s[44:45]
    v_cndmask_b32 v74, 0, -v74, s[44:45]
    v_cndmask_b32 v71, 0, v71, s[46:47]
    v_cndmask_b32 v75, 0, -v75, s[46:47]
    v_lshl_add_u32 v84, v1, 4, s35
    s_mov_b32 s35, 0x1f93f
    s_bitcmp0_b32 s35, s51
    s_cbranch_scc1 tj_1
    v_cvt_pk_bf16_f32 v76, v68, -v72
    v_cvt_pk_bf16_f32 v80, v72, v68
    v_cvt_pk_bf16_f32 v77, v69, -v73
    v_cvt_pk_bf16_f32 v81, v73, v69
    v_cvt_pk_bf16_f32 v78, v70, -v74
    v_cvt_pk_bf16_f32 v82, v74, v70
    v_cvt_pk_bf16_f32 v79, v71, -v75
    v_cvt_pk_bf16_f32 v83, v75, v71
    ds_write_b128 v84, v[76:79]
    ds_write_b128 v84, v[80:83] offset:1024
    s_branch tj_2
tj_1:
    ds_write_b128 v84, v[68:71]
    ds_write_b128 v84, v[72:75] offset:1024
tj_2:
    s_lshl_b32 s35, s51, 2
    s_add_u32 s35, s35, 28960
    v_mov_b32 v4, s35
    v_mov_b32 v5, 1
    ds_write_b32 v4, v5
    s_cmp_eq_u32 s51, 3
    s_mov_b32 s51, 8
    s_cbranch_scc1 A_tj0
    v_lshlrev_b32 v6, 2, v1
    v_add_u32 v6, 28960, v6
    s_waitcnt lgkmcnt(0)
    s_mov_b32 s8, s72
    s_and_b32 s9, s73, 0xffff
    s_mov_b32 s10, 268435456
    s_mov_b32 s11, 0x00020000
    s_mov_b32 s12, s66
    s_and_b32 s13, s67, 0xffff
    s_mov_b32 s14, 1314816
    s_mov_b32 s15, 0x00020000
    s_mov_b32 s16, s68
    s_and_b32 s17, s69, 0xffff
    s_mov_b32 s18, 1314816
    s_mov_b32 s19, 0x00020000
    s_mov_b32 s20, s92
    s_and_b32 s21, s93, 0xffff
    s_mov_b32 s22, 5242880
    s_mov_b32 s23, 0x00020000
    s_mov_b32 exec_lo, 0xff
    s_mov_b32 exec_hi, 0x0
    s_mov_b32 s50, 0
tf_3:
    ds_read_b32 v4, v6
    s_add_u32 s50, s50, 1
    s_waitcnt lgkmcnt(0)
    v_cmp_ne_u32 vcc, 1, v4
    s_cmp_gt_u32 s50, 2000000
    s_nop 3
    s_cbranch_scc1 tf_4
    s_cbranch_vccz tf_4
    s_sleep 1
    s_branch tf_3
tf_4:
    s_mov_b64 exec, -1
    v_lshlrev_b32 v7, 4, v1
    v_add_u32 v7, 53760, v7
    ds_read_b128 v[40:43], v7 offset:0
    ds_read_b128 v[44:47], v7 offset:1024
    ds_read_b128 v[48:51], v7 offset:2048
    ds_read_b128 v[52:55], v7 offset:3072
    ds_read_b128 v[56:59], v7 offset:4096
    ds_read_b128 v[60:63], v7 offset:5120
    ds_read_b128 v[64:67], v7 offset:6144
    ds_read_b128 v[68:71], v7 offset:7168
    ds_read_b128 v[72:75], v7 offset:8192
    ds_read_b128 v[76:79], v7 offset:9216
    ds_read_b128 v[80:83], v7 offset:10240
    ds_read_b128 v[84:87], v7 offset:11264
    ds_read_b128 v[88:91], v7 offset:12288
    ds_read_b128 v[92:95], v7 offset:13312
    ds_read_b128 v[96:99], v7 offset:14336
    ds_read_b128 v[100:103], v7 offset:15360
    v_lshlrev_b32 v4, 2, v3
    s_lshr_b32 s35, s33, 3
    v_add_u32 v124, 0, v4
    v_add_u32 v125, 1, v4
    v_add_u32 v126, 2, v4
    v_add_u32 v127, 3, v4
    v_lshl_add_u32 v113, v2, 1, s35
    v_lshl_add_u32 v124, v124, 3, s28
    v_lshl_add_u32 v125, v125, 3, s28
    v_lshl_add_u32 v126, v126, 3, s28
    v_lshl_add_u32 v127, v127, 3, s28
    v_mul_u32_u24 v124, v124, v113
    v_mul_u32_u24 v125, v125, v113
    v_mul_u32_u24 v126, v126, v113
    v_mul_u32_u24 v127, v127, v113
    v_and_b32 v124, 255, v124
    v_and_b32 v125, 255, v125
    v_and_b32 v126, 255, v126
    v_and_b32 v127, 255, v127
    v_cvt_f32_u32 v124, v124
    v_cvt_f32_u32 v125, v125
    v_cvt_f32_u32 v126, v126
    v_cvt_f32_u32 v127, v127
    v_mul_f32 v124, 0x3b800000, v124
    v_mul_f32 v125, 0x3b800000, v125
    v_mul_f32 v126, 0x3b800000, v126
    v_mul_f32 v127, 0x3b800000, v127
    v_cos_f32 v128, v124
    v_sin_f32 v132, v124
    v_cos_f32 v129, v125
    v_sin_f32 v133, v125
    v_cos_f32 v130, v126
    v_sin_f32 v134, v126
    v_cos_f32 v131, v127
    v_sin_f32 v135, v127
    v_cvt_pk_bf16_f32 v148, v128, v132
    v_cvt_pk_bf16_f32 v152, -v132, v128
    v_cvt_pk_bf16_f32 v149, v129, v133
    v_cvt_pk_bf16_f32 v153, -v133, v129
    v_cvt_pk_bf16_f32 v150, v130, v134
    v_cvt_pk_bf16_f32 v154, -v134, v130
    v_cvt_pk_bf16_f32 v151, v131, v135
    v_cvt_pk_bf16_f32 v155, -v135, v131
    v_lshlrev_b32 v4, 2, v3
    s_lshr_b32 s35, s33, 3
    v_add_u32 v120, 0, v4
    v_add_u32 v121, 1, v4
    v_add_u32 v122, 2, v4
    v_add_u32 v123, 3, v4
    v_lshl_add_u32 v112, v2, 3, s28
    v_lshl_add_u32 v120, v120, 1, s35
    v_lshl_add_u32 v121, v121, 1, s35
    v_lshl_add_u32 v122, v122, 1, s35
    v_lshl_add_u32 v123, v123, 1, s35
    v_mul_u32_u24 v120, v120, v112
    v_mul_u32_u24 v121, v121, v112
    v_mul_u32_u24 v122, v122, v112
    v_mul_u32_u24 v123, v123, v112
    v_and_b32 v120, 255, v120
    v_and_b32 v121, 255, v121
    v_and_b32 v122, 255, v122
    v_and_b32 v123, 255, v123
    v_cvt_f32_u32 v120, v120
    v_cvt_f32_u32 v121, v121
    v_cvt_f32_u32 v122, v122
    v_cvt_f32_u32 v123, v123
    v_mul_f32 v120, 0x3b800000, v120
    v_mul_f32 v121, 0x3b800000, v121
    v_mul_f32 v122, 0x3b800000, v122
    v_mul_f32 v123, 0x3b800000, v123
    v_cos_f32 v104, v120
    v_sin_f32 v108, v120
    v_cos_f32 v105, v121
    v_sin_f32 v109, v121
    v_cos_f32 v106, v122
    v_sin_f32 v110, v122
    v_cos_f32 v107, v123
    v_sin_f32 v111, v123
    v_cvt_pk_bf16_f32 v156, v104, -v108
    v_cvt_pk_bf16_f32 v160, v108, v104
    v_cvt_pk_bf16_f32 v157, v105, -v109
    v_cvt_pk_bf16_f32 v161, v109, v105
    v_cvt_pk_bf16_f32 v158, v106, -v110
    v_cvt_pk_bf16_f32 v162, v110, v106
    v_cvt_pk_bf16_f32 v159, v107, -v111
    v_cvt_pk_bf16_f32 v163, v111, v107
    s_nop 1
    s_branch A_s1_skip
A_s1:
    s_load_dword s59, s[8:9], 0
    v_lshrrev_b32 v6, 1, v2
    v_cmp_ne_u32 vcc, 14, v2
    v_add_u32 v6, 1, v6
    v_mov_b32 v7, s29
    v_cndmask_b32 v6, 0, v6, vcc
    v_cmp_gt_u32 vcc, 14, v2
    v_and_b32 v52, 1, v2
    s_nop 0
    v_cndmask_b32 v7, 0, v7, vcc
    s_sub_u32 s35, s28, 8
    v_lshl_add_u32 v7, v3, 9, v7
    v_lshlrev_b32 v52, 31, v52
    v_add_u32 v40, 0, v7
    v_add_u32 v41, 128, v7
    v_add_u32 v42, 256, v7
    v_add_u32 v43, 384, v7
    v_mul_u32_u24 v40, v40, v6
    v_mul_u32_u24 v41, v41, v6
    v_mul_u32_u24 v42, v42, v6
    v_mul_u32_u24 v43, v43, v6
    v_and_b32 v40, 2047, v40
    v_and_b32 v41, 2047, v41
    v_and_b32 v42, 2047, v42
    v_and_b32 v43, 2047, v43
    v_cvt_f32_u32 v40, v40
    v_cvt_f32_u32 v41, v41
    v_cvt_f32_u32 v42, v42
    v_cvt_f32_u32 v43, v43
    v_mul_f32 v40, 0x3a000000, v40
    v_mul_f32 v41, 0x3a000000, v41
    v_mul_f32 v42, 0x3a000000, v42
    v_mul_f32 v43, 0x3a000000, v43
    v_cos_f32 v44, v40
    v_sin_f32 v48, v40
    v_cos_f32 v45, v41
    v_sin_f32 v49, v41
    v_cos_f32 v46, v42
    v_sin_f32 v50, v42
    v_cos_f32 v47, v43
    v_sin_f32 v51, v43
    s_lshl_b32 s36, s35, 4
    s_mul_i32 s35, s35, 96
    v_cndmask_b32 v52, 0, v52, vcc
    v_cvt_pk_bf16_f32 v32, v44, v48
    v_cvt_pk_bf16_f32 v36, -v48, v44
    v_cvt_pk_bf16_f32 v33, v45, v49
    v_cvt_pk_bf16_f32 v37, -v49, v45
    v_cvt_pk_bf16_f32 v34, v46, v50
    v_cvt_pk_bf16_f32 v38, -v50, v46
    v_cvt_pk_bf16_f32 v35, v47, v51
    v_cvt_pk_bf16_f32 v39, -v51, v47
    v_mul_u32_u24 v4, 1552, v2
    v_mul_u32_u24 v5, 384, v3
    s_add_u32 s35, s35, 64
    v_xor_b32 v32, v52, v32
    v_xor_b32 v33, v52, v33
    v_xor_b32 v34, v52, v34
    v_xor_b32 v35, v52, v35
    v_xor_b32 v36, v52, v36
    v_xor_b32 v37, v52, v37
    v_xor_b32 v38, v52, v38
    v_xor_b32 v39, v52, v39
    v_add3_u32 v166, v4, v5, s36
    v_add3_u32 v165, v4, v5, s35
    s_setprio 2
    s_waitcnt vmcnt(5)
    s_cmp_lt_u32 s28, 11
    s_cbranch_scc1 A_s1b
    s_waitcnt vmcnt(3)
A_s1b:
    v_swap_b32 v17, v20
    v_swap_b32 v18, v24
    v_swap_b32 v19, v28
    v_swap_b32 v22, v25
    v_swap_b32 v23, v29
    v_swap_b32 v27, v30
    v_mfma_f32_16x16x32_bf16 v[104:107], v[16:19], v[32:35], 0
    v_mfma_f32_16x16x32_bf16 v[108:111], v[16:19], v[36:39], 0
    v_mfma_f32_16x16x32_bf16 v[112:115], v[20:23], v[32:35], 0
    v_mfma_f32_16x16x32_bf16 v[116:119], v[20:23], v[36:39], 0
    s_nop 5
    v_cvt_pk_bf16_f32 v16, v104, v108
    v_cvt_pk_bf16_f32 v17, v105, v109
    v_mfma_f32_16x16x32_bf16 v[120:123], v[24:27], v[32:35], 0
    v_cvt_pk_bf16_f32 v18, v106, v110
    v_cvt_pk_bf16_f32 v19, v107, v111
    v_mfma_f32_16x16x32_bf16 v[124:127], v[24:27], v[36:39], 0
    v_cvt_pk_bf16_f32 v20, v112, v116
    v_cvt_pk_bf16_f32 v21, v113, v117
    v_mfma_f32_16x16x32_bf16 v[128:131], v[28:31], v[32:35], 0
    v_cvt_pk_bf16_f32 v22, v114, v118
    v_cvt_pk_bf16_f32 v23, v115, v119
    v_mfma_f32_16x16x32_bf16 v[132:135], v[28:31], v[36:39], 0
    s_nop 1
    v_cvt_pk_bf16_f32 v24, v120, v124
    v_cvt_pk_bf16_f32 v25, v121, v125
    v_mfma_f32_16x16x32_bf16 v[40:43], v[12:15], v[32:35], 0
    v_cvt_pk_bf16_f32 v26, v122, v126
    v_cvt_pk_bf16_f32 v27, v123, v127
    v_mfma_f32_16x16x32_bf16 v[44:47], v[12:15], v[36:39], 0
    v_cvt_pk_bf16_f32 v28, v128, v132
    v_cvt_pk_bf16_f32 v29, v129, v133
    v_cvt_pk_bf16_f32 v30, v130, v134
    v_cvt_pk_bf16_f32 v31, v131, v135
    ds_write_b128 v166, v[16:19] offset:0
    ds_write_b128 v166, v[20:23] offset:96
    ds_write_b128 v166, v[24:27] offset:192
    s_nop 0
    v_cvt_pk_bf16_f32 v8, v40, v44
    v_cvt_pk_bf16_f32 v9, v41, v45
    v_cvt_pk_bf16_f32 v10, v42, v46
    v_cvt_pk_bf16_f32 v11, v43, v47
    ds_write_b128 v166, v[28:31] offset:288
    ds_write_b128 v165, v[8:11] offset:0
    s_branch A_s2_skipA
A_s1_skip:
    s_load_dword s59, s[8:9], 0
    v_lshlrev_b32 v6, 2, v1
    v_add_u32 v6, 28960, v6
    s_mov_b32 exec_lo, 0x100
    s_mov_b32 exec_hi, 0x0
    s_mov_b32 s50, 0
t3_5:
    ds_read_b32 v4, v6
    s_add_u32 s50, s50, 1
    s_waitcnt lgkmcnt(0)
    v_cmp_ne_u32 vcc, 1, v4
    s_cmp_gt_u32 s50, 2000000
    s_nop 3
    s_cbranch_scc1 t3_6
    s_cbranch_vccz t3_6
    s_sleep 1
    s_branch t3_5
t3_6:
    s_mov_b64 exec, -1
    ds_read_b128 v[8:11], v7 offset:16384
    ds_read_b128 v[12:15], v7 offset:17408
    s_and_b32 s36, s29, 7
    v_mul_u32_u24 v4, 96, v2
    s_lshl_b32 s36, s36, 2
    s_bfe_u32 s37, s29, 0x20003
    v_and_b32 v5, 1, v3
    s_add_u32 s36, s36, s37
    s_mul_i32 s54, s28, 33024
    s_lshl_b32 s36, s36, 2
    s_lshr_b32 s37, s29, 5
    s_mul_i32 s35, s28, 3104
    s_add_u32 s36, s36, s37
    v_add_u32 v4, s35, v4
    s_mul_i32 s36, s36, 256
    v_mul_u32_u24 v5, 1552, v5
    s_add_u32 s54, s54, s36
    v_mul_u32_u24 v166, 1056768, v3
    s_add_u32 s54, s54, 2097152
    v_add3_u32 v5, v5, v4, 64
    s_add_u32 s55, s54, 264192
    s_add_u32 s56, s54, 528384
    v_lshl_add_u32 v4, v3, 4, v4
    v_lshl_add_u32 v166, v2, 4, v166
    s_add_u32 s57, s54, 792576
    s_cmp_lt_u32 s28, 7
    s_cbranch_scc1 A_s2_skipA
    v_mov_b32 v130, v4
    v_mov_b32 v131, v5
    v_mul_u32_u24 v4, 80, v2
    v_lshl_add_u32 v128, v3, 4, v4
    v_add_u32 v128, 25600, v128
    v_add_u32 v5, 1120, v128
    v_add_u32 v6, 2240, v128
    v_cmp_gt_u32 vcc, 7, v2
    v_lshrrev_b32 v7, 1, v3
    s_nop 0
    v_cndmask_b32 v129, v6, v5, vcc
    v_mul_u32_u24 v7, 1680, v7
    v_add_u32 v7, 25600, v7
    v_and_b32 v5, 1, v3
    v_lshlrev_b32 v5, 4, v5
    v_add3_u32 v32, v7, v4, v5
    v_sub_u32 v6, v7, v4
    v_sub_u32 v6, v6, v5
    v_add_u32 v33, 1648, v6
    v_add_u32 v4, 1120, v32
    v_add_u32 v6, 1100, v6
    v_cndmask_b32 v34, v6, v4, vcc
    v_mov_b32 v4, -4
    v_cndmask_b32 v4, v4, 4, vcc
    v_add_u32 v35, v34, v4
    v_add_u32 v36, v35, v4
    v_add_u32 v37, v36, v4
    v_bfrev_b32 v4, 1
    v_cndmask_b32 v38, v4, 0, vcc
    v_mov_b32 v4, v130
    v_mov_b32 v5, v131
    s_nop 1
A_s2_skipA:
    s_waitcnt lgkmcnt(0)
    s_barrier
    s_add_u32 s30, s59, 1
    s_cmp_gt_u32 s28, 7
    s_cbranch_scc1 A_tj2
    s_setprio 0
    s_cmp_eq_u32 s28, 7
    s_cbranch_scc1 A_p1sp
    ds_read_b128 v[16:19], v4 offset:0
    ds_read_b128 v[20:23], v4 offset:1552
    ds_read_b128 v[24:27], v5 offset:0
    v_mov_b32 v31, s30
    s_waitcnt lgkmcnt(2)
    v_mfma_f32_16x16x32_bf16 v[120:123], v[16:19], v[64:67], 0
    v_mfma_f32_16x16x32_bf16 v[124:127], v[16:19], v[68:71], 0
    v_mfma_f32_16x16x32_bf16 v[104:107], v[16:19], v[40:43], 0
    s_waitcnt lgkmcnt(1)
    v_mfma_f32_16x16x32_bf16 v[112:115], v[20:23], v[40:43], 0
    v_mfma_f32_16x16x32_bf16 v[120:123], v[20:23], v[72:75], v[120:123]
    v_mfma_f32_16x16x32_bf16 v[108:111], v[16:19], v[44:47], 0
    v_mov_b32 v19, s30
    v_mfma_f32_16x16x32_bf16 v[116:119], v[20:23], v[44:47], 0
    v_mfma_f32_16x16x32_bf16 v[124:127], v[20:23], v[76:79], v[124:127]
    v_mov_b32 v23, s30
    s_waitcnt lgkmcnt(0)
    v_mfma_f32_16x16x32_bf16 v[104:107], v[24:27], v[48:51], v[104:107]
    v_mfma_f32_16x16x32_bf16 v[112:115], v[24:27], v[56:59], v[112:115]
    v_mfma_f32_16x16x32_bf16 v[120:123], v[24:27], v[80:83], v[120:123]
    s_nop 5
    v_mul_f32 v140, v104, v88
    v_mul_f32 v144, v104, v92
    v_mfma_f32_16x16x32_bf16 v[108:111], v[24:27], v[52:55], v[108:111]
    v_mul_f32 v141, v105, v89
    v_mul_f32 v145, v105, v93
    v_mfma_f32_16x16x32_bf16 v[116:119], v[24:27], v[60:63], v[116:119]
    v_mul_f32 v142, v106, v90
    v_mul_f32 v146, v106, v94
    v_mfma_f32_16x16x32_bf16 v[124:127], v[24:27], v[84:87], v[124:127]
    v_mul_f32 v143, v107, v91
    v_mul_f32 v147, v107, v95
    v_mul_f32 v48, v112, v88
    v_mul_f32 v52, v112, v92
    v_mul_f32 v49, v113, v89
    v_mul_f32 v53, v113, v93
    v_mul_f32 v50, v114, v90
    v_mul_f32 v54, v114, v94
    v_mul_f32 v51, v115, v91
    v_mul_f32 v55, v115, v95
    v_mul_f32 v68, v120, v96
    v_mul_f32 v72, v120, v100
    v_mul_f32 v69, v121, v97
    v_mul_f32 v73, v121, v101
    v_mul_f32 v70, v122, v98
    v_mul_f32 v74, v122, v102
    v_mul_f32 v71, v123, v99
    v_mul_f32 v75, v123, v103
    v_fma_f32 v140, -v108, v92, v140
    v_fmac_f32 v144, v108, v88
    v_fma_f32 v141, -v109, v93, v141
    v_fmac_f32 v145, v109, v89
    v_fma_f32 v142, -v110, v94, v142
    v_fmac_f32 v146, v110, v90
    v_fma_f32 v143, -v111, v95, v143
    v_fmac_f32 v147, v111, v91
    v_fma_f32 v48, -v116, v92, v48
    v_fmac_f32 v52, v116, v88
    v_fma_f32 v49, -v117, v93, v49
    v_fmac_f32 v53, v117, v89
    v_fma_f32 v50, -v118, v94, v50
    v_fmac_f32 v54, v118, v90
    v_fma_f32 v51, -v119, v95, v51
    v_fmac_f32 v55, v119, v91
    v_fma_f32 v68, -v124, v100, v68
    v_fmac_f32 v72, v124, v96
    v_fma_f32 v69, -v125, v101, v69
    v_fmac_f32 v73, v125, v97
    v_fma_f32 v70, -v126, v102, v70
    v_fmac_f32 v74, v126, v98
    v_fma_f32 v71, -v127, v103, v71
    v_fmac_f32 v75, v127, v99
    v_cvt_pk_bf16_f32 v136, v140, v144
    v_cvt_pk_bf16_f32 v137, v141, v145
    v_cvt_pk_bf16_f32 v138, v142, v146
    v_cvt_pk_bf16_f32 v139, v143, v147
    v_cvt_pk_bf16_f32 v44, v48, v52
    v_cvt_pk_bf16_f32 v45, v49, v53
    v_cvt_pk_bf16_f32 v46, v50, v54
    v_cvt_pk_bf16_f32 v47, v51, v55
    v_cvt_pk_bf16_f32 v64, v68, v72
    v_cvt_pk_bf16_f32 v65, v69, v73
    v_cvt_pk_bf16_f32 v66, v70, v74
    v_cvt_pk_bf16_f32 v67, v71, v75
    v_mfma_f32_16x16x32_bf16 v[104:107], v[8:11], v[136:139], 0
    v_mov_b32 v27, s30
    v_mfma_f32_16x16x32_bf16 v[108:111], v[12:15], v[136:139], 0
    v_mfma_f32_16x16x32_bf16 v[112:115], v[8:11], v[44:47], 0
    v_mfma_f32_16x16x32_bf16 v[116:119], v[12:15], v[44:47], 0
    s_nop 5
    v_cvt_pk_bf16_f32 v16, v104, v108
    v_cvt_pk_bf16_f32 v20, v105, v109
    v_mfma_f32_16x16x32_bf16 v[120:123], v[8:11], v[64:67], 0
    v_cvt_pk_bf16_f32 v24, v106, v110
    v_cvt_pk_bf16_f32 v28, v107, v111
    v_mfma_f32_16x16x32_bf16 v[124:127], v[12:15], v[64:67], 0
    v_cvt_pk_bf16_f32 v17, v112, v116
    v_cvt_pk_bf16_f32 v21, v113, v117
    v_cvt_pk_bf16_f32 v25, v114, v118
    v_cvt_pk_bf16_f32 v29, v115, v119
    s_nop 3
    v_cvt_pk_bf16_f32 v18, v120, v124
    v_cvt_pk_bf16_f32 v22, v121, v125
    v_cvt_pk_bf16_f32 v26, v122, v126
    v_cvt_pk_bf16_f32 v30, v123, v127
    s_mov_b32 exec_lo, 0x3fff3fff
    s_mov_b32 exec_hi, 0x3fff3fff
    s_branch A_p1st
A_p1sp:
    s_setprio 2
    ds_read_b128 v[16:19], v4 offset:0
    ds_read_b128 v[20:23], v4 offset:1552
    ds_read_b128 v[24:27], v5 offset:0
    v_mov_b32 v31, s30
    s_waitcnt lgkmcnt(2)
    v_mfma_f32_16x16x32_bf16 v[120:123], v[16:19], v[64:67], 0
    v_mfma_f32_16x16x32_bf16 v[124:127], v[16:19], v[68:71], 0
    v_mfma_f32_16x16x32_bf16 v[104:107], v[16:19], v[40:43], 0
    s_waitcnt lgkmcnt(1)
    v_mfma_f32_16x16x32_bf16 v[112:115], v[20:23], v[40:43], 0
    v_mfma_f32_16x16x32_bf16 v[120:123], v[20:23], v[72:75], v[120:123]
    v_mfma_f32_16x16x32_bf16 v[108:111], v[16:19], v[44:47], 0
    v_mov_b32 v19, s30
    v_mfma_f32_16x16x32_bf16 v[116:119], v[20:23], v[44:47], 0
    v_mfma_f32_16x16x32_bf16 v[124:127], v[20:23], v[76:79], v[124:127]
    v_mov_b32 v23, s30
    s_waitcnt lgkmcnt(0)
    v_mfma_f32_16x16x32_bf16 v[104:107], v[24:27], v[48:51], v[104:107]
    v_mfma_f32_16x16x32_bf16 v[112:115], v[24:27], v[56:59], v[112:115]
    v_mfma_f32_16x16x32_bf16 v[120:123], v[24:27], v[80:83], v[120:123]
    s_nop 5
    v_mul_f32 v140, v104, v88
    v_mul_f32 v144, v104, v92
    v_mfma_f32_16x16x32_bf16 v[108:111], v[24:27], v[52:55], v[108:111]
    v_mul_f32 v141, v105, v89
    v_mul_f32 v145, v105, v93
    v_mfma_f32_16x16x32_bf16 v[116:119], v[24:27], v[60:63], v[116:119]
    v_mul_f32 v142, v106, v90
    v_mul_f32 v146, v106, v94
    v_mfma_f32_16x16x32_bf16 v[124:127], v[24:27], v[84:87], v[124:127]
    v_mul_f32 v143, v107, v91
    v_mul_f32 v147, v107, v95
    v_mul_f32 v48, v112, v88
    v_mul_f32 v52, v112, v92
    v_mul_f32 v49, v113, v89
    v_mul_f32 v53, v113, v93
    v_mul_f32 v50, v114, v90
    v_mul_f32 v54, v114, v94
    v_mul_f32 v51, v115, v91
    v_mul_f32 v55, v115, v95
    v_mul_f32 v68, v120, v96
    v_mul_f32 v72, v120, v100
    v_mul_f32 v69, v121, v97
    v_mul_f32 v73, v121, v101
    v_mul_f32 v70, v122, v98
    v_mul_f32 v74, v122, v102
    v_mul_f32 v71, v123, v99
    v_mul_f32 v75, v123, v103
    v_fma_f32 v140, -v108, v92, v140
    v_fmac_f32 v144, v108, v88
    v_fma_f32 v141, -v109, v93, v141
    v_fmac_f32 v145, v109, v89
    v_fma_f32 v142, -v110, v94, v142
    v_fmac_f32 v146, v110, v90
    v_fma_f32 v143, -v111, v95, v143
    v_fmac_f32 v147, v111, v91
    v_fma_f32 v48, -v116, v92, v48
    v_fmac_f32 v52, v116, v88
    v_fma_f32 v49, -v117, v93, v49
    v_fmac_f32 v53, v117, v89
    v_fma_f32 v50, -v118, v94, v50
    v_fmac_f32 v54, v118, v90
    v_fma_f32 v51, -v119, v95, v51
    v_fmac_f32 v55, v119, v91
    v_fma_f32 v68, -v124, v100, v68
    v_fmac_f32 v72, v124, v96
    v_fma_f32 v69, -v125, v101, v69
    v_fmac_f32 v73, v125, v97
    v_fma_f32 v70, -v126, v102, v70
    v_fmac_f32 v74, v126, v98
    v_fma_f32 v71, -v127, v103, v71
    v_fmac_f32 v75, v127, v99
    v_cvt_pk_bf16_f32 v136, v140, v144
    v_cvt_pk_bf16_f32 v137, v141, v145
    v_cvt_pk_bf16_f32 v138, v142, v146
    v_cvt_pk_bf16_f32 v139, v143, v147
    v_cvt_pk_bf16_f32 v44, v48, v52
    v_cvt_pk_bf16_f32 v45, v49, v53
    v_cvt_pk_bf16_f32 v46, v50, v54
    v_cvt_pk_bf16_f32 v47, v51, v55
    v_cvt_pk_bf16_f32 v64, v68, v72
    v_cvt_pk_bf16_f32 v65, v69, v73
    v_cvt_pk_bf16_f32 v66, v70, v74
    v_cvt_pk_bf16_f32 v67, v71, v75
    v_mfma_f32_16x16x32_bf16 v[104:107], v[8:11], v[136:139], 0
    v_mov_b32 v27, s30
    v_mfma_f32_16x16x32_bf16 v[108:111], v[12:15], v[136:139], 0
    v_mfma_f32_16x16x32_bf16 v[112:115], v[8:11], v[44:47], 0
    v_mfma_f32_16x16x32_bf16 v[116:119], v[12:15], v[44:47], 0
    s_nop 5
    v_cvt_pk_bf16_f32 v136, v104, v108
    v_cvt_pk_bf16_f32 v137, v105, v109
    v_mfma_f32_16x16x32_bf16 v[120:123], v[8:11], v[64:67], 0
    v_cvt_pk_bf16_f32 v138, v106, v110
    v_cvt_pk_bf16_f32 v139, v107, v111
    v_mfma_f32_16x16x32_bf16 v[124:127], v[12:15], v[64:67], 0
    v_cvt_pk_bf16_f32 v140, v112, v116
    v_cvt_pk_bf16_f32 v141, v113, v117
    v_cvt_pk_bf16_f32 v142, v114, v118
    v_cvt_pk_bf16_f32 v143, v115, v119
    s_nop 3
    v_cvt_pk_bf16_f32 v144, v120, v124
    v_cvt_pk_bf16_f32 v145, v121, v125
    v_cvt_pk_bf16_f32 v146, v122, v126
    v_cvt_pk_bf16_f32 v147, v123, v127
    s_mov_b32 exec_lo, 0x3fff3fff
    s_mov_b32 exec_hi, 0x3fff3fff
    ds_write_b128 v128, v[136:139]
    ds_write_b128 v128, v[140:143] offset:1680
    ds_write_b128 v129, v[144:147]
    ds_read_b32 v16, v32 offset:0
    ds_read_b32 v17, v33 offset:12
    ds_read_b32 v18, v34
    ds_read_b32 v20, v32 offset:4
    ds_read_b32 v21, v33 offset:8
    ds_read_b32 v22, v35
    ds_read_b32 v24, v32 offset:8
    ds_read_b32 v25, v33 offset:4
    ds_read_b32 v26, v36
    ds_read_b32 v28, v32 offset:12
    ds_read_b32 v29, v33 offset:0
    ds_read_b32 v30, v37
    s_waitcnt lgkmcnt(10)
    v_xor_b32 v17, 0x80000000, v17
    s_waitcnt lgkmcnt(9)
    v_xor_b32 v18, v38, v18
    s_waitcnt lgkmcnt(7)
    v_xor_b32 v21, 0x80000000, v21
    s_waitcnt lgkmcnt(6)
    v_xor_b32 v22, v38, v22
    s_waitcnt lgkmcnt(4)
    v_xor_b32 v25, 0x80000000, v25
    s_waitcnt lgkmcnt(3)
    v_xor_b32 v26, v38, v26
    s_waitcnt lgkmcnt(1)
    v_xor_b32 v29, 0x80000000, v29
    s_waitcnt lgkmcnt(0)
    v_xor_b32 v30, v38, v30
    s_nop 1
A_p1st:
    buffer_store_dwordx4 v[16:19], v166, s[8:11], s54 offen sc1
    buffer_store_dwordx4 v[20:23], v166, s[8:11], s55 offen sc1
    buffer_store_dwordx4 v[24:27], v166, s[8:11], s56 offen sc1
    buffer_store_dwordx4 v[28:31], v166, s[8:11], s57 offen sc1
    s_mov_b64 exec, -1
    s_lshl_b32 s35, s28, 2
    s_add_u32 s35, s35, 29024
    v_mov_b32 v4, s35
    v_mov_b32 v5, 1
    ds_write_b32 v4, v5
    s_nop 0
    s_branch A_s2_skip
A_tj2:
    s_setprio 0
    s_setprio 0
    s_cmp_eq_u32 s28, 8
    s_cbranch_scc1 A_noun
    s_cmp_eq_u32 s28, 11
    s_cbranch_scc1 A_noun
    s_waitcnt vmcnt(2)
    s_mov_b32 s36, 1280
    v_and_b32 v64, 0xffff, v150
    v_lshrrev_b32 v65, 16, v150
    v_and_b32 v66, 0xffff, v151
    v_lshrrev_b32 v67, 16, v151
    v_cmp_gt_u32 s[40:41], s36, v64
    v_cmp_gt_u32 s[42:43], s36, v65
    v_cmp_gt_u32 s[44:45], s36, v66
    v_cmp_gt_u32 s[46:47], s36, v67
    v_cvt_f32_u32 v64, v64
    v_cvt_f32_u32 v65, v65
    v_cvt_f32_u32 v66, v66
    v_cvt_f32_u32 v67, v67
    v_mul_f32 v64, 0x3a4ccccd, v64
    v_mul_f32 v65, 0x3a4ccccd, v65
    v_mul_f32 v66, 0x3a4ccccd, v66
    v_mul_f32 v67, 0x3a4ccccd, v67
    v_cos_f32 v68, v64
    v_sin_f32 v72, v64
    v_cos_f32 v69, v65
    v_sin_f32 v73, v65
    v_cos_f32 v70, v66
    v_sin_f32 v74, v66
    v_cos_f32 v71, v67
    v_sin_f32 v75, v67
    s_lshl_b32 s35, s28, 11
    v_cndmask_b32 v68, 0, v68, s[40:41]
    s_add_u32 s35, s35, 53760
    v_cndmask_b32 v72, 0, -v72, s[40:41]
    v_cndmask_b32 v69, 0, v69, s[42:43]
    v_cndmask_b32 v73, 0, -v73, s[42:43]
    v_cndmask_b32 v70, 0, v70, s[44:45]
    v_cndmask_b32 v74, 0, -v74, s[44:45]
    v_cndmask_b32 v71, 0, v71, s[46:47]
    v_cndmask_b32 v75, 0, -v75, s[46:47]
    v_lshl_add_u32 v84, v1, 4, s35
    s_mov_b32 s35, 0x1f93f
    s_bitcmp0_b32 s35, s28
    s_cbranch_scc1 tj_7
    v_cvt_pk_bf16_f32 v76, v68, -v72
    v_cvt_pk_bf16_f32 v80, v72, v68
    v_cvt_pk_bf16_f32 v77, v69, -v73
    v_cvt_pk_bf16_f32 v81, v73, v69
    v_cvt_pk_bf16_f32 v78, v70, -v74
    v_cvt_pk_bf16_f32 v82, v74, v70
    v_cvt_pk_bf16_f32 v79, v71, -v75
    v_cvt_pk_bf16_f32 v83, v75, v71
    ds_write_b128 v84, v[76:79]
    ds_write_b128 v84, v[80:83] offset:1024
    s_branch tj_8
tj_7:
    ds_write_b128 v84, v[68:71]
    ds_write_b128 v84, v[72:75] offset:1024
tj_8:
    s_lshl_b32 s35, s28, 2
    s_add_u32 s35, s35, 28960
    v_mov_b32 v4, s35
    v_mov_b32 v5, 1
    ds_write_b32 v4, v5
    s_nop 0
A_noun:
    s_sub_u32 s35, s28, 8
    s_lshl_b32 s35, s35, 6
    v_add_u32 v4, s35, v1
    v_mul_u32_u24 v5, 21846, v4
    v_lshrrev_b32 v5, 16, v5
    v_mul_u32_u24 v6, 3, v5
    v_sub_u32 v4, v4, v6
    v_lshlrev_b32 v4, 4, v4
    v_lshlrev_b32 v5, 4, v5
    v_add_u32 v5, s33, v5
    v_sub_u32 v6, 2048, v5
    v_and_b32 v6, 2047, v6
    v_mul_u32_u24 v5, 642, v5
    v_mul_u32_u24 v6, 642, v6
    s_and_b32 s36, s33, 1
    s_lshl_b32 s36, s36, 1
    v_subrev_u32 v4, s36, v4
    v_add_u32 v158, v5, v4
    s_mul_i32 s36, s34, 40
    s_sub_u32 s36, 596, s36
    v_add3_u32 v159, v6, v4, s36
    s_sub_u32 s35, s28, 4
    s_lshl_b32 s35, s35, 6
    v_add_u32 v4, s35, v1
    v_mul_u32_u24 v5, 21846, v4
    v_lshrrev_b32 v5, 16, v5
    v_mul_u32_u24 v6, 3, v5
    v_sub_u32 v4, v4, v6
    v_lshlrev_b32 v4, 4, v4
    v_lshlrev_b32 v5, 4, v5
    v_add_u32 v5, s33, v5
    v_sub_u32 v6, 2048, v5
    v_and_b32 v6, 2047, v6
    v_mul_u32_u24 v5, 642, v5
    v_mul_u32_u24 v6, 642, v6
    s_and_b32 s36, s33, 1
    s_lshl_b32 s36, s36, 1
    v_subrev_u32 v4, s36, v4
    v_add_u32 v160, v5, v4
    s_mul_i32 s36, s34, 40
    s_sub_u32 s36, 596, s36
    v_add3_u32 v161, v6, v4, s36
    v_lshlrev_b32 v6, 2, v1
    v_add_u32 v6, 29024, v6
    s_mov_b32 exec_lo, 0xff
    s_mov_b32 exec_hi, 0x0
    s_mov_b32 s50, 0
ws_9:
    ds_read_b32 v4, v6
    s_add_u32 s50, s50, 1
    s_waitcnt lgkmcnt(0)
    v_cmp_ne_u32 vcc, 1, v4
    s_cmp_gt_u32 s50, 2000000
    s_nop 3
    s_cbranch_scc1 ws_10
    s_cbranch_vccz ws_10
    s_sleep 1
    s_branch ws_9
ws_10:
    s_mov_b64 exec, -1
    s_mul_i32 s37, s34, 40
    s_mov_b32 s38, 0
    s_sub_u32 s35, s28, 8
    s_lshl_b32 s35, s35, 10
    s_add_u32 s35, s35, 29184
    s_add_u32 m0, s35, 0
    s_nop 0
    buffer_load_dwordx4 v158, s[12:15], s37 offen  lds
    s_add_u32 m0, s35, 6144
    s_nop 0
    buffer_load_dwordx4 v158, s[16:19], s37 offen  lds
    s_add_u32 m0, s35, 12288
    s_nop 0
    buffer_load_dwordx4 v159, s[12:15], s38 offen  lds
    s_add_u32 m0, s35, 18432
    s_nop 0
    buffer_load_dwordx4 v159, s[16:19], s38 offen  lds
    s_cmp_gt_u32 s28, 9
    s_cbranch_scc1 A_wgd
    s_add_u32 m0, s35, 4096
    s_nop 0
    buffer_load_dwordx4 v160, s[12:15], s37 offen  lds
    s_add_u32 m0, s35, 10240
    s_nop 0
    buffer_load_dwordx4 v160, s[16:19], s37 offen  lds
    s_add_u32 m0, s35, 16384
    s_nop 0
    buffer_load_dwordx4 v161, s[12:15], s38 offen  lds
    s_add_u32 m0, s35, 22528
    s_nop 0
    buffer_load_dwordx4 v161, s[16:19], s38 offen  lds
A_wgd:
A_s2_skip:
    s_setprio 0
    v_lshlrev_b32 v6, 2, v1
    v_add_u32 v6, 28960, v6
    s_mov_b32 exec_lo, 0x600
    s_mov_b32 exec_hi, 0x0
    s_mov_b32 s50, 0
tu_11:
    ds_read_b32 v4, v6
    s_add_u32 s50, s50, 1
    s_waitcnt lgkmcnt(0)
    v_cmp_ne_u32 vcc, 1, v4
    s_cmp_gt_u32 s50, 2000000
    s_nop 3
    s_cbranch_scc1 tu_12
    s_cbranch_vccz tu_12
    s_sleep 1
    s_branch tu_11
tu_12:
    s_mov_b64 exec, -1
    v_lshlrev_b32 v7, 4, v1
    v_add_u32 v7, 72192, v7
    ds_read_b128 v[88:91], v7 offset:0
    ds_read_b128 v[92:95], v7 offset:1024
    ds_read_b128 v[96:99], v7 offset:2048
    ds_read_b128 v[100:103], v7 offset:3072
    s_lshl_b32 s58, s28, 1
    s_add_u32 s35, s28, 8
    s_min_u32 s58, s58, s35
    s_add_u32 s51, s58, 1
    s_cmp_gt_u32 s28, 7
    s_cselect_b32 s51, 20, s51
    s_mul_i32 s35, s34, 20
    s_mul_i32 s36, s34, 20
    s_add_u32 s35, s35, s58
    s_add_u32 s36, s36, s51
    s_mov_b32 s44, 0x35cccccd
    s_cmp_eq_u32 s35, 160
    s_mov_b32 s45, 0x35cccccd
    s_cselect_b32 s46, 0x354ccccd, s44
    s_cmp_eq_u32 s31, 7
    v_bfe_u32 v4, v2, 1, 1
    s_cselect_b32 s44, s46, s44
    s_cmp_eq_u32 s35, 0
    v_lshrrev_b32 v5, 1, v3
    s_cselect_b32 s44, 0x354ccccd, s44
    s_cmp_eq_u32 s35, 320
    v_cmp_eq_u32 s[40:41], v4, v5
    s_cselect_b32 s44, 0x354ccccd, s44
    s_cmp_eq_u32 s36, 160
    v_lshl_add_u32 v4, v3, 5, v2
    s_cselect_b32 s47, 0x354ccccd, s45
    s_cmp_eq_u32 s31, 7
    v_mul_u32_u24 v4, 48, v4
    s_cselect_b32 s45, s47, s45
    s_cmp_eq_u32 s36, 0
    v_lshl_add_u32 v4, v3, 0, v4
    s_cselect_b32 s45, 0x354ccccd, s45
    s_cmp_eq_u32 s36, 320
    v_subrev_u32 v4, v3, v4
    s_cselect_b32 s45, 0x354ccccd, s45
    s_and_b32 s37, s33, 1
    v_cvt_f32_u32 v104, s35
    s_lshl_b32 s37, s37, 1
    s_lshl_b32 s38, s58, 1
    v_mov_b32 v105, 0.125
    s_sub_u32 s39, 44, s38
    s_add_u32 s38, s38, s37
    s_add_u32 s39, s39, s37
    s_and_b32 s98, s38, 7
    v_cvt_f32_u32 v120, s36
    s_mul_i32 s98, s98, 0x01010000
    v_mov_b32 v121, 0.125
    s_add_u32 s98, s98, 0x01000c0c
    s_and_b32 s38, s38, 0xf8
    s_and_b32 s99, s39, 7
    v_add_u32 v136, s38, v4
    s_mul_i32 s99, s99, 0x01010000
    v_fmac_f32 v105, 0x3a4ccccd, v104
    s_add_u32 s99, s99, 0x01000c0c
    s_and_b32 s39, s39, 0xf8
    s_lshl_b32 s38, s51, 1
    v_add_u32 v137, s39, v4
    s_sub_u32 s39, 44, s38
    s_add_u32 s38, s38, s37
    s_add_u32 s39, s39, s37
    s_and_b32 s100, s38, 7
    v_fmac_f32 v121, 0x3a4ccccd, v120
    s_mul_i32 s100, s100, 0x01010000
    s_mul_i32 s52, s58, 1296
    s_add_u32 s100, s100, 0x01000c0c
    s_and_b32 s38, s38, 0xf8
    s_and_b32 s101, s39, 7
    v_add_u32 v138, s38, v4
    s_mul_i32 s101, s101, 0x01010000
    s_mul_i32 s53, s51, 1296
    s_add_u32 s101, s101, 0x01000c0c
    s_and_b32 s39, s39, 0xf8
    s_and_b32 s37, s28, 7
    v_add_u32 v139, s39, v4
    s_mul_i32 s38, s37, 4096
    s_mul_i32 s39, s29, 33024
    v_cos_f32 v106, v105
    s_add_u32 s38, s38, s39
    v_sin_f32 v107, v105
    s_add_u32 s48, s38, 2097152
    s_mul_i32 s38, s37, 80
    v_cos_f32 v122, v121
    s_add_u32 s49, s38, 92672
    s_add_u32 s52, s52, 92672
    v_sin_f32 v123, v121
    s_add_u32 s53, s53, 92672
    s_lshl_b32 s54, s31, 2
    s_and_b32 s38, s32, 3
    v_cmp_gt_u32 s[42:43], 8, v2
    s_add_u32 s54, s54, s38
    v_cndmask_b32 v108, v107, v106, s[40:41]
    s_lshl_b32 s54, s54, 2
    v_cndmask_b32 v109, v107, v106, s[42:43]
    v_cndmask_b32 v124, v123, v122, s[40:41]
    v_cndmask_b32 v125, v123, v122, s[42:43]
    s_lshr_b32 s38, s32, 2
    s_waitcnt lgkmcnt(3)
    v_mul_f32 v112, v108, v88
    s_add_u32 s54, s54, s38
    s_waitcnt lgkmcnt(2)
    v_mul_f32 v113, v108, v92
    v_mul_f32 v114, v108, v89
    v_mul_f32 v115, v108, v93
    s_waitcnt lgkmcnt(1)
    v_mul_f32 v116, v109, v96
    s_waitcnt lgkmcnt(0)
    v_mul_f32 v117, v109, v100
    v_mul_f32 v118, v109, v97
    v_mul_f32 v119, v109, v101
    v_mul_f32 v128, v124, v88
    v_mul_f32 v129, v124, v92
    v_mul_f32 v130, v124, v89
    v_mul_f32 v131, v124, v93
    v_mul_f32 v132, v125, v96
    v_mul_f32 v133, v125, v100
    v_mul_f32 v134, v125, v97
    v_mul_f32 v135, v125, v101
    s_mul_i32 s54, s54, 256
    s_mul_i32 s38, s37, 33024
    v_cndmask_b32 v110, v106, v107, s[42:43]
    v_cndmask_b32 v126, v122, v123, s[42:43]
    v_mul_u32_u24 v7, 256, v3
    v_lshl_add_u32 v5, v3, 4, s49
    v_mov_b32 v6, 9712
    v_mov_b32 v144, 18144
    v_cmp_gt_u32 vcc, 7, v2
    v_mul_u32_u24 v145, 1296, v2
    v_mul_u32_u24 v146, 320, v3
    v_mul_u32_u24 v147, 80, v2
    s_add_u32 s54, s54, s38
    v_cvt_pk_bf16_f32 v40, v112, -v113
    v_cvt_pk_bf16_f32 v44, v113, v112
    v_cvt_pk_bf16_f32 v41, v114, -v115
    v_cvt_pk_bf16_f32 v45, v115, v114
    v_cvt_pk_bf16_f32 v48, v116, -v117
    v_cvt_pk_bf16_f32 v52, v117, v116
    v_cvt_pk_bf16_f32 v49, v118, -v119
    v_cvt_pk_bf16_f32 v53, v119, v118
    v_cvt_pk_bf16_f32 v56, v128, -v129
    v_cvt_pk_bf16_f32 v60, v129, v128
    v_cvt_pk_bf16_f32 v57, v130, -v131
    v_cvt_pk_bf16_f32 v61, v131, v130
    v_cvt_pk_bf16_f32 v64, v132, -v133
    v_cvt_pk_bf16_f32 v68, v133, v132
    v_cvt_pk_bf16_f32 v65, v134, -v135
    v_cvt_pk_bf16_f32 v69, v135, v134
    v_mul_f32 v112, v108, v90
    v_mul_f32 v113, v108, v94
    v_mul_f32 v114, v108, v91
    v_mul_f32 v115, v108, v95
    v_mul_f32 v116, v110, v98
    v_mul_f32 v117, v110, v102
    v_mul_f32 v118, v110, v99
    v_mul_f32 v119, v110, v103
    v_mul_f32 v128, v124, v90
    v_mul_f32 v129, v124, v94
    v_mul_f32 v130, v124, v91
    v_mul_f32 v131, v124, v95
    v_mul_f32 v132, v126, v98
    v_mul_f32 v133, v126, v102
    v_mul_f32 v134, v126, v99
    v_mul_f32 v135, v126, v103
    v_lshl_add_u32 v7, v2, 4, v7
    v_cndmask_b32 v6, v6, v144, vcc
    v_add_u32 v5, v5, v145
    v_lshl_add_u32 v146, v2, 2, v146
    v_lshl_add_u32 v147, v3, 4, v147
    s_add_u32 s54, s54, 7340032
    v_cvt_pk_bf16_f32 v42, v112, -v113
    s_add_u32 s55, s54, 264192
    s_add_u32 s56, s54, 528384
    v_cvt_pk_bf16_f32 v46, v113, v112
    v_cvt_pk_bf16_f32 v43, v114, -v115
    v_cvt_pk_bf16_f32 v47, v115, v114
    v_cvt_pk_bf16_f32 v50, v116, -v117
    v_cvt_pk_bf16_f32 v54, v117, v116
    v_cvt_pk_bf16_f32 v51, v118, -v119
    v_cvt_pk_bf16_f32 v55, v119, v118
    v_cvt_pk_bf16_f32 v58, v128, -v129
    v_cvt_pk_bf16_f32 v62, v129, v128
    v_cvt_pk_bf16_f32 v59, v130, -v131
    v_cvt_pk_bf16_f32 v63, v131, v130
    v_cvt_pk_bf16_f32 v66, v132, -v133
    v_cvt_pk_bf16_f32 v70, v133, v132
    v_cvt_pk_bf16_f32 v67, v134, -v135
    v_cvt_pk_bf16_f32 v71, v135, v134
    v_add_u32 v7, s48, v7
    v_add_u32 v6, v6, v5
    v_add_u32 v140, s52, v146
    v_add_u32 v141, s53, v146
    v_add_u32 v142, s52, v147
    v_add_u32 v143, s53, v147
    s_add_u32 s57, s54, 792576
    s_mov_b32 s58, s44
    s_mov_b32 s51, s45
    s_cmp_gt_u32 s28, 7
    s_cbranch_scc1 A_sa_skip
    s_sleep 4
    s_mov_b64 exec, s[96:97]
    s_mov_b32 s50, 0
    buffer_load_dwordx4 v[16:19], v7, s[8:11], 0 offen offset:0 sc1
    buffer_load_dwordx4 v[20:23], v7, s[8:11], 0 offen offset:1024 sc1
    buffer_load_dwordx4 v[24:27], v7, s[8:11], 0 offen offset:2048 sc1
    buffer_load_dwordx4 v[28:31], v7, s[8:11], 0 offen offset:3072 sc1
pollc_15:
    s_mov_b32 s41, 0
    s_waitcnt vmcnt(3)
    v_cmp_ne_u32 s[42:43], s30, v19
    s_nop 1
    s_cmp_lg_u64 s[42:43], 0
    s_addc_u32 s41, s41, s41
    s_waitcnt vmcnt(2)
    v_cmp_ne_u32 s[44:45], s30, v23
    s_nop 1
    s_cmp_lg_u64 s[44:45], 0
    s_addc_u32 s41, s41, s41
    s_waitcnt vmcnt(1)
    v_cmp_ne_u32 s[46:47], s30, v27
    s_nop 1
    s_cmp_lg_u64 s[46:47], 0
    s_addc_u32 s41, s41, s41
    s_waitcnt vmcnt(0)
    v_cmp_ne_u32 s[42:43], s30, v31
    s_nop 1
    s_cmp_lg_u64 s[42:43], 0
    s_addc_u32 s41, s41, s41
    s_cmp_eq_u32 s41, 0
    s_cbranch_scc1 polld_14
    s_add_u32 s50, s50, 1
    s_cmp_gt_u32 s50, 200000
    s_cbranch_scc1 polld_14
    s_sleep 2
    s_bitcmp0_b32 s41, 3
    s_cbranch_scc1 psk_16
    buffer_load_dwordx4 v[16:19], v7, s[8:11], 0 offen offset:0 sc1
psk_16:
    s_bitcmp0_b32 s41, 2
    s_cbranch_scc1 psk_17
    buffer_load_dwordx4 v[20:23], v7, s[8:11], 0 offen offset:1024 sc1
psk_17:
    s_bitcmp0_b32 s41, 1
    s_cbranch_scc1 psk_18
    buffer_load_dwordx4 v[24:27], v7, s[8:11], 0 offen offset:2048 sc1
psk_18:
    s_bitcmp0_b32 s41, 0
    s_cbranch_scc1 psk_19
    buffer_load_dwordx4 v[28:31], v7, s[8:11], 0 offen offset:3072 sc1
psk_19:
    s_waitcnt vmcnt(0)
    s_branch pollc_15
polld_14:
    s_mov_b64 exec, -1
    s_mov_b32 exec_lo, 0x3fff3fff
    s_mov_b32 exec_hi, 0x3fff3fff
    v_swap_b32 v17, v20
    v_swap_b32 v18, v24
    v_swap_b32 v19, v28
    v_swap_b32 v22, v25
    v_swap_b32 v23, v29
    v_swap_b32 v27, v30
    v_mfma_f32_16x16x32_bf16 v[104:107], v[148:151], v[16:19], 0
    v_mfma_f32_16x16x32_bf16 v[108:111], v[152:155], v[16:19], 0
    v_mfma_f32_16x16x32_bf16 v[112:115], v[148:151], v[20:23], 0
    v_mfma_f32_16x16x32_bf16 v[116:119], v[152:155], v[20:23], 0
    s_nop 5
    v_cvt_pk_bf16_f32 v16, v104, v108
    v_cvt_pk_bf16_f32 v17, v105, v109
    v_mfma_f32_16x16x32_bf16 v[120:123], v[148:151], v[24:27], 0
    v_cvt_pk_bf16_f32 v18, v106, v110
    v_cvt_pk_bf16_f32 v19, v107, v111
    v_mfma_f32_16x16x32_bf16 v[124:127], v[152:155], v[24:27], 0
    v_cvt_pk_bf16_f32 v20, v112, v116
    v_cvt_pk_bf16_f32 v21, v113, v117
    v_cvt_pk_bf16_f32 v22, v114, v118
    v_cvt_pk_bf16_f32 v23, v115, v119
    ds_write_b128 v5, v[16:19] offset:0
    ds_write_b128 v5, v[20:23] offset:640
    s_nop 1
    v_cvt_pk_bf16_f32 v24, v120, v124
    v_cvt_pk_bf16_f32 v25, v121, v125
    v_cvt_pk_bf16_f32 v26, v122, v126
    v_cvt_pk_bf16_f32 v27, v123, v127
    ds_write_b128 v6, v[24:27] offset:0
    s_mov_b64 exec, -1
A_sa_skip:
    s_cmp_eq_u32 s29, 63
    s_cselect_b32 s35, 8, 7
    s_cmp_eq_u32 s32, 15
    s_cselect_b32 s35, 8, s35
    s_cmp_lt_u32 s28, 8
    s_cbranch_scc1 A_bb
    s_waitcnt vmcnt(0)
A_bb:
    s_waitcnt lgkmcnt(0)
    s_barrier
    s_cmp_gt_u32 s28, s35
    s_cbranch_scc1 A_mid1
    ds_read2_b32 v[16:17], v140 offset0:0 offset1:20
    ds_read2_b32 v[18:19], v140 offset0:40 offset1:60
    ds_read2_b32 v[20:21], v141 offset0:0 offset1:20
    ds_read2_b32 v[22:23], v141 offset0:40 offset1:60
    ds_read_b64 v[120:121], v136 offset:29184
    ds_read_b64 v[122:123], v136 offset:29952
    ds_read_b64 v[124:125], v136 offset:35328
    ds_read_b64 v[126:127], v136 offset:36096
    ds_read_b64 v[128:129], v137 offset:41472
    ds_read_b64 v[130:131], v137 offset:42240
    ds_read_b64 v[132:133], v137 offset:47616
    ds_read_b64 v[134:135], v137 offset:48384
    ds_read_b64 v[88:89], v138 offset:29184
    ds_read_b64 v[90:91], v138 offset:29952
    ds_read_b64 v[92:93], v138 offset:35328
    ds_read_b64 v[94:95], v138 offset:36096
    ds_read_b64 v[96:97], v139 offset:41472
    ds_read_b64 v[98:99], v139 offset:42240
    ds_read_b64 v[100:101], v139 offset:47616
    ds_read_b64 v[102:103], v139 offset:48384
    s_waitcnt lgkmcnt(15)
    v_mfma_f32_16x16x32_bf16 v[104:107], v[40:43], v[16:19], 0
    v_perm_b32 v72, v121, v120, s98
    v_mfma_f32_16x16x32_bf16 v[112:115], v[56:59], v[20:23], 0
    s_waitcnt lgkmcnt(14)
    v_perm_b32 v73, v123, v122, s98
    s_waitcnt lgkmcnt(13)
    v_perm_b32 v76, v125, v124, s98
    v_mfma_f32_16x16x32_bf16 v[108:111], v[44:47], v[16:19], 0
    s_waitcnt lgkmcnt(12)
    v_perm_b32 v77, v127, v126, s98
    s_waitcnt lgkmcnt(11)
    v_perm_b32 v74, v129, v128, s99
    v_mfma_f32_16x16x32_bf16 v[116:119], v[60:63], v[20:23], 0
    s_waitcnt lgkmcnt(10)
    v_perm_b32 v75, v131, v130, s99
    s_waitcnt lgkmcnt(9)
    v_perm_b32 v78, v133, v132, s99
    s_waitcnt lgkmcnt(8)
    v_perm_b32 v79, v135, v134, s99
    s_waitcnt lgkmcnt(7)
    v_perm_b32 v80, v89, v88, s100
    s_waitcnt lgkmcnt(6)
    v_perm_b32 v81, v91, v90, s100
    s_waitcnt lgkmcnt(5)
    v_perm_b32 v84, v93, v92, s100
    s_waitcnt lgkmcnt(4)
    v_perm_b32 v85, v95, v94, s100
    s_waitcnt lgkmcnt(3)
    v_perm_b32 v82, v97, v96, s101
    s_waitcnt lgkmcnt(2)
    v_perm_b32 v83, v99, v98, s101
    s_waitcnt lgkmcnt(1)
    v_perm_b32 v86, v101, v100, s101
    s_waitcnt lgkmcnt(0)
    v_perm_b32 v87, v103, v102, s101
    v_mul_f32 v72, s58, v72
    v_mul_f32 v73, s58, v73
    v_mul_f32 v76, s58, v76
    v_mul_f32 v77, s58, v77
    v_mul_f32 v74, s58, v74
    v_mul_f32 v75, s58, v75
    v_mul_f32 v78, s58, -v78
    v_mul_f32 v79, s58, -v79
    v_mul_f32 v80, s51, v80
    v_mul_f32 v81, s51, v81
    v_mul_f32 v84, s51, v84
    v_mul_f32 v85, s51, v85
    v_mul_f32 v82, s51, v82
    v_mul_f32 v83, s51, v83
    v_mul_f32 v86, s51, -v86
    v_mul_f32 v87, s51, -v87
    v_mul_f32 v124, v104, v72
    v_mul_f32 v128, v104, v76
    v_mul_f32 v125, v105, v73
    v_mul_f32 v129, v105, v77
    v_mul_f32 v126, v106, v74
    v_mul_f32 v130, v106, v78
    v_mul_f32 v127, v107, v75
    v_mul_f32 v131, v107, v79
    v_mul_f32 v32, v112, v80
    v_mul_f32 v36, v112, v84
    v_mul_f32 v33, v113, v81
    v_mul_f32 v37, v113, v85
    v_mul_f32 v34, v114, v82
    v_mul_f32 v38, v114, v86
    v_mul_f32 v35, v115, v83
    v_mul_f32 v39, v115, v87
    v_fma_f32 v124, -v108, v76, v124
    v_fmac_f32 v128, v108, v72
    v_fma_f32 v125, -v109, v77, v125
    v_fmac_f32 v129, v109, v73
    v_fma_f32 v126, -v110, v78, v126
    v_fmac_f32 v130, v110, v74
    v_fma_f32 v127, -v111, v79, v127
    v_fmac_f32 v131, v111, v75
    v_fma_f32 v32, -v116, v84, v32
    v_fmac_f32 v36, v116, v80
    v_fma_f32 v33, -v117, v85, v33
    v_fmac_f32 v37, v117, v81
    v_fma_f32 v34, -v118, v86, v34
    v_fmac_f32 v38, v118, v82
    v_fma_f32 v35, -v119, v87, v35
    v_fmac_f32 v39, v119, v83
    v_cvt_pk_bf16_f32 v120, v124, v128
    v_cvt_pk_bf16_f32 v121, v125, v129
    v_cvt_pk_bf16_f32 v122, v126, v130
    v_cvt_pk_bf16_f32 v123, v127, v131
    v_cvt_pk_bf16_f32 v28, v32, v36
    v_cvt_pk_bf16_f32 v29, v33, v37
    v_cvt_pk_bf16_f32 v30, v34, v38
    v_cvt_pk_bf16_f32 v31, v35, v39
    v_mfma_f32_16x16x32_bf16 v[104:107], v[120:123], v[48:51], 0
    v_mfma_f32_16x16x32_bf16 v[108:111], v[120:123], v[52:55], 0
    v_mfma_f32_16x16x32_bf16 v[112:115], v[28:31], v[64:67], 0
    v_mfma_f32_16x16x32_bf16 v[116:119], v[28:31], v[68:71], 0
    s_nop 5
    v_cvt_pk_bf16_f32 v24, v104, v108
    v_cvt_pk_bf16_f32 v25, v105, v109
    v_cvt_pk_bf16_f32 v26, v106, v110
    v_cvt_pk_bf16_f32 v27, v107, v111
    ds_write_b128 v142, v[24:27]
    v_cvt_pk_bf16_f32 v28, v112, v116
    v_cvt_pk_bf16_f32 v29, v113, v117
    v_cvt_pk_bf16_f32 v30, v114, v118
    v_cvt_pk_bf16_f32 v31, v115, v119
    ds_write_b128 v143, v[28:31]
    s_nop 0
    s_branch A_mid_done
A_mid1:
    ds_read2_b32 v[16:17], v140 offset0:0 offset1:20
    ds_read2_b32 v[18:19], v140 offset0:40 offset1:60
    ds_read_b64 v[120:121], v136 offset:29184
    ds_read_b64 v[122:123], v136 offset:29952
    ds_read_b64 v[124:125], v136 offset:35328
    ds_read_b64 v[126:127], v136 offset:36096
    ds_read_b64 v[128:129], v137 offset:41472
    ds_read_b64 v[130:131], v137 offset:42240
    ds_read_b64 v[132:133], v137 offset:47616
    ds_read_b64 v[134:135], v137 offset:48384
    s_waitcnt lgkmcnt(8)
    v_mfma_f32_16x16x32_bf16 v[104:107], v[40:43], v[16:19], 0
    s_waitcnt lgkmcnt(7)
    v_perm_b32 v72, v121, v120, s98
    s_waitcnt lgkmcnt(6)
    v_perm_b32 v73, v123, v122, s98
    v_mfma_f32_16x16x32_bf16 v[108:111], v[44:47], v[16:19], 0
    s_waitcnt lgkmcnt(5)
    v_perm_b32 v76, v125, v124, s98
    s_waitcnt lgkmcnt(4)
    v_perm_b32 v77, v127, v126, s98
    s_waitcnt lgkmcnt(3)
    v_perm_b32 v74, v129, v128, s99
    s_waitcnt lgkmcnt(2)
    v_perm_b32 v75, v131, v130, s99
    s_waitcnt lgkmcnt(1)
    v_perm_b32 v78, v133, v132, s99
    s_waitcnt lgkmcnt(0)
    v_perm_b32 v79, v135, v134, s99
    v_mul_f32 v72, s58, v72
    v_mul_f32 v73, s58, v73
    v_mul_f32 v76, s58, v76
    v_mul_f32 v77, s58, v77
    v_mul_f32 v74, s58, v74
    v_mul_f32 v75, s58, v75
    v_mul_f32 v78, s58, -v78
    v_mul_f32 v79, s58, -v79
    v_mul_f32 v124, v104, v72
    v_mul_f32 v128, v104, v76
    v_mul_f32 v125, v105, v73
    v_mul_f32 v129, v105, v77
    v_mul_f32 v126, v106, v74
    v_mul_f32 v130, v106, v78
    v_mul_f32 v127, v107, v75
    v_mul_f32 v131, v107, v79
    v_fma_f32 v124, -v108, v76, v124
    v_fmac_f32 v128, v108, v72
    v_fma_f32 v125, -v109, v77, v125
    v_fmac_f32 v129, v109, v73
    v_fma_f32 v126, -v110, v78, v126
    v_fmac_f32 v130, v110, v74
    v_fma_f32 v127, -v111, v79, v127
    v_fmac_f32 v131, v111, v75
    v_cvt_pk_bf16_f32 v120, v124, v128
    v_cvt_pk_bf16_f32 v121, v125, v129
    v_cvt_pk_bf16_f32 v122, v126, v130
    v_cvt_pk_bf16_f32 v123, v127, v131
    s_nop 1
    v_mfma_f32_16x16x32_bf16 v[104:107], v[120:123], v[48:51], 0
    v_mfma_f32_16x16x32_bf16 v[108:111], v[120:123], v[52:55], 0
    s_nop 7
    v_cvt_pk_bf16_f32 v24, v104, v108
    v_cvt_pk_bf16_f32 v25, v105, v109
    v_cvt_pk_bf16_f32 v26, v106, v110
    v_cvt_pk_bf16_f32 v27, v107, v111
    ds_write_b128 v142, v[24:27]
    s_cmp_lg_u32 s28, 8
    s_cbranch_scc1 A_mid_done
    v_mov_b32 v16, 0
    v_mov_b32 v17, 0
    v_mov_b32 v18, 0
    v_mov_b32 v19, 0
    ds_write_b128 v143, v[16:19]
    s_nop 0
A_mid_done:
    s_waitcnt lgkmcnt(0)
    s_barrier
    s_cmp_gt_u32 s28, 7
    s_cbranch_scc1 A_sl_skip
    ds_read_b128 v[136:139], v5 offset:0
    ds_read_b128 v[140:143], v5 offset:640
    ds_read_b128 v[144:147], v6 offset:0
    v_mov_b32 v19, s30
    v_mov_b32 v23, s30
    v_mov_b32 v27, s30
    v_mov_b32 v31, s30
    s_waitcnt lgkmcnt(2)
    v_mfma_f32_16x16x32_bf16 v[104:107], v[156:159], v[136:139], 0
    v_mfma_f32_16x16x32_bf16 v[108:111], v[160:163], v[136:139], 0
    s_waitcnt lgkmcnt(1)
    v_mfma_f32_16x16x32_bf16 v[112:115], v[156:159], v[140:143], 0
    v_mfma_f32_16x16x32_bf16 v[116:119], v[160:163], v[140:143], 0
    s_nop 4
    v_cvt_pk_bf16_f32 v16, v104, v108
    v_cvt_pk_bf16_f32 v20, v105, v109
    s_waitcnt lgkmcnt(0)
    v_mfma_f32_16x16x32_bf16 v[120:123], v[156:159], v[144:147], 0
    v_cvt_pk_bf16_f32 v24, v106, v110
    v_cvt_pk_bf16_f32 v28, v107, v111
    v_mfma_f32_16x16x32_bf16 v[124:127], v[160:163], v[144:147], 0
    v_cvt_pk_bf16_f32 v17, v112, v116
    v_cvt_pk_bf16_f32 v21, v113, v117
    v_cvt_pk_bf16_f32 v25, v114, v118
    v_cvt_pk_bf16_f32 v29, v115, v119
    s_nop 3
    v_cvt_pk_bf16_f32 v18, v120, v124
    v_cvt_pk_bf16_f32 v22, v121, v125
    v_cvt_pk_bf16_f32 v26, v122, v126
    v_cvt_pk_bf16_f32 v30, v123, v127
    s_mov_b32 exec_lo, 0x3fff3fff
    s_mov_b32 exec_hi, 0x3fff3fff
    buffer_store_dwordx4 v[16:19], v166, s[8:11], s54 offen sc1
    buffer_store_dwordx4 v[20:23], v166, s[8:11], s55 offen sc1
    buffer_store_dwordx4 v[24:27], v166, s[8:11], s56 offen sc1
    buffer_store_dwordx4 v[28:31], v166, s[8:11], s57 offen sc1
    s_mov_b64 exec, -1
    s_nop 0
    s_branch A_sl_done
A_sl_skip:
    s_mov_b32 s36, 1280
    s_lshl_b32 s48, s28, 1
    s_sub_u32 s48, s48, 5
    v_and_b32 v104, 0xffff, v154
    v_lshrrev_b32 v105, 16, v154
    v_and_b32 v106, 0xffff, v155
    v_lshrrev_b32 v107, 16, v155
    v_cmp_gt_u32 s[40:41], s36, v104
    v_cmp_gt_u32 s[42:43], s36, v105
    v_cmp_gt_u32 s[44:45], s36, v106
    v_cmp_gt_u32 s[46:47], s36, v107
    v_cvt_f32_u32 v104, v104
    v_cvt_f32_u32 v105, v105
    v_cvt_f32_u32 v106, v106
    v_cvt_f32_u32 v107, v107
    v_mul_f32 v104, 0x3a4ccccd, v104
    v_mul_f32 v105, 0x3a4ccccd, v105
    v_mul_f32 v106, 0x3a4ccccd, v106
    v_mul_f32 v107, 0x3a4ccccd, v107
    v_cos_f32 v108, v104
    v_sin_f32 v112, v104
    v_cos_f32 v109, v105
    v_sin_f32 v113, v105
    v_cos_f32 v110, v106
    v_sin_f32 v114, v106
    v_cos_f32 v111, v107
    v_sin_f32 v115, v107
    s_lshl_b32 s35, s48, 11
    v_cndmask_b32 v108, 0, v108, s[40:41]
    s_add_u32 s35, s35, 53760
    v_cndmask_b32 v112, 0, -v112, s[40:41]
    v_cndmask_b32 v109, 0, v109, s[42:43]
    v_cndmask_b32 v113, 0, -v113, s[42:43]
    v_cndmask_b32 v110, 0, v110, s[44:45]
    v_cndmask_b32 v114, 0, -v114, s[44:45]
    v_cndmask_b32 v111, 0, v111, s[46:47]
    v_cndmask_b32 v115, 0, -v115, s[46:47]
    v_lshl_add_u32 v124, v1, 4, s35
    s_mov_b32 s35, 0x1f93f
    s_bitcmp0_b32 s35, s48
    s_cbranch_scc1 tj_20
    v_cvt_pk_bf16_f32 v116, v108, -v112
    v_cvt_pk_bf16_f32 v120, v112, v108
    v_cvt_pk_bf16_f32 v117, v109, -v113
    v_cvt_pk_bf16_f32 v121, v113, v109
    v_cvt_pk_bf16_f32 v118, v110, -v114
    v_cvt_pk_bf16_f32 v122, v114, v110
    v_cvt_pk_bf16_f32 v119, v111, -v115
    v_cvt_pk_bf16_f32 v123, v115, v111
    ds_write_b128 v124, v[116:119]
    ds_write_b128 v124, v[120:123] offset:1024
    s_branch tj_21
tj_20:
    ds_write_b128 v124, v[108:111]
    ds_write_b128 v124, v[112:115] offset:1024
tj_21:
    s_mov_b32 s36, 1280
    s_add_u32 s48, s48, 1
    v_and_b32 v8, 0xffff, v156
    v_lshrrev_b32 v9, 16, v156
    v_and_b32 v10, 0xffff, v157
    v_lshrrev_b32 v11, 16, v157
    v_cmp_gt_u32 s[40:41], s36, v8
    v_cmp_gt_u32 s[42:43], s36, v9
    v_cmp_gt_u32 s[44:45], s36, v10
    v_cmp_gt_u32 s[46:47], s36, v11
    v_cvt_f32_u32 v8, v8
    v_cvt_f32_u32 v9, v9
    v_cvt_f32_u32 v10, v10
    v_cvt_f32_u32 v11, v11
    v_mul_f32 v8, 0x3a4ccccd, v8
    v_mul_f32 v9, 0x3a4ccccd, v9
    v_mul_f32 v10, 0x3a4ccccd, v10
    v_mul_f32 v11, 0x3a4ccccd, v11
    v_cos_f32 v12, v8
    v_sin_f32 v16, v8
    v_cos_f32 v13, v9
    v_sin_f32 v17, v9
    v_cos_f32 v14, v10
    v_sin_f32 v18, v10
    v_cos_f32 v15, v11
    v_sin_f32 v19, v11
    s_lshl_b32 s35, s48, 11
    v_cndmask_b32 v12, 0, v12, s[40:41]
    s_add_u32 s35, s35, 53760
    v_cndmask_b32 v16, 0, -v16, s[40:41]
    v_cndmask_b32 v13, 0, v13, s[42:43]
    v_cndmask_b32 v17, 0, -v17, s[42:43]
    v_cndmask_b32 v14, 0, v14, s[44:45]
    v_cndmask_b32 v18, 0, -v18, s[44:45]
    v_cndmask_b32 v15, 0, v15, s[46:47]
    v_cndmask_b32 v19, 0, -v19, s[46:47]
    v_lshl_add_u32 v28, v1, 4, s35
    s_mov_b32 s35, 0x1f93f
    s_bitcmp0_b32 s35, s48
    s_cbranch_scc1 tj_22
    v_cvt_pk_bf16_f32 v20, v12, -v16
    v_cvt_pk_bf16_f32 v24, v16, v12
    v_cvt_pk_bf16_f32 v21, v13, -v17
    v_cvt_pk_bf16_f32 v25, v17, v13
    v_cvt_pk_bf16_f32 v22, v14, -v18
    v_cvt_pk_bf16_f32 v26, v18, v14
    v_cvt_pk_bf16_f32 v23, v15, -v19
    v_cvt_pk_bf16_f32 v27, v19, v15
    ds_write_b128 v28, v[20:23]
    ds_write_b128 v28, v[24:27] offset:1024
    s_branch tj_23
tj_22:
    ds_write_b128 v28, v[12:15]
    ds_write_b128 v28, v[16:19] offset:1024
tj_23:
    s_lshl_b32 s35, s28, 2
    s_add_u32 s35, s35, 28960
    v_mov_b32 v4, s35
    v_mov_b32 v5, 2
    ds_write_b32 v4, v5
    s_nop 0
A_sl_done:
    s_cmp_lt_u32 s28, 7
    s_cbranch_scc1 A_g1_skip
    v_lshlrev_b32 v6, 1, v3
    v_lshlrev_b32 v4, 7, v2
    v_add_u32 v7, 2, v6
    v_add_u32 v5, s29, v4
    v_cmp_eq_u32 vcc, 3, v3
    v_add_u32 v6, 1, v6
    s_nop 0
    v_cndmask_b32 v4, v5, v4, vcc
    v_mul_u32_u24 v104, v5, v6
    v_cndmask_b32 v116, v7, 0, vcc
    v_mul_u32_u24 v107, v4, v7
    v_and_b32 v104, 2047, v104
    v_mul_u32_u24 v106, v4, v116
    v_and_b32 v107, 2047, v107
    v_mov_b32 v105, v104
    v_and_b32 v106, 2047, v106
    v_cvt_f32_u32 v105, v105
    v_cvt_f32_u32 v107, v107
    v_and_b32 v121, 3, v2
    v_cvt_f32_u32 v104, v104
    v_cvt_f32_u32 v106, v106
    v_mul_f32 v105, 0x3a000000, v105
    v_mul_f32 v107, 0x3a000000, v107
    v_lshrrev_b32 v120, 2, v2
    v_mul_u32_u24 v122, 400, v121
    s_sub_u32 s35, s28, 7
    v_mul_f32 v104, 0x3a000000, v104
    v_mul_f32 v106, 0x3a000000, v106
    v_cos_f32 v109, v105
    v_sin_f32 v113, v105
    v_cos_f32 v111, v107
    v_sin_f32 v115, v107
    v_lshl_add_u32 v122, v120, 2, v122
    v_mul_u32_u24 v123, 6336, v3
    s_lshl_b32 s36, s35, 4
    v_cos_f32 v108, v104
    v_sin_f32 v112, v104
    v_cos_f32 v110, v106
    v_sin_f32 v114, v106
    v_add3_u32 v164, v122, v123, s36
    v_mov_b32 v117, 0x80008000
    s_lshl_b32 s35, s35, 8
    s_mul_i32 s36, s29, 2560
    v_cndmask_b32 v117, v117, 0, vcc
    v_cvt_pk_bf16_f32 v37, v113, v109
    v_cvt_pk_bf16_f32 v39, v115, v111
    v_mul_u32_u24 v122, 1310720, v3
    s_add_u32 s54, s35, s36
    v_cvt_pk_bf16_f32 v32, v108, -v112
    s_add_u32 s55, s54, 327680
    s_add_u32 s56, s54, 655360
    v_cvt_pk_bf16_f32 v36, v112, v108
    v_cvt_pk_bf16_f32 v33, v109, -v113
    v_cvt_pk_bf16_f32 v34, v110, -v114
    v_cvt_pk_bf16_f32 v38, v114, v110
    v_cvt_pk_bf16_f32 v35, v111, -v115
    v_xor_b32 v37, 0x80008000, v37
    v_xor_b32 v39, v117, v39
    v_lshl_add_u32 v165, v2, 4, v122
    s_add_u32 s57, s54, 983040
    s_nop 0
A_g1_skip:
    s_cmp_gt_u32 s28, 7
    s_cbranch_scc1 A_p3_skip
    v_lshlrev_b32 v6, 2, v1
    v_add_u32 v6, 28960, v6
    s_mov_b32 exec_lo, 0xf00
    s_mov_b32 exec_hi, 0x0
    s_mov_b32 s50, 0
tg_24:
    ds_read_b32 v4, v6
    s_add_u32 s50, s50, 1
    s_waitcnt lgkmcnt(0)
    v_cmp_ne_u32 vcc, 2, v4
    s_cmp_gt_u32 s50, 2000000
    s_nop 3
    s_cbranch_scc1 tg_25
    s_cbranch_vccz tg_25
    s_sleep 1
    s_branch tg_24
tg_25:
    s_mov_b64 exec, -1
    v_lshlrev_b32 v7, 4, v1
    v_add_u32 v7, 76288, v7
    ds_read_b128 v[40:43], v7 offset:0
    ds_read_b128 v[44:47], v7 offset:1024
    ds_read_b128 v[48:51], v7 offset:2048
    ds_read_b128 v[52:55], v7 offset:3072
    ds_read_b128 v[56:59], v7 offset:4096
    ds_read_b128 v[60:63], v7 offset:5120
    ds_read_b128 v[64:67], v7 offset:6144
    ds_read_b128 v[68:71], v7 offset:7168
    ds_read_b128 v[72:75], v7 offset:8192
    ds_read_b128 v[76:79], v7 offset:9216
    ds_read_b128 v[80:83], v7 offset:10240
    ds_read_b128 v[84:87], v7 offset:11264
    ds_read_b128 v[88:91], v7 offset:12288
    ds_read_b128 v[92:95], v7 offset:13312
    ds_read_b128 v[96:99], v7 offset:14336
    ds_read_b128 v[100:103], v7 offset:15360
    v_xor_b32 v8, 0x80000000, v8
    v_xor_b32 v12, 0x8000, v12
    v_xor_b32 v9, 0x80000000, v9
    v_xor_b32 v13, 0x8000, v13
    v_xor_b32 v10, 0x80000000, v10
    v_xor_b32 v14, 0x8000, v14
    v_xor_b32 v11, 0x80000000, v11
    v_xor_b32 v15, 0x8000, v15
    v_mov_b32 v16, 0
    v_mov_b32 v17, 0
    v_mov_b32 v18, 0
    v_mov_b32 v19, 0
    v_mov_b32 v20, 0
    v_mov_b32 v21, 0
    v_mov_b32 v22, 0
    v_mov_b32 v23, 0
    v_mov_b32 v24, 0
    v_mov_b32 v25, 0
    v_mov_b32 v26, 0
    v_mov_b32 v27, 0
    v_mov_b32 v28, 0
    v_mov_b32 v29, 0
    v_mov_b32 v30, 0
    v_mov_b32 v31, 0
    s_cmp_lt_u32 s28, 7
    s_nop 0
    s_cbranch_scc1 A_noperm
    v_mul_u32_u24 v4, 80, v2
    v_lshl_add_u32 v148, v3, 4, v4
    v_add_u32 v148, 25600, v148
    v_add_u32 v5, 1120, v148
    v_add_u32 v6, 2240, v148
    v_cmp_gt_u32 vcc, 7, v2
    v_lshrrev_b32 v7, 1, v3
    s_nop 0
    v_cndmask_b32 v149, v6, v5, vcc
    v_mul_u32_u24 v7, 1680, v7
    v_add_u32 v7, 25600, v7
    v_and_b32 v5, 1, v3
    v_lshlrev_b32 v5, 4, v5
    v_add3_u32 v150, v7, v4, v5
    v_sub_u32 v6, v7, v4
    v_sub_u32 v6, v6, v5
    v_add_u32 v151, 1648, v6
    v_add_u32 v4, 1120, v150
    v_add_u32 v6, 1100, v6
    v_cndmask_b32 v152, v6, v4, vcc
    v_mov_b32 v4, -4
    v_cndmask_b32 v4, v4, 4, vcc
    v_add_u32 v153, v152, v4
    v_add_u32 v154, v153, v4
    v_add_u32 v155, v154, v4
    v_bfrev_b32 v4, 1
    v_cndmask_b32 v156, v4, 0, vcc
    v_mov_b32 v136, 0
    v_mov_b32 v137, 0
    v_mov_b32 v138, 0
    v_mov_b32 v139, 0
    v_mov_b32 v140, 0
    v_mov_b32 v141, 0
    v_mov_b32 v142, 0
    v_mov_b32 v143, 0
    v_mov_b32 v144, 0
    v_mov_b32 v145, 0
    v_mov_b32 v146, 0
    v_mov_b32 v147, 0
    s_nop 1
A_noperm:
    s_mul_i32 s35, s28, 4096
    s_mul_i32 s36, s29, 33024
    s_add_u32 s35, s35, s36
    s_add_u32 s35, s35, 7340032
    v_mul_u32_u24 v4, 256, v3
    v_lshl_add_u32 v4, v2, 4, v4
    v_add_u32 v4, s35, v4
    s_mul_i32 s35, s28, 3168
    v_lshrrev_b32 v5, 2, v2
    v_lshlrev_b32 v5, 4, v5
    v_mul_u32_u24 v6, 96, v2
    v_add3_u32 v5, v5, v6, s35
    v_mul_u32_u24 v6, 1584, v3
    v_add3_u32 v6, v6, v5, 64
    v_lshl_add_u32 v5, v3, 4, v5
    s_waitcnt lgkmcnt(0)
    s_sleep 16
    s_mov_b64 exec, s[96:97]
    s_mov_b32 s50, 0
    buffer_load_dwordx4 v[16:19], v4, s[8:11], 0 offen offset:0 sc1
    buffer_load_dwordx4 v[20:23], v4, s[8:11], 0 offen offset:1024 sc1
    buffer_load_dwordx4 v[24:27], v4, s[8:11], 0 offen offset:2048 sc1
    buffer_load_dwordx4 v[28:31], v4, s[8:11], 0 offen offset:3072 sc1
pollc_28:
    s_mov_b32 s41, 0
    s_waitcnt vmcnt(3)
    v_cmp_ne_u32 s[42:43], s30, v19
    s_nop 1
    s_cmp_lg_u64 s[42:43], 0
    s_addc_u32 s41, s41, s41
    s_waitcnt vmcnt(2)
    v_cmp_ne_u32 s[44:45], s30, v23
    s_nop 1
    s_cmp_lg_u64 s[44:45], 0
    s_addc_u32 s41, s41, s41
    s_waitcnt vmcnt(1)
    v_cmp_ne_u32 s[46:47], s30, v27
    s_nop 1
    s_cmp_lg_u64 s[46:47], 0
    s_addc_u32 s41, s41, s41
    s_waitcnt vmcnt(0)
    v_cmp_ne_u32 s[42:43], s30, v31
    s_nop 1
    s_cmp_lg_u64 s[42:43], 0
    s_addc_u32 s41, s41, s41
    s_cmp_eq_u32 s41, 0
    s_cbranch_scc1 polld_27
    s_add_u32 s50, s50, 1
    s_cmp_gt_u32 s50, 200000
    s_cbranch_scc1 polld_27
    s_sleep 2
    s_bitcmp0_b32 s41, 3
    s_cbranch_scc1 psk_29
    buffer_load_dwordx4 v[16:19], v4, s[8:11], 0 offen offset:0 sc1
psk_29:
    s_bitcmp0_b32 s41, 2
    s_cbranch_scc1 psk_30
    buffer_load_dwordx4 v[20:23], v4, s[8:11], 0 offen offset:1024 sc1
psk_30:
    s_bitcmp0_b32 s41, 1
    s_cbranch_scc1 psk_31
    buffer_load_dwordx4 v[24:27], v4, s[8:11], 0 offen offset:2048 sc1
psk_31:
    s_bitcmp0_b32 s41, 0
    s_cbranch_scc1 psk_32
    buffer_load_dwordx4 v[28:31], v4, s[8:11], 0 offen offset:3072 sc1
psk_32:
    s_waitcnt vmcnt(0)
    s_branch pollc_28
polld_27:
    s_mov_b64 exec, -1
    s_cmp_eq_u32 s28, 7
    s_cbranch_scc1 A_p3sp
    v_swap_b32 v17, v20
    v_swap_b32 v18, v24
    v_swap_b32 v19, v28
    v_swap_b32 v22, v25
    v_swap_b32 v23, v29
    v_mfma_f32_16x16x32_bf16 v[104:107], v[16:19], v[8:11], 0
    v_swap_b32 v27, v30
    v_mfma_f32_16x16x32_bf16 v[108:111], v[16:19], v[12:15], 0
    v_mfma_f32_16x16x32_bf16 v[112:115], v[20:23], v[8:11], 0
    s_nop 4
    v_mul_f32 v140, v104, v88
    v_mul_f32 v144, v104, v92
    v_mfma_f32_16x16x32_bf16 v[116:119], v[20:23], v[12:15], 0
    v_mul_f32 v141, v105, v89
    v_mul_f32 v145, v105, v93
    v_mfma_f32_16x16x32_bf16 v[120:123], v[24:27], v[8:11], 0
    v_mul_f32 v142, v106, v90
    v_mul_f32 v146, v106, v94
    v_mul_f32 v143, v107, v91
    v_mul_f32 v147, v107, v95
    v_mfma_f32_16x16x32_bf16 v[124:127], v[24:27], v[12:15], 0
    v_fma_f32 v140, -v108, v92, v140
    v_fmac_f32 v144, v108, v88
    v_fma_f32 v141, -v109, v93, v141
    v_fmac_f32 v145, v109, v89
    v_fma_f32 v142, -v110, v94, v142
    v_fmac_f32 v146, v110, v90
    v_fma_f32 v143, -v111, v95, v143
    v_fmac_f32 v147, v111, v91
    v_mul_f32 v20, v112, v88
    v_mul_f32 v24, v112, v92
    v_mul_f32 v21, v113, v89
    v_mul_f32 v25, v113, v93
    v_mul_f32 v22, v114, v90
    v_mul_f32 v26, v114, v94
    v_mul_f32 v23, v115, v91
    v_mul_f32 v27, v115, v95
    v_cvt_pk_bf16_f32 v136, v140, v144
    v_cvt_pk_bf16_f32 v137, v141, v145
    v_cvt_pk_bf16_f32 v138, v142, v146
    v_cvt_pk_bf16_f32 v139, v143, v147
    v_fma_f32 v20, -v116, v92, v20
    v_fmac_f32 v24, v116, v88
    v_fma_f32 v21, -v117, v93, v21
    v_fmac_f32 v25, v117, v89
    v_fma_f32 v22, -v118, v94, v22
    v_fmac_f32 v26, v118, v90
    v_fma_f32 v23, -v119, v95, v23
    v_fmac_f32 v27, v119, v91
    v_mfma_f32_16x16x32_bf16 v[128:131], v[64:67], v[136:139], 0
    v_cvt_pk_bf16_f32 v16, v20, v24
    v_cvt_pk_bf16_f32 v17, v21, v25
    v_mfma_f32_16x16x32_bf16 v[132:135], v[68:71], v[136:139], 0
    v_cvt_pk_bf16_f32 v18, v22, v26
    v_cvt_pk_bf16_f32 v19, v23, v27
    v_mul_f32 v152, v120, v96
    v_mul_f32 v156, v120, v100
    v_mul_f32 v153, v121, v97
    v_mul_f32 v157, v121, v101
    v_mul_f32 v154, v122, v98
    v_mul_f32 v158, v122, v102
    v_mul_f32 v155, v123, v99
    v_mul_f32 v159, v123, v103
    v_mfma_f32_16x16x32_bf16 v[104:107], v[40:43], v[136:139], 0
    v_fma_f32 v152, -v124, v100, v152
    v_fmac_f32 v156, v124, v96
    v_mfma_f32_16x16x32_bf16 v[112:115], v[40:43], v[16:19], 0
    v_fma_f32 v153, -v125, v101, v153
    v_fmac_f32 v157, v125, v97
    v_mfma_f32_16x16x32_bf16 v[108:111], v[44:47], v[136:139], 0
    v_fma_f32 v154, -v126, v102, v154
    v_fmac_f32 v158, v126, v98
    v_mfma_f32_16x16x32_bf16 v[116:119], v[44:47], v[16:19], 0
    v_fma_f32 v155, -v127, v103, v155
    v_fmac_f32 v159, v127, v99
    v_mfma_f32_16x16x32_bf16 v[128:131], v[72:75], v[16:19], v[128:131]
    v_cvt_pk_bf16_f32 v148, v152, v156
    v_cvt_pk_bf16_f32 v149, v153, v157
    v_mfma_f32_16x16x32_bf16 v[132:135], v[76:79], v[16:19], v[132:135]
    v_cvt_pk_bf16_f32 v150, v154, v158
    v_cvt_pk_bf16_f32 v151, v155, v159
    s_nop 1
    v_mfma_f32_16x16x32_bf16 v[104:107], v[48:51], v[148:151], v[104:107]
    v_mfma_f32_16x16x32_bf16 v[112:115], v[56:59], v[148:151], v[112:115]
    v_mfma_f32_16x16x32_bf16 v[108:111], v[52:55], v[148:151], v[108:111]
    v_mfma_f32_16x16x32_bf16 v[116:119], v[60:63], v[148:151], v[116:119]
    v_mfma_f32_16x16x32_bf16 v[128:131], v[80:83], v[148:151], v[128:131]
    s_nop 5
    v_cvt_pk_bf16_f32 v120, v104, v108
    v_cvt_pk_bf16_f32 v121, v105, v109
    v_mfma_f32_16x16x32_bf16 v[132:135], v[84:87], v[148:151], v[132:135]
    v_cvt_pk_bf16_f32 v122, v106, v110
    v_cvt_pk_bf16_f32 v123, v107, v111
    v_cvt_pk_bf16_f32 v124, v112, v116
    v_cvt_pk_bf16_f32 v125, v113, v117
    v_cvt_pk_bf16_f32 v126, v114, v118
    v_cvt_pk_bf16_f32 v127, v115, v119
    ds_write_b128 v5, v[120:123] offset:0
    ds_write_b128 v5, v[124:127] offset:1584
    v_cvt_pk_bf16_f32 v88, v128, v132
    v_cvt_pk_bf16_f32 v89, v129, v133
    v_cvt_pk_bf16_f32 v90, v130, v134
    v_cvt_pk_bf16_f32 v91, v131, v135
    s_mov_b32 exec_lo, 0xffffffff
    s_mov_b32 exec_hi, 0x0
    ds_write_b128 v6, v[88:91] offset:0
    s_mov_b64 exec, -1
    s_branch A_p3_skip
A_p3sp:
    s_setprio 2
    s_mov_b32 exec_lo, 0x3fff3fff
    s_mov_b32 exec_hi, 0x3fff3fff
    v_xor_b32 v17, 0x80000000, v17
    v_xor_b32 v18, v156, v18
    ds_write_b32 v150, v16 offset:0
    ds_write_b32 v151, v17 offset:12
    ds_write_b32 v152, v18
    v_xor_b32 v21, 0x80000000, v21
    v_xor_b32 v22, v156, v22
    ds_write_b32 v150, v20 offset:4
    ds_write_b32 v151, v21 offset:8
    ds_write_b32 v153, v22
    v_xor_b32 v25, 0x80000000, v25
    v_xor_b32 v26, v156, v26
    ds_write_b32 v150, v24 offset:8
    ds_write_b32 v151, v25 offset:4
    ds_write_b32 v154, v26
    v_xor_b32 v29, 0x80000000, v29
    v_xor_b32 v30, v156, v30
    ds_write_b32 v150, v28 offset:12
    ds_write_b32 v151, v29 offset:0
    ds_write_b32 v155, v30
    ds_read_b128 v[136:139], v148
    ds_read_b128 v[140:143], v148 offset:1680
    ds_read_b128 v[144:147], v149
    s_mov_b64 exec, -1
    s_waitcnt lgkmcnt(2)
    v_mfma_f32_16x16x32_bf16 v[104:107], v[136:139], v[8:11], 0
    v_mfma_f32_16x16x32_bf16 v[108:111], v[136:139], v[12:15], 0
    s_waitcnt lgkmcnt(1)
    v_mfma_f32_16x16x32_bf16 v[112:115], v[140:143], v[8:11], 0
    s_nop 4
    v_mul_f32 v20, v104, v88
    v_mul_f32 v24, v104, v92
    v_mfma_f32_16x16x32_bf16 v[116:119], v[140:143], v[12:15], 0
    v_mul_f32 v21, v105, v89
    v_mul_f32 v25, v105, v93
    s_waitcnt lgkmcnt(0)
    v_mfma_f32_16x16x32_bf16 v[120:123], v[144:147], v[8:11], 0
    v_mul_f32 v22, v106, v90
    v_mul_f32 v26, v106, v94
    v_mul_f32 v23, v107, v91
    v_mul_f32 v27, v107, v95
    v_mfma_f32_16x16x32_bf16 v[124:127], v[144:147], v[12:15], 0
    v_fma_f32 v20, -v108, v92, v20
    v_fmac_f32 v24, v108, v88
    v_fma_f32 v21, -v109, v93, v21
    v_fmac_f32 v25, v109, v89
    v_fma_f32 v22, -v110, v94, v22
    v_fmac_f32 v26, v110, v90
    v_fma_f32 v23, -v111, v95, v23
    v_fmac_f32 v27, v111, v91
    v_mul_f32 v152, v112, v88
    v_mul_f32 v156, v112, v92
    v_mul_f32 v153, v113, v89
    v_mul_f32 v157, v113, v93
    v_mul_f32 v154, v114, v90
    v_mul_f32 v158, v114, v94
    v_mul_f32 v155, v115, v91
    v_mul_f32 v159, v115, v95
    v_cvt_pk_bf16_f32 v16, v20, v24
    v_cvt_pk_bf16_f32 v17, v21, v25
    v_cvt_pk_bf16_f32 v18, v22, v26
    v_cvt_pk_bf16_f32 v19, v23, v27
    v_fma_f32 v152, -v116, v92, v152
    v_fmac_f32 v156, v116, v88
    v_fma_f32 v153, -v117, v93, v153
    v_fmac_f32 v157, v117, v89
    v_fma_f32 v154, -v118, v94, v154
    v_fmac_f32 v158, v118, v90
    v_fma_f32 v155, -v119, v95, v155
    v_fmac_f32 v159, v119, v91
    v_mfma_f32_16x16x32_bf16 v[128:131], v[64:67], v[16:19], 0
    v_cvt_pk_bf16_f32 v148, v152, v156
    v_cvt_pk_bf16_f32 v149, v153, v157
    v_mfma_f32_16x16x32_bf16 v[132:135], v[68:71], v[16:19], 0
    v_cvt_pk_bf16_f32 v150, v154, v158
    v_cvt_pk_bf16_f32 v151, v155, v159
    v_mul_f32 v140, v120, v96
    v_mul_f32 v144, v120, v100
    v_mul_f32 v141, v121, v97
    v_mul_f32 v145, v121, v101
    v_mul_f32 v142, v122, v98
    v_mul_f32 v146, v122, v102
    v_mul_f32 v143, v123, v99
    v_mul_f32 v147, v123, v103
    v_mfma_f32_16x16x32_bf16 v[104:107], v[40:43], v[16:19], 0
    v_fma_f32 v140, -v124, v100, v140
    v_fmac_f32 v144, v124, v96
    v_mfma_f32_16x16x32_bf16 v[112:115], v[40:43], v[148:151], 0
    v_fma_f32 v141, -v125, v101, v141
    v_fmac_f32 v145, v125, v97
    v_mfma_f32_16x16x32_bf16 v[108:111], v[44:47], v[16:19], 0
    v_fma_f32 v142, -v126, v102, v142
    v_fmac_f32 v146, v126, v98
    v_mfma_f32_16x16x32_bf16 v[116:119], v[44:47], v[148:151], 0
    v_fma_f32 v143, -v127, v103, v143
    v_fmac_f32 v147, v127, v99
    v_mfma_f32_16x16x32_bf16 v[128:131], v[72:75], v[148:151], v[128:131]
    v_cvt_pk_bf16_f32 v136, v140, v144
    v_cvt_pk_bf16_f32 v137, v141, v145
    v_mfma_f32_16x16x32_bf16 v[132:135], v[76:79], v[148:151], v[132:135]
    v_cvt_pk_bf16_f32 v138, v142, v146
    v_cvt_pk_bf16_f32 v139, v143, v147
    s_nop 1
    v_mfma_f32_16x16x32_bf16 v[104:107], v[48:51], v[136:139], v[104:107]
    v_mfma_f32_16x16x32_bf16 v[112:115], v[56:59], v[136:139], v[112:115]
    v_mfma_f32_16x16x32_bf16 v[108:111], v[52:55], v[136:139], v[108:111]
    v_mfma_f32_16x16x32_bf16 v[116:119], v[60:63], v[136:139], v[116:119]
    v_mfma_f32_16x16x32_bf16 v[128:131], v[80:83], v[136:139], v[128:131]
    s_nop 5
    v_cvt_pk_bf16_f32 v120, v104, v108
    v_cvt_pk_bf16_f32 v121, v105, v109
    v_mfma_f32_16x16x32_bf16 v[132:135], v[84:87], v[136:139], v[132:135]
    v_cvt_pk_bf16_f32 v122, v106, v110
    v_cvt_pk_bf16_f32 v123, v107, v111
    v_cvt_pk_bf16_f32 v124, v112, v116
    v_cvt_pk_bf16_f32 v125, v113, v117
    v_cvt_pk_bf16_f32 v126, v114, v118
    v_cvt_pk_bf16_f32 v127, v115, v119
    ds_write_b128 v5, v[120:123] offset:0
    ds_write_b128 v5, v[124:127] offset:1584
    v_cvt_pk_bf16_f32 v88, v128, v132
    v_cvt_pk_bf16_f32 v89, v129, v133
    v_cvt_pk_bf16_f32 v90, v130, v134
    v_cvt_pk_bf16_f32 v91, v131, v135
    s_mov_b32 exec_lo, 0xffffffff
    s_mov_b32 exec_hi, 0x0
    ds_write_b128 v6, v[88:91] offset:0
    s_mov_b64 exec, -1
A_p3_skip:
    s_waitcnt lgkmcnt(0)
    s_barrier
    s_cmp_lt_u32 s28, 7
    s_cbranch_scc1 A_end
    ds_read_b32 v40, v164 offset:0
    ds_read_b32 v41, v164 offset:1584
    ds_read_b32 v42, v164 offset:3168
    ds_read_b32 v43, v164 offset:4752
    ds_read_b32 v44, v164 offset:96
    ds_read_b32 v45, v164 offset:1680
    ds_read_b32 v46, v164 offset:3264
    ds_read_b32 v47, v164 offset:4848
    ds_read_b32 v48, v164 offset:192
    ds_read_b32 v49, v164 offset:1776
    ds_read_b32 v50, v164 offset:3360
    ds_read_b32 v51, v164 offset:4944
    ds_read_b32 v52, v164 offset:288
    ds_read_b32 v53, v164 offset:1872
    ds_read_b32 v54, v164 offset:3456
    ds_read_b32 v55, v164 offset:5040
    s_waitcnt lgkmcnt(12)
    v_mfma_f32_16x16x32_bf16 v[104:107], v[32:35], v[40:43], 0
    v_mfma_f32_16x16x32_bf16 v[108:111], v[36:39], v[40:43], 0
    s_waitcnt lgkmcnt(8)
    v_mfma_f32_16x16x32_bf16 v[112:115], v[32:35], v[44:47], 0
    v_mfma_f32_16x16x32_bf16 v[116:119], v[36:39], v[44:47], 0
    s_nop 4
    v_cvt_pk_bf16_f32 v16, v104, v108
    v_cvt_pk_bf16_f32 v20, v105, v109
    s_waitcnt lgkmcnt(4)
    v_mfma_f32_16x16x32_bf16 v[120:123], v[32:35], v[48:51], 0
    v_cvt_pk_bf16_f32 v24, v106, v110
    v_cvt_pk_bf16_f32 v28, v107, v111
    v_mfma_f32_16x16x32_bf16 v[124:127], v[36:39], v[48:51], 0
    v_cvt_pk_bf16_f32 v17, v112, v116
    v_cvt_pk_bf16_f32 v21, v113, v117
    s_waitcnt lgkmcnt(0)
    v_mfma_f32_16x16x32_bf16 v[128:131], v[32:35], v[52:55], 0
    v_cvt_pk_bf16_f32 v25, v114, v118
    v_cvt_pk_bf16_f32 v29, v115, v119
    v_mfma_f32_16x16x32_bf16 v[132:135], v[36:39], v[52:55], 0
    s_nop 0
    v_cvt_pk_bf16_f32 v18, v120, v124
    v_cvt_pk_bf16_f32 v22, v121, v125
    v_cvt_pk_bf16_f32 v26, v122, v126
    v_cvt_pk_bf16_f32 v30, v123, v127
    s_nop 2
    v_cvt_pk_bf16_f32 v19, v128, v132
    v_cvt_pk_bf16_f32 v23, v129, v133
    v_cvt_pk_bf16_f32 v27, v130, v134
    buffer_store_dwordx4 v[16:19], v165, s[20:23], s54 offen nt
    v_cvt_pk_bf16_f32 v31, v131, v135
    buffer_store_dwordx4 v[20:23], v165, s[20:23], s55 offen nt
    buffer_store_dwordx4 v[24:27], v165, s[20:23], s56 offen nt
    buffer_store_dwordx4 v[28:31], v165, s[20:23], s57 offen nt
    s_cmp_lg_u32 s29, 0
    s_nop 0
    s_cbranch_scc1 A_end
    s_cmp_lg_u32 s28, 7
    s_cbranch_scc1 A_end
    v_mov_b32 v4, s30
    v_mov_b32 v5, 0
    s_mov_b32 exec_lo, 0x1
    s_mov_b32 exec_hi, 0x0
    buffer_store_dword v4, v5, s[8:11], 0 offen
    s_mov_b64 exec, -1
A_end:
    s_endpgm
B_body:
    s_mov_b64 exec, -1
    s_waitcnt lgkmcnt(0)
    s_lshr_b32 s35, s28, 1
    s_min_u32 s35, s35, 4
    s_add_u32 s51, s58, s35
    s_lshl_b32 s35, s51, 1
    s_and_b32 s35, s35, 0xfffffffc
    s_load_dword s12, s[88:89], s35
    s_load_dword s13, s[90:91], s35
    s_mov_b32 s8, s72
    s_and_b32 s9, s73, 0xffff
    s_mov_b32 s10, 268435456
    s_mov_b32 s11, 0x00020000
    s_mov_b32 s20, s92
    s_and_b32 s21, s93, 0xffff
    s_mov_b32 s22, 5242880
    s_mov_b32 s23, 0x00020000
    s_mul_i32 s57, s32, 20608
    s_add_u32 s57, s57, 12582912
    s_mov_b64 s[98:99], 0
    s_mov_b64 s[100:101], -1
    v_lshlrev_b32 v4, 2, v1
    v_add_u32 v4, 141120, v4
    v_mov_b32 v5, 0
    ds_write_b32 v4, v5
    s_cmp_gt_u32 s28, 9
    s_cbranch_scc1 B_upath
    s_lshr_b32 s38, s28, 1
    s_lshl_b32 s38, s38, 8
    s_add_u32 s38, s38, 133440
    v_and_b32 v11, 127, v0
    v_lshl_add_u32 v11, v11, 1, s38
    v_mov_b32 v16, 0
    v_mov_b32 v17, 0
    v_mov_b32 v18, 0
    v_mov_b32 v19, 0
    v_mov_b32 v20, 0
    v_mov_b32 v21, 0
    v_mov_b32 v28, 0
    v_mov_b32 v29, 0
    v_mov_b32 v30, 0
    v_mov_b32 v31, 0
    v_lshlrev_b32 v6, 4, v0
    v_add_u32 v6, 92160, v6
    ds_write_b128 v6, v[28:31]
    v_cmp_gt_u32 vcc, 500, v0
    s_nop 1
    s_and_saveexec_b64 s[52:53], vcc
    ds_write_b128 v6, v[28:31] offset:10240
    s_mov_b64 exec, s[52:53]
    v_mul_u32_u24 v6, 2185, v0
    v_lshrrev_b32 v6, 16, v6
    v_mul_u32_u24 v7, 4128, v6
    v_lshl_add_u32 v7, v0, 4, v7
    v_add_u32 v7, 69120, v7
    v_cmp_gt_u32 vcc, 150, v0
    s_nop 1
    s_and_saveexec_b64 s[52:53], vcc
    ds_write_b128 v7, v[28:31]
    s_mov_b64 exec, s[52:53]
    s_lshl_b32 s35, s28, 2
    s_add_u32 s35, s35, 141120
    v_mov_b32 v165, s35
    v_lshrrev_b32 v150, 1, v3
    v_and_b32 v151, 1, v3
    v_lshlrev_b32 v150, 8, v150
    v_cmp_eq_u32 s[42:43], 2, v3
    v_lshl_add_u32 v150, v151, 3, v150
    v_lshlrev_b32 v151, 8, v3
    v_cmp_eq_u32 s[44:45], 3, v3
    v_lshl_add_u32 v151, v2, 4, v151
    v_and_b32 v154, 1, v2
    v_subrev_u32 v152, 240, v151
    v_xor_b32 v154, 1, v154
    v_cndmask_b32 v151, v151, v152, s[42:43]
    v_lshlrev_b32 v152, 1, v2
    v_mul_u32_u24 v154, 384, v154
    v_sub_u32 v152, 2562, v152
    s_xor_b32 s37, s28, 1
    v_add_u32 v153, 256, v152
    s_lshr_b32 s36, s28, 1
    v_cndmask_b32 v152, v152, v153, s[44:45]
    v_and_b32 v153, 14, v2
    s_mul_i32 s36, s36, 3648
    v_lshl_add_u32 v153, v3, 6, v153
    s_add_u32 s36, s36, 92160
    v_sub_u32 v153, 3072, v153
    v_bfe_u32 v62, v1, 2, 2
    v_add_u32 v153, v153, v154
    v_add_u32 v154, -1, v3
    v_and_b32 v63, 3, v1
    v_cmp_gt_u32 s[46:47], 2, v154
    s_add_u32 s38, s36, 1082
    v_and_b32 v58, 1, v2
    s_add_u32 s39, s36, 562
    s_min_u32 s14, s28, 4
    v_cndmask_b32 v152, v152, v153, s[46:47]
    v_mov_b32 v155, 32
    v_lshl_add_u32 v64, v62, 1, v63
    s_mul_i32 s15, s14, 4608
    v_mul_u32_u24 v59, 1214, v58
    s_mul_i32 s16, s14, 3648
    v_cndmask_b32 v155, v155, 16, s[46:47]
    v_add_u32 v152, s36, v152
    v_lshlrev_b32 v57, 4, v3
    v_mul_u32_u24 v58, 190, v58
    v_lshlrev_b32 v61, 2, v2
    v_lshrrev_b32 v65, 2, v64
    v_lshl_add_u32 v67, v3, 3, v62
    s_add_u32 s15, s15, 69120
    s_add_u32 s16, s16, 92160
    v_sub_u32 v153, v152, v155
    v_lshlrev_b32 v56, 5, v2
    v_add3_u32 v59, v59, v57, s16
    v_lshlrev_b32 v60, 1, v2
    v_add3_u32 v58, v58, v57, s16
    v_sub_u32 v61, v57, v61
    v_mul_u32_u24 v65, 40, v65
    v_and_b32 v64, 3, v64
    v_mul_u32_u24 v67, 40, v67
    v_lshl_add_u32 v150, v2, 4, v150
    v_sub_u32 v154, v153, v155
    v_lshl_add_u32 v56, v3, 4, v56
    v_sub_u32 v59, v59, v60
    v_sub_u32 v58, v58, v60
    v_add_u32 v61, s16, v61
    v_lshl_add_u32 v64, v64, 3, v65
    v_mul_u32_u24 v66, 160, v3
    v_lshl_add_u32 v67, v63, 3, v67
    v_mul_u32_u24 v68, 164864, v3
    s_mul_i32 s35, s28, 4608
    s_mul_i32 s37, s37, 4608
    s_add_u32 s17, s16, 2436
    s_mul_i32 s18, s14, 12920
    v_lshl_add_u32 v148, v1, 4, s35
    v_lshl_add_u32 v149, v1, 4, s37
    v_sub_u32 v150, s38, v150
    v_sub_u32 v151, s39, v151
    v_sub_u32 v155, v154, v155
    v_add_u32 v157, s15, v56
    v_add_u32 v158, 96, v59
    v_add_u32 v160, 2912, v58
    v_add_u32 v159, 2432, v61
    v_mov_b32 v164, s17
    v_add3_u32 v161, v64, v66, s18
    v_add_u32 v162, s18, v67
    v_lshl_add_u32 v163, v2, 4, v68
    s_cmp_gt_u32 s28, 5
    s_nop 0
    s_cbranch_scc1 B_b0k
    s_waitcnt vmcnt(0)
B_b0k:
    s_waitcnt lgkmcnt(0)
    s_barrier
    s_setprio 2
    ds_read_u16_d16_hi v16, v11 offset:0
    ds_read_u16_d16_hi v17, v11 offset:1280
    ds_read_u16_d16_hi v18, v11 offset:2560
    ds_read_u16_d16_hi v19, v11 offset:3840
    ds_read_u16_d16_hi v20, v11 offset:5120
    ds_read_u16_d16_hi v21, v11 offset:6400
    s_bitcmp1_b32 s51, 0
    s_cselect_b32 s35, 0, 16
    s_lshl_b32 s12, s12, s35
    s_lshl_b32 s13, s13, s35
    s_and_b32 s12, s12, 0xffff0000
    s_and_b32 s13, s13, 0xffff0000
    s_mul_i32 m0, s28, 4608
    v_mov_b32 v6, s12
    s_mov_b32 s36, 0x3fb8aa3b
    v_mul_f32 v4, 0x3fb8aa3b, v6
    s_mul_i32 s37, s28, 4608
    v_fma_f32 v5, v6, s36, -v4
    v_exp_f32 v4, v4
    v_fmac_f32 v5, 0x32a57060, v6
    v_min_u32 v6, 8, v2
    v_mul_f32 v5, 0x3f317218, v5
    v_mul_u32_u24 v6, 288, v6
    v_fmac_f32 v4, v4, v5
    v_mul_u32_u24 v5, 288, v2
    v_cvt_pk_bf16_f32 v4, v4, v4
    v_lshl_add_u32 v7, v3, 4, s37
    v_and_b32 v4, 0xffff0000, v4
    v_add_u32 v8, v5, v7
    s_waitcnt lgkmcnt(4)
    v_mul_f32 v17, v4, v17
    v_mul_f32 v16, v4, v16
    v_mul_f32 v17, 0.15915494, v17
    v_mul_f32 v16, 0x3fb8aa3b, v16
    v_mul_f32 v59, 0x41000000, v17
    v_mul_f32 v56, 0x41000000, v16
    v_fract_f32 v59, v59
    v_exp_f32 v56, v56
    v_cos_f32 v34, v59
    v_sin_f32 v35, v59
    v_mul_f32 v34, v56, v34
    v_mul_f32 v60, 0x3f800000, v17
    v_mul_f32 v35, v56, v35
    v_mul_f32 v57, 0x3f800000, v16
    v_pk_mul_f32 v[112:113], v[34:35], v[34:35] op_sel:[0,0] op_sel_hi:[0,1]
    v_fract_f32 v60, v60
    s_waitcnt lgkmcnt(3)
    v_mul_f32 v18, v4, v18
    v_pk_fma_f32 v[44:45], v[34:35], v[34:35], v[112:113] op_sel:[1,1,0] op_sel_hi:[1,0,1] neg_lo:[1,0,0]
    s_waitcnt lgkmcnt(2)
    v_mul_f32 v19, v4, v19
    v_exp_f32 v57, v57
    v_pk_mul_f32 v[116:117], v[34:35], v[44:45] op_sel:[0,0] op_sel_hi:[0,1]
    v_pk_mul_f32 v[118:119], v[44:45], v[44:45] op_sel:[0,0] op_sel_hi:[0,1]
    v_cos_f32 v32, v60
    v_pk_fma_f32 v[126:127], v[34:35], v[44:45], v[116:117] op_sel:[1,1,0] op_sel_hi:[1,0,1] neg_lo:[1,0,0]
    v_pk_fma_f32 v[128:129], v[44:45], v[44:45], v[118:119] op_sel:[1,1,0] op_sel_hi:[1,0,1] neg_lo:[1,0,0]
    v_sin_f32 v33, v60
    v_pk_mul_f32 v[120:121], v[126:127], v[44:45] op_sel:[0,0] op_sel_hi:[0,1]
    v_pk_mul_f32 v[122:123], v[128:129], v[44:45] op_sel:[0,0] op_sel_hi:[0,1]
    s_waitcnt lgkmcnt(0)
    v_pk_mul_f32 v[110:111], v[20:21], v[18:19] op_sel:[0,0] op_sel_hi:[0,1]
    v_pk_fma_f32 v[130:131], v[126:127], v[44:45], v[120:121] op_sel:[1,1,0] op_sel_hi:[1,0,1] neg_lo:[1,0,0]
    v_pk_fma_f32 v[132:133], v[128:129], v[44:45], v[122:123] op_sel:[1,1,0] op_sel_hi:[1,0,1] neg_lo:[1,0,0]
    v_pk_fma_f32 v[42:43], v[20:21], v[18:19], v[110:111] op_sel:[1,1,0] op_sel_hi:[1,0,1] neg_lo:[1,0,0]
    v_pk_mul_f32 v[108:109], v[130:131], v[44:45] op_sel:[0,0] op_sel_hi:[0,1]
    v_mul_f32 v32, v57, v32
    v_mul_f32 v33, v57, v33
    v_pk_fma_f32 v[134:135], v[130:131], v[44:45], v[108:109] op_sel:[1,1,0] op_sel_hi:[1,0,1] neg_lo:[1,0,0]
    v_pk_mul_f32 v[110:111], v[132:133], v[44:45] op_sel:[0,0] op_sel_hi:[0,1]
    v_pk_mul_f32 v[114:115], v[32:33], v[32:33] op_sel:[0,0] op_sel_hi:[0,1]
    v_pk_mul_f32 v[112:113], v[134:135], v[44:45] op_sel:[0,0] op_sel_hi:[0,1]
    v_pk_fma_f32 v[136:137], v[132:133], v[44:45], v[110:111] op_sel:[1,1,0] op_sel_hi:[1,0,1] neg_lo:[1,0,0]
    v_pk_fma_f32 v[38:39], v[32:33], v[32:33], v[114:115] op_sel:[1,1,0] op_sel_hi:[1,0,1] neg_lo:[1,0,0]
    v_pk_fma_f32 v[138:139], v[134:135], v[44:45], v[112:113] op_sel:[1,1,0] op_sel_hi:[1,0,1] neg_lo:[1,0,0]
    v_pk_mul_f32 v[114:115], v[136:137], v[44:45] op_sel:[0,0] op_sel_hi:[0,1]
    v_pk_mul_f32 v[110:111], v[42:43], v[32:33] op_sel:[0,0] op_sel_hi:[0,1]
    v_pk_mul_f32 v[116:117], v[138:139], v[44:45] op_sel:[0,0] op_sel_hi:[0,1]
    v_pk_fma_f32 v[140:141], v[136:137], v[44:45], v[114:115] op_sel:[1,1,0] op_sel_hi:[1,0,1] neg_lo:[1,0,0]
    v_cvt_pk_bf16_f32 v49, v128, -v129
    v_pk_fma_f32 v[142:143], v[138:139], v[44:45], v[116:117] op_sel:[1,1,0] op_sel_hi:[1,0,1] neg_lo:[1,0,0]
    v_pk_mul_f32 v[118:119], v[140:141], v[44:45] op_sel:[0,0] op_sel_hi:[0,1]
    v_pk_fma_f32 v[128:129], v[42:43], v[32:33], v[110:111] op_sel:[1,1,0] op_sel_hi:[1,0,1] neg_lo:[1,0,0]
    v_pk_mul_f32 v[120:121], v[142:143], v[44:45] op_sel:[0,0] op_sel_hi:[0,1]
    v_pk_fma_f32 v[144:145], v[140:141], v[44:45], v[118:119] op_sel:[1,1,0] op_sel_hi:[1,0,1] neg_lo:[1,0,0]
    v_mul_f32 v61, 0x43000000, v17
    v_pk_fma_f32 v[146:147], v[142:143], v[44:45], v[120:121] op_sel:[1,1,0] op_sel_hi:[1,0,1] neg_lo:[1,0,0]
    v_pk_mul_f32 v[116:117], v[42:43], v[38:39] op_sel:[0,0] op_sel_hi:[0,1]
    v_pk_mul_f32 v[118:119], v[128:129], v[38:39] op_sel:[0,0] op_sel_hi:[0,1]
    v_mul_f32 v58, 0x43000000, v16
    v_fract_f32 v61, v61
    v_cvt_pk_bf16_f32 v52, v134, -v135
    v_cvt_pk_bf16_f32 v53, v136, -v137
    v_pk_mul_f32 v[108:109], v[146:147], v[44:45] op_sel:[0,0] op_sel_hi:[0,1]
    v_pk_fma_f32 v[134:135], v[42:43], v[38:39], v[116:117] op_sel:[1,1,0] op_sel_hi:[1,0,1] neg_lo:[1,0,0]
    v_pk_fma_f32 v[136:137], v[128:129], v[38:39], v[118:119] op_sel:[1,1,0] op_sel_hi:[1,0,1] neg_lo:[1,0,0]
    v_cvt_pk_bf16_f32 v48, v126, -v127
    v_exp_f32 v58, v58
    v_cos_f32 v36, v61
    v_sin_f32 v37, v61
    v_cvt_pk_bf16_f32 v46, v34, -v35
    v_cvt_pk_bf16_f32 v47, v44, -v45
    v_pk_mul_f32 v[122:123], v[144:145], v[44:45] op_sel:[0,0] op_sel_hi:[0,1]
    v_pk_fma_f32 v[126:127], v[146:147], v[44:45], v[108:109] op_sel:[1,1,0] op_sel_hi:[1,0,1] neg_lo:[1,0,0]
    v_pk_mul_f32 v[108:109], v[134:135], v[38:39] op_sel:[0,0] op_sel_hi:[0,1]
    v_pk_mul_f32 v[110:111], v[136:137], v[38:39] op_sel:[0,0] op_sel_hi:[0,1]
    ds_write_addtid_b32 v46 offset:288
    ds_write_addtid_b32 v47 offset:576
    v_cvt_pk_bf16_f32 v46, v142, -v143
    v_cvt_pk_bf16_f32 v47, v144, -v145
    v_pk_fma_f32 v[124:125], v[144:145], v[44:45], v[122:123] op_sel:[1,1,0] op_sel_hi:[1,0,1] neg_lo:[1,0,0]
    v_mul_f32 v36, v58, v36
    v_mul_f32 v37, v58, v37
    v_pk_fma_f32 v[142:143], v[134:135], v[38:39], v[108:109] op_sel:[1,1,0] op_sel_hi:[1,0,1] neg_lo:[1,0,0]
    v_pk_fma_f32 v[144:145], v[136:137], v[38:39], v[110:111] op_sel:[1,1,0] op_sel_hi:[1,0,1] neg_lo:[1,0,0]
    v_cvt_pk_bf16_f32 v50, v130, -v131
    v_pk_mul_f32 v[114:115], v[128:129], v[36:37] op_sel:[0,0] op_sel_hi:[0,1]
    v_pk_mul_f32 v[116:117], v[142:143], v[38:39] op_sel:[0,0] op_sel_hi:[0,1]
    v_pk_mul_f32 v[118:119], v[144:145], v[38:39] op_sel:[0,0] op_sel_hi:[0,1]
    ds_write_addtid_b32 v50 offset:1440
    v_cvt_pk_bf16_f32 v51, v132, -v133
    ds_write_addtid_b32 v52 offset:2016
    v_cvt_pk_bf16_f32 v50, v126, -v127
    v_cvt_pk_bf16_f32 v52, v128, v129
    v_pk_mul_f32 v[112:113], v[42:43], v[36:37] op_sel:[0,0] op_sel_hi:[0,1]
    v_pk_fma_f32 v[132:133], v[128:129], v[36:37], v[114:115] op_sel:[1,1,0] op_sel_hi:[1,0,1] neg_lo:[1,0,0]
    v_pk_mul_f32 v[120:121], v[134:135], v[36:37] op_sel:[0,0] op_sel_hi:[0,1]
    v_pk_mul_f32 v[122:123], v[136:137], v[36:37] op_sel:[0,0] op_sel_hi:[0,1]
    v_pk_fma_f32 v[126:127], v[142:143], v[38:39], v[116:117] op_sel:[1,1,0] op_sel_hi:[1,0,1] neg_lo:[1,0,0]
    v_pk_fma_f32 v[128:129], v[144:145], v[38:39], v[118:119] op_sel:[1,1,0] op_sel_hi:[1,0,1] neg_lo:[1,0,0]
    v_cvt_pk_bf16_f32 v54, v138, -v139
    v_cvt_pk_bf16_f32 v55, v140, -v141
    v_pk_fma_f32 v[130:131], v[42:43], v[36:37], v[112:113] op_sel:[1,1,0] op_sel_hi:[1,0,1] neg_lo:[1,0,0]
    v_pk_fma_f32 v[138:139], v[134:135], v[36:37], v[120:121] op_sel:[1,1,0] op_sel_hi:[1,0,1] neg_lo:[1,0,0]
    v_pk_fma_f32 v[140:141], v[136:137], v[36:37], v[122:123] op_sel:[1,1,0] op_sel_hi:[1,0,1] neg_lo:[1,0,0]
    v_add_u32 v9, v6, v7
    ds_write_addtid_b32 v48 offset:864
    ds_write_addtid_b32 v49 offset:1152
    v_pk_mul_f32 v[112:113], v[142:143], v[36:37] op_sel:[0,0] op_sel_hi:[0,1]
    v_pk_mul_f32 v[114:115], v[144:145], v[36:37] op_sel:[0,0] op_sel_hi:[0,1]
    v_pk_mul_f32 v[120:121], v[126:127], v[36:37] op_sel:[0,0] op_sel_hi:[0,1]
    v_pk_mul_f32 v[122:123], v[128:129], v[36:37] op_sel:[0,0] op_sel_hi:[0,1]
    v_mov_b32 v7, 0x3f80
    v_cvt_pk_bf16_f32 v48, v146, -v147
    v_cvt_pk_bf16_f32 v49, v124, -v125
    ds_write_addtid_b32 v53 offset:2304
    ds_write_addtid_b32 v54 offset:2592
    ds_write_addtid_b32 v51 offset:1728
    ds_write_addtid_b32 v55 offset:2880
    ds_write_addtid_b32 v46 offset:3168
    v_cvt_pk_bf16_f32 v53, v130, v131
    v_cvt_pk_bf16_f32 v54, v132, v133
    ds_write_addtid_b32 v7 offset:0
    ds_write_addtid_b32 v47 offset:3456
    ds_write_addtid_b32 v48 offset:3744
    ds_write_addtid_b32 v49 offset:4032
    ds_write_addtid_b32 v50 offset:4320
    v_cvt_pk_bf16_f32 v51, v42, v43
    v_cvt_pk_bf16_f32 v55, v134, v135
    v_cvt_pk_bf16_f32 v46, v136, v137
    v_pk_fma_f32 v[146:147], v[142:143], v[36:37], v[112:113] op_sel:[1,1,0] op_sel_hi:[1,0,1] neg_lo:[1,0,0]
    v_pk_fma_f32 v[124:125], v[144:145], v[36:37], v[114:115] op_sel:[1,1,0] op_sel_hi:[1,0,1] neg_lo:[1,0,0]
    v_pk_fma_f32 v[130:131], v[126:127], v[36:37], v[120:121] op_sel:[1,1,0] op_sel_hi:[1,0,1] neg_lo:[1,0,0]
    v_pk_fma_f32 v[132:133], v[128:129], v[36:37], v[122:123] op_sel:[1,1,0] op_sel_hi:[1,0,1] neg_lo:[1,0,0]
    ds_read_b128 v[76:79], v8 offset:0
    ds_read_b128 v[80:83], v8 offset:64
    ds_read_b128 v[84:87], v8 offset:128
    ds_read_b128 v[88:91], v8 offset:192
    ds_write_addtid_b32 v51 offset:0
    ds_write_addtid_b32 v52 offset:288
    ds_write_addtid_b32 v53 offset:2304
    ds_write_addtid_b32 v54 offset:2592
    ds_write_addtid_b32 v55 offset:576
    ds_write_addtid_b32 v46 offset:864
    v_cvt_pk_bf16_f32 v47, v138, v139
    v_cvt_pk_bf16_f32 v48, v140, v141
    v_cvt_pk_bf16_f32 v49, v142, v143
    v_cvt_pk_bf16_f32 v50, v144, v145
    v_cvt_pk_bf16_f32 v51, v146, v147
    v_cvt_pk_bf16_f32 v52, v124, v125
    v_cvt_pk_bf16_f32 v53, v126, v127
    v_cvt_pk_bf16_f32 v54, v128, v129
    v_cvt_pk_bf16_f32 v55, v130, v131
    v_cvt_pk_bf16_f32 v46, v132, v133
    v_pk_mul_f32 v[108:109], v[36:37], v[36:37] op_sel:[0,0] op_sel_hi:[0,1]
    ds_write_addtid_b32 v47 offset:2880
    ds_write_addtid_b32 v48 offset:3168
    ds_write_addtid_b32 v49 offset:1152
    ds_write_addtid_b32 v50 offset:1440
    ds_write_addtid_b32 v51 offset:3456
    ds_write_addtid_b32 v52 offset:3744
    ds_write_addtid_b32 v53 offset:1728
    ds_write_addtid_b32 v54 offset:2016
    ds_write_addtid_b32 v55 offset:4032
    ds_write_addtid_b32 v46 offset:4320
    v_pk_fma_f32 v[40:41], v[36:37], v[36:37], v[108:109] op_sel:[1,1,0] op_sel_hi:[1,0,1] neg_lo:[1,0,0]
    ds_read_b128 v[92:95], v8 offset:0
    ds_read_b128 v[96:99], v8 offset:64
    ds_read_b128 v[100:103], v8 offset:128
    ds_read_b128 v[104:107], v8 offset:192
    v_pk_mul_f32 v[110:111], v[42:43], v[40:41] op_sel:[0,0] op_sel_hi:[0,1]
    s_waitcnt lgkmcnt(3)
    v_mfma_f32_16x16x32_bf16 v[64:67], v[92:95], v[76:79], 0
    v_pk_fma_f32 v[56:57], v[42:43], v[40:41], v[110:111] op_sel:[1,1,0] op_sel_hi:[1,0,1] neg_lo:[1,0,0]
    s_waitcnt lgkmcnt(2)
    v_mfma_f32_16x16x32_bf16 v[64:67], v[96:99], v[80:83], v[64:67]
    v_pk_mul_f32 v[112:113], v[56:57], v[38:39] op_sel:[0,0] op_sel_hi:[0,1]
    v_pk_mul_f32 v[118:119], v[56:57], v[36:37] op_sel:[0,0] op_sel_hi:[0,1]
    v_cvt_pk_bf16_f32 v47, v56, v57
    v_pk_fma_f32 v[134:135], v[56:57], v[38:39], v[112:113] op_sel:[1,1,0] op_sel_hi:[1,0,1] neg_lo:[1,0,0]
    v_pk_fma_f32 v[58:59], v[56:57], v[36:37], v[118:119] op_sel:[1,1,0] op_sel_hi:[1,0,1] neg_lo:[1,0,0]
    ds_write_addtid_b32 v47 offset:0
    v_pk_mul_f32 v[114:115], v[134:135], v[38:39] op_sel:[0,0] op_sel_hi:[0,1]
    v_pk_mul_f32 v[110:111], v[58:59], v[34:35] op_sel:[0,0] op_sel_hi:[0,1]
    v_pk_mul_f32 v[120:121], v[134:135], v[36:37] op_sel:[0,0] op_sel_hi:[0,1]
    v_pk_fma_f32 v[136:137], v[134:135], v[38:39], v[114:115] op_sel:[1,1,0] op_sel_hi:[1,0,1] neg_lo:[1,0,0]
    v_pk_fma_f32 v[62:63], v[58:59], v[34:35], v[110:111] op_sel:[1,1,0] op_sel_hi:[1,0,1] neg_lo:[1,0,0]
    v_pk_fma_f32 v[140:141], v[134:135], v[36:37], v[120:121] op_sel:[1,1,0] op_sel_hi:[1,0,1] neg_lo:[1,0,0]
    v_pk_mul_f32 v[116:117], v[136:137], v[38:39] op_sel:[0,0] op_sel_hi:[0,1]
    v_pk_mul_f32 v[112:113], v[62:63], v[36:37] op_sel:[0,0] op_sel_hi:[0,1]
    v_pk_mul_f32 v[114:115], v[62:63], v[40:41] op_sel:[0,0] op_sel_hi:[0,1]
    v_pk_fma_f32 v[138:139], v[136:137], v[38:39], v[116:117] op_sel:[1,1,0] op_sel_hi:[1,0,1] neg_lo:[1,0,0]
    v_pk_fma_f32 v[144:145], v[62:63], v[36:37], v[112:113] op_sel:[1,1,0] op_sel_hi:[1,0,1] neg_lo:[1,0,0]
    v_pk_fma_f32 v[146:147], v[62:63], v[40:41], v[114:115] op_sel:[1,1,0] op_sel_hi:[1,0,1] neg_lo:[1,0,0]
    v_pk_mul_f32 v[108:109], v[138:139], v[36:37] op_sel:[0,0] op_sel_hi:[0,1]
    v_pk_mul_f32 v[122:123], v[136:137], v[36:37] op_sel:[0,0] op_sel_hi:[0,1]
    v_pk_mul_f32 v[110:111], v[146:147], v[40:41] op_sel:[0,0] op_sel_hi:[0,1]
    v_pk_fma_f32 v[142:143], v[138:139], v[36:37], v[108:109] op_sel:[1,1,0] op_sel_hi:[1,0,1] neg_lo:[1,0,0]
    v_pk_mul_f32 v[108:109], v[144:145], v[40:41] op_sel:[0,0] op_sel_hi:[0,1]
    v_cvt_pk_bf16_f32 v48, v134, v135
    v_pk_fma_f32 v[134:135], v[146:147], v[40:41], v[110:111] op_sel:[1,1,0] op_sel_hi:[1,0,1] neg_lo:[1,0,0]
    v_pk_fma_f32 v[132:133], v[144:145], v[40:41], v[108:109] op_sel:[1,1,0] op_sel_hi:[1,0,1] neg_lo:[1,0,0]
    v_pk_fma_f32 v[60:61], v[136:137], v[36:37], v[122:123] op_sel:[1,1,0] op_sel_hi:[1,0,1] neg_lo:[1,0,0]
    v_pk_mul_f32 v[114:115], v[134:135], v[40:41] op_sel:[0,0] op_sel_hi:[0,1]
    v_pk_mul_f32 v[112:113], v[132:133], v[40:41] op_sel:[0,0] op_sel_hi:[0,1]
    v_cvt_pk_bf16_f32 v49, v136, v137
    v_cvt_pk_bf16_f32 v50, v138, v139
    v_pk_mul_f32 v[116:117], v[60:61], v[36:37] op_sel:[0,0] op_sel_hi:[0,1]
    v_pk_mul_f32 v[118:119], v[60:61], v[40:41] op_sel:[0,0] op_sel_hi:[0,1]
    v_pk_fma_f32 v[136:137], v[132:133], v[40:41], v[112:113] op_sel:[1,1,0] op_sel_hi:[1,0,1] neg_lo:[1,0,0]
    v_pk_fma_f32 v[138:139], v[134:135], v[40:41], v[114:115] op_sel:[1,1,0] op_sel_hi:[1,0,1] neg_lo:[1,0,0]
    v_pk_fma_f32 v[124:125], v[60:61], v[36:37], v[116:117] op_sel:[1,1,0] op_sel_hi:[1,0,1] neg_lo:[1,0,0]
    v_pk_fma_f32 v[126:127], v[60:61], v[40:41], v[118:119] op_sel:[1,1,0] op_sel_hi:[1,0,1] neg_lo:[1,0,0]
    v_pk_mul_f32 v[116:117], v[136:137], v[40:41] op_sel:[0,0] op_sel_hi:[0,1]
    v_pk_mul_f32 v[118:119], v[138:139], v[40:41] op_sel:[0,0] op_sel_hi:[0,1]
    v_cvt_pk_bf16_f32 v52, v140, v141
    v_cvt_pk_bf16_f32 v54, v142, v143
    v_pk_mul_f32 v[120:121], v[124:125], v[40:41] op_sel:[0,0] op_sel_hi:[0,1]
    v_pk_mul_f32 v[122:123], v[126:127], v[40:41] op_sel:[0,0] op_sel_hi:[0,1]
    v_pk_fma_f32 v[140:141], v[136:137], v[40:41], v[116:117] op_sel:[1,1,0] op_sel_hi:[1,0,1] neg_lo:[1,0,0]
    v_pk_fma_f32 v[142:143], v[138:139], v[40:41], v[118:119] op_sel:[1,1,0] op_sel_hi:[1,0,1] neg_lo:[1,0,0]
    v_pk_fma_f32 v[128:129], v[124:125], v[40:41], v[120:121] op_sel:[1,1,0] op_sel_hi:[1,0,1] neg_lo:[1,0,0]
    v_pk_fma_f32 v[130:131], v[126:127], v[40:41], v[122:123] op_sel:[1,1,0] op_sel_hi:[1,0,1] neg_lo:[1,0,0]
    v_pk_mul_f32 v[120:121], v[140:141], v[40:41] op_sel:[0,0] op_sel_hi:[0,1]
    v_pk_mul_f32 v[122:123], v[142:143], v[40:41] op_sel:[0,0] op_sel_hi:[0,1]
    v_cvt_pk_bf16_f32 v46, v144, v145
    v_cvt_pk_bf16_f32 v47, v146, v147
    s_waitcnt lgkmcnt(2)
    v_mfma_f32_16x16x32_bf16 v[64:67], v[100:103], v[84:87], v[64:67]
    v_pk_fma_f32 v[144:145], v[140:141], v[40:41], v[120:121] op_sel:[1,1,0] op_sel_hi:[1,0,1] neg_lo:[1,0,0]
    v_pk_fma_f32 v[146:147], v[142:143], v[40:41], v[122:123] op_sel:[1,1,0] op_sel_hi:[1,0,1] neg_lo:[1,0,0]
    v_cvt_pk_bf16_f32 v51, v58, v59
    v_pk_mul_f32 v[108:109], v[144:145], v[40:41] op_sel:[0,0] op_sel_hi:[0,1]
    v_pk_mul_f32 v[110:111], v[146:147], v[40:41] op_sel:[0,0] op_sel_hi:[0,1]
    v_cvt_pk_bf16_f32 v53, v60, v61
    v_cvt_pk_bf16_f32 v55, v62, v63
    ds_write_addtid_b32 v48 offset:288
    ds_write_addtid_b32 v49 offset:576
    ds_write_addtid_b32 v50 offset:864
    ds_write_addtid_b32 v51 offset:1152
    s_waitcnt lgkmcnt(5)
    v_mfma_f32_16x16x32_bf16 v[64:67], v[104:107], v[88:91], v[64:67]
    v_cvt_pk_bf16_f32 v48, v124, v125
    v_cvt_pk_bf16_f32 v49, v126, v127
    ds_write_addtid_b32 v52 offset:1440
    ds_write_addtid_b32 v53 offset:1728
    ds_write_addtid_b32 v54 offset:2016
    ds_write_addtid_b32 v55 offset:2304
    v_cvt_pk_bf16_f32 v50, v128, v129
    v_cvt_pk_bf16_f32 v51, v130, v131
    v_pk_fma_f32 v[124:125], v[144:145], v[40:41], v[108:109] op_sel:[1,1,0] op_sel_hi:[1,0,1] neg_lo:[1,0,0]
    v_pk_fma_f32 v[126:127], v[146:147], v[40:41], v[110:111] op_sel:[1,1,0] op_sel_hi:[1,0,1] neg_lo:[1,0,0]
    ds_read_b128 v[92:95], v9 offset:0
    ds_read_b128 v[96:99], v9 offset:64
    ds_read_b128 v[100:103], v9 offset:128
    ds_read_b128 v[104:107], v9 offset:192
    ds_write_addtid_b32 v46 offset:0
    ds_write_addtid_b32 v47 offset:288
    ds_write_addtid_b32 v48 offset:3456
    ds_write_addtid_b32 v49 offset:3744
    ds_write_addtid_b32 v50 offset:4032
    ds_write_addtid_b32 v51 offset:4320
    v_cvt_pk_bf16_f32 v52, v132, v133
    v_cvt_pk_bf16_f32 v53, v134, v135
    v_cvt_pk_bf16_f32 v54, v136, v137
    v_cvt_pk_bf16_f32 v55, v138, v139
    v_cvt_pk_bf16_f32 v46, v140, v141
    v_cvt_pk_bf16_f32 v47, v142, v143
    v_cvt_pk_bf16_f32 v48, v144, v145
    v_cvt_pk_bf16_f32 v49, v146, v147
    v_cvt_pk_bf16_f32 v50, v124, v125
    v_cvt_pk_bf16_f32 v51, v126, v127
    ds_write_addtid_b32 v52 offset:576
    ds_write_addtid_b32 v53 offset:864
    ds_write_addtid_b32 v54 offset:1152
    ds_write_addtid_b32 v55 offset:1440
    ds_write_addtid_b32 v46 offset:1728
    ds_write_addtid_b32 v47 offset:2016
    ds_write_addtid_b32 v48 offset:2304
    ds_write_addtid_b32 v49 offset:2592
    ds_write_addtid_b32 v50 offset:2880
    ds_write_addtid_b32 v51 offset:3168
    ds_read_b128 v[16:19], v8 offset:0
    ds_read_b128 v[20:23], v8 offset:64
    ds_read_b128 v[24:27], v8 offset:128
    ds_read_b128 v[28:31], v8 offset:192
    s_waitcnt lgkmcnt(15)
    v_mfma_f32_16x16x32_bf16 v[68:71], v[92:95], v[76:79], 0
    v_mfma_f32_16x16x32_bf16 v[68:71], v[96:99], v[80:83], v[68:71]
    v_mfma_f32_16x16x32_bf16 v[68:71], v[100:103], v[84:87], v[68:71]
    v_mfma_f32_16x16x32_bf16 v[68:71], v[104:107], v[88:91], v[68:71]
    s_waitcnt lgkmcnt(3)
    v_mfma_f32_16x16x32_bf16 v[72:75], v[16:19], v[76:79], 0
    s_waitcnt lgkmcnt(2)
    v_mfma_f32_16x16x32_bf16 v[72:75], v[20:23], v[80:83], v[72:75]
    s_waitcnt lgkmcnt(1)
    v_mfma_f32_16x16x32_bf16 v[72:75], v[24:27], v[84:87], v[72:75]
    s_waitcnt lgkmcnt(0)
    v_mfma_f32_16x16x32_bf16 v[72:75], v[28:31], v[88:91], v[72:75]
    s_bitcmp1_b32 s28, 0
    s_nop 6
    s_cbranch_scc1 B_x1
    ds_write_b128 v148, v[68:71] offset:1024
    ds_write_b128 v148, v[72:75] offset:2048
    s_branch B_x2
B_x1:
    ds_write_b128 v148, v[64:67]
B_x2:
    v_mov_b32 v166, 1
    ds_write_b32 v165, v166
    v_xor_b32 v165, 4, v165
    s_mov_b32 s50, 0
    s_nop 0
B_fl:
    ds_read_b32 v166, v165
    s_add_u32 s50, s50, 1
    s_waitcnt lgkmcnt(0)
    v_readfirstlane_b32 s35, v166
    s_cmp_gt_u32 s50, 1000000
    s_nop 3
    s_cbranch_scc1 B_fld
    s_cmp_eq_u32 s35, 1
    s_cbranch_scc1 B_fld
    s_sleep 1
    s_branch B_fl
B_fld:
    s_bitcmp1_b32 s28, 0
    s_cbranch_scc1 B_sc_h1
    ds_read_b128 v[76:79], v149
    v_mov_b32 v156, s13
    v_cmp_eq_u32 vcc, 0, v1
    s_nop 1
    v_cndmask_b32 v156, 0, v156, vcc
    v_add_f32 v64, v64, v156
    s_waitcnt lgkmcnt(0)
    v_add_f32 v64, v64, v76
    v_add_f32 v65, v65, v77
    v_add_f32 v66, v66, v78
    v_add_f32 v67, v67, v79
    v_cvt_pk_bf16_f32 v76, v64, v65
    v_cvt_pk_bf16_f32 v77, v66, v67
    ds_write_b16 v150, v76 offset:6
    ds_write_b16 v150, v76 offset:1220
    ds_write_b16_d16_hi v150, v76 offset:4
    ds_write_b16_d16_hi v150, v76 offset:1218
    ds_write_b16 v150, v77 offset:2
    ds_write_b16 v150, v77 offset:1216
    ds_write_b16_d16_hi v150, v77 offset:0
    ds_write_b16_d16_hi v150, v77 offset:1214
    s_branch B_b3
B_sc_h1:
    ds_read_b128 v[76:79], v149 offset:1024
    ds_read_b128 v[80:83], v149 offset:2048
    s_waitcnt lgkmcnt(1)
    v_add_f32 v68, v68, v76
    v_add_f32 v69, v69, v77
    v_add_f32 v70, v70, v78
    v_add_f32 v71, v71, v79
    s_waitcnt lgkmcnt(0)
    v_add_f32 v72, v72, v80
    v_add_f32 v73, v73, v81
    v_add_f32 v74, v74, v82
    v_add_f32 v75, v75, v83
    v_cvt_pk_bf16_f32 v76, v68, v69
    v_cvt_pk_bf16_f32 v77, v70, v71
    v_cvt_pk_bf16_f32 v78, v72, v73
    v_cvt_pk_bf16_f32 v79, v74, v75
    s_mov_b32 exec_lo, 0xfffffffe
    s_mov_b32 exec_hi, 0x8000
    ds_write_b16 v151, v76 offset:16
    ds_write_b16 v151, v76 offset:1230
    s_mov_b32 exec_lo, 0xffffffff
    s_mov_b32 exec_hi, 0x8000
    ds_write_b16 v151, v76 offset:14
    ds_write_b16 v151, v76 offset:12
    ds_write_b16_d16_hi v151, v76 offset:10
    ds_write_b16 v151, v76 offset:1228
    ds_write_b16 v151, v76 offset:1226
    ds_write_b16_d16_hi v151, v76 offset:1224
    s_mov_b32 exec_lo, 0xffffffff
    s_mov_b32 exec_hi, 0x0
    ds_write_b16 v151, v77 offset:8
    ds_write_b16 v151, v77 offset:6
    ds_write_b16 v151, v77 offset:4
    ds_write_b16_d16_hi v151, v77 offset:2
    ds_write_b16 v151, v77 offset:1222
    ds_write_b16 v151, v77 offset:1220
    ds_write_b16 v151, v77 offset:1218
    ds_write_b16_d16_hi v151, v77 offset:1216
    s_mov_b64 exec, -1
    ds_write_b16 v152, v78 offset:0
    ds_write_b16_d16_hi v153, v78 offset:0
    ds_write_b16 v154, v79 offset:0
    ds_write_b16_d16_hi v155, v79 offset:0
    s_mov_b32 exec_lo, 0xffff0000
    s_mov_b32 exec_hi, 0xffff
    ds_write_b16 v152, v78 offset:190
    ds_write_b16_d16_hi v153, v78 offset:190
    ds_write_b16 v154, v79 offset:190
    ds_write_b16_d16_hi v155, v79 offset:190
    s_mov_b64 exec, -1
    s_branch B_b3
B_upath:
    v_mov_b32 v163, 0
    v_lshlrev_b32 v95, 4, v1
    v_and_b32 v8, 3, v1
    v_bfe_u32 v10, v1, 2, 2
    v_lshl_add_u32 v9, v3, 2, v8
    s_lshl_b32 s35, s28, 2
    v_lshl_add_u32 v9, v9, 3, v10
    s_add_u32 s35, s35, 141120
    s_sub_u32 s14, s28, 10
    v_lshl_add_u32 v10, v3, 2, v10
    s_mul_i32 s15, s14, 80
    v_add_u32 v108, 0, v3
    s_mul_i32 s16, s14, 11520
    v_lshlrev_b32 v10, 4, v10
    v_mul_u32_u24 v8, 288, v8
    s_add_u32 s15, s15, 110400
    s_add_u32 s16, s16, 46080
    v_mul_u32_u24 v109, 13108, v108
    v_add3_u32 v97, v8, v10, s16
    v_lshlrev_b32 v10, 4, v2
    v_lshrrev_b32 v109, 16, v109
    v_lshl_add_u32 v108, v108, 12, v10
    v_mul_u32_u24 v109, 144384, v109
    v_add_u32 v110, 4, v3
    v_add_u32 v100, v108, v109
    v_add_u32 v112, 8, v3
    v_add_u32 v114, 12, v3
    v_add_u32 v108, 16, v3
    v_mul_u32_u24 v111, 13108, v110
    v_mul_u32_u24 v113, 13108, v112
    v_mul_u32_u24 v115, 13108, v114
    v_mul_u32_u24 v109, 13108, v108
    s_mul_i32 s56, s31, 20608
    s_lshl_b32 s17, s29, 8
    v_lshrrev_b32 v111, 16, v111
    v_lshrrev_b32 v113, 16, v113
    v_lshrrev_b32 v115, 16, v115
    v_lshrrev_b32 v109, 16, v109
    s_add_u32 s56, s56, s17
    s_mul_i32 s17, s14, 1318912
    v_mov_b32 v94, s35
    v_mul_u32_u24 v9, 176, v9
    v_mul_u32_u24 v8, 288, v3
    s_add_u32 s56, s56, s17
    v_lshl_add_u32 v110, v110, 12, v10
    v_mul_u32_u24 v111, 144384, v111
    v_lshl_add_u32 v112, v112, 12, v10
    v_mul_u32_u24 v113, 144384, v113
    v_lshl_add_u32 v114, v114, 12, v10
    v_mul_u32_u24 v115, 144384, v115
    v_lshl_add_u32 v108, v108, 12, v10
    v_mul_u32_u24 v109, 144384, v109
    s_add_u32 s56, s56, 12582912
    v_xor_b32 v93, 4, v94
    v_add_u32 v96, s15, v9
    v_add3_u32 v98, v8, v10, s16
    v_add_u32 v101, v110, v111
    v_add_u32 v102, v112, v113
    v_add_u32 v103, v114, v115
    v_add_u32 v104, v108, v109
    s_add_u32 s18, s56, 659456
    v_lshlrev_b32 v4, 6, v1
    s_sub_u32 s35, s28, 10
    s_mul_i32 s35, s35, 10240
    s_add_u32 s35, s35, s57
    s_add_u32 s36, s35, 4096
    s_add_u32 s37, s35, 8192
    s_lshl_b32 s38, s32, 7
    s_add_u32 s38, s38, 8192
    s_cmp_eq_u32 s28, 11
    s_cselect_b32 s39, 16384, 0
    s_add_u32 s38, s38, s39
    buffer_load_dword v120, v4, s[8:11], s35 offen nt
    buffer_load_dword v121, v4, s[8:11], s36 offen nt
    s_mov_b32 exec_lo, 0xffffffff
    s_mov_b32 exec_hi, 0x0
    buffer_load_dword v122, v4, s[8:11], s37 offen nt
    s_mov_b32 exec_lo, 0x3
    s_mov_b32 exec_hi, 0x0
    buffer_load_dword v123, v4, s[8:11], s38 offen nt
    s_mov_b64 exec, -1
    s_waitcnt lgkmcnt(0)
    s_barrier
    s_waitcnt vmcnt(4)
    s_and_b32 s35, s2, 7
    s_lshl_b32 s35, s35, 8
    s_add_u32 s35, s35, 4096
    v_lshlrev_b32 v4, 3, v1
    s_mov_b32 exec_lo, 0xffff
    s_mov_b32 exec_hi, 0x0
    buffer_load_dwordx2 v[6:7], v4, s[8:11], s35 offen sc1
    s_mov_b64 exec, -1
    s_setprio 3
    v_mov_b32 v92, 1
    ds_write_b32 v94, v92
    s_mov_b32 s50, 0
ps_33:
    ds_read_b32 v92, v93
    s_add_u32 s50, s50, 1
    s_waitcnt lgkmcnt(0)
    v_cmp_gt_u32 vcc, 1, v92
    s_cmp_gt_u32 s50, 2000000
    s_nop 3
    s_cbranch_scc1 ps_34
    s_cbranch_vccz ps_34
    s_sleep 1
    s_branch ps_33
ps_34:
    ds_read_b64_tr_b16 v[16:17], v96 offset:0
    ds_read_b64_tr_b16 v[18:19], v96 offset:704
    ds_read_b64_tr_b16 v[20:21], v96 offset:8
    ds_read_b64_tr_b16 v[22:23], v96 offset:712
    ds_read_b64_tr_b16 v[24:25], v96 offset:16
    ds_read_b64_tr_b16 v[26:27], v96 offset:720
    ds_read_b64_tr_b16 v[28:29], v96 offset:24
    ds_read_b64_tr_b16 v[30:31], v96 offset:728
    ds_read_b64_tr_b16 v[32:33], v96 offset:32
    ds_read_b64_tr_b16 v[34:35], v96 offset:736
    ds_read_b64_tr_b16 v[36:37], v96 offset:40
    ds_read_b64_tr_b16 v[38:39], v96 offset:744
    ds_read_b64_tr_b16 v[40:41], v96 offset:48
    ds_read_b64_tr_b16 v[42:43], v96 offset:752
    ds_read_b64_tr_b16 v[44:45], v96 offset:56
    ds_read_b64_tr_b16 v[46:47], v96 offset:760
    ds_read_b64_tr_b16 v[48:49], v96 offset:64
    ds_read_b64_tr_b16 v[50:51], v96 offset:768
    ds_read_b64_tr_b16 v[52:53], v96 offset:72
    ds_read_b64_tr_b16 v[54:55], v96 offset:776
    s_waitcnt lgkmcnt(15)
    ds_write_b128 v97, v[16:19] offset:0
    ds_write_b128 v97, v[20:23] offset:1152
    s_waitcnt lgkmcnt(15)
    ds_write_b128 v97, v[24:27] offset:2304
    ds_read_b128 v[56:59], v98 offset:0
    s_waitcnt lgkmcnt(15)
    ds_write_b128 v97, v[28:31] offset:3456
    ds_read_b128 v[60:63], v98 offset:1152
    s_waitcnt lgkmcnt(15)
    ds_write_b128 v97, v[32:35] offset:4608
    ds_read_b128 v[64:67], v98 offset:2304
    s_waitcnt lgkmcnt(15)
    ds_write_b128 v97, v[36:39] offset:5760
    ds_read_b128 v[68:71], v98 offset:3456
    s_waitcnt lgkmcnt(15)
    ds_write_b128 v97, v[40:43] offset:6912
    ds_read_b128 v[72:75], v98 offset:4608
    s_waitcnt lgkmcnt(15)
    ds_write_b128 v97, v[44:47] offset:8064
    ds_read_b128 v[76:79], v98 offset:5760
    s_waitcnt lgkmcnt(15)
    ds_write_b128 v97, v[48:51] offset:9216
    ds_read_b128 v[80:83], v98 offset:6912
    s_waitcnt lgkmcnt(15)
    ds_write_b128 v97, v[52:55] offset:10368
    ds_read_b128 v[84:87], v98 offset:8064
    ds_read_b128 v[108:111], v98 offset:9216
    ds_read_b128 v[112:115], v98 offset:10368
    s_getreg_b32 s35, hwreg(HW_REG_XCC_ID)
    s_mov_b32 exec_lo, 0xffff
    s_mov_b32 exec_hi, 0x0
    s_waitcnt vmcnt(0)
    v_cmp_ne_u32 vcc, s30, v6
    v_cmp_ne_u32 s[40:41], s35, v7
    s_mov_b64 exec, -1
    s_nop 0
    s_or_b64 vcc, vcc, s[40:41]
    s_cselect_b64 s[98:99], 0, -1
    s_not_b64 s[100:101], s[98:99]
    v_mov_b32 v92, s98
    ds_write_b32 v94, v92 offset:16
    s_cmp_eq_u32 s98, 0
    s_cbranch_scc1 snd_35
    s_waitcnt lgkmcnt(15)
    buffer_store_dwordx4 v[56:59], v100, s[8:11], s56 offen
    buffer_store_dwordx4 v[60:63], v101, s[8:11], s56 offen
    s_waitcnt lgkmcnt(13)
    buffer_store_dwordx4 v[64:67], v102, s[8:11], s56 offen
    s_waitcnt lgkmcnt(11)
    buffer_store_dwordx4 v[68:71], v103, s[8:11], s56 offen
    s_waitcnt lgkmcnt(9)
    buffer_store_dwordx4 v[72:75], v104, s[8:11], s56 offen
    s_waitcnt lgkmcnt(7)
    buffer_store_dwordx4 v[76:79], v100, s[8:11], s18 offen
    s_waitcnt lgkmcnt(5)
    buffer_store_dwordx4 v[80:83], v101, s[8:11], s18 offen
    s_waitcnt lgkmcnt(3)
    buffer_store_dwordx4 v[84:87], v102, s[8:11], s18 offen
    s_waitcnt lgkmcnt(2)
    buffer_store_dwordx4 v[108:111], v103, s[8:11], s18 offen
    s_waitcnt lgkmcnt(1)
    buffer_store_dwordx4 v[112:115], v104, s[8:11], s18 offen
    s_nop 1
    s_branch snd_36
snd_35:
    s_waitcnt lgkmcnt(15)
    buffer_store_dwordx4 v[56:59], v100, s[8:11], s56 offen sc1
    buffer_store_dwordx4 v[60:63], v101, s[8:11], s56 offen sc1
    s_waitcnt lgkmcnt(13)
    buffer_store_dwordx4 v[64:67], v102, s[8:11], s56 offen sc1
    s_waitcnt lgkmcnt(11)
    buffer_store_dwordx4 v[68:71], v103, s[8:11], s56 offen sc1
    s_waitcnt lgkmcnt(9)
    buffer_store_dwordx4 v[72:75], v104, s[8:11], s56 offen sc1
    s_waitcnt lgkmcnt(7)
    buffer_store_dwordx4 v[76:79], v100, s[8:11], s18 offen sc1
    s_waitcnt lgkmcnt(5)
    buffer_store_dwordx4 v[80:83], v101, s[8:11], s18 offen sc1
    s_waitcnt lgkmcnt(3)
    buffer_store_dwordx4 v[84:87], v102, s[8:11], s18 offen sc1
    s_waitcnt lgkmcnt(2)
    buffer_store_dwordx4 v[108:111], v103, s[8:11], s18 offen sc1
    s_waitcnt lgkmcnt(1)
    buffer_store_dwordx4 v[112:115], v104, s[8:11], s18 offen sc1
    s_nop 1
snd_36:
    s_waitcnt vmcnt(0)
    v_mov_b32 v92, 2
    ds_write_b32 v94, v92
    s_mov_b32 s50, 0
ps_37:
    ds_read_b32 v92, v93
    s_add_u32 s50, s50, 1
    s_waitcnt lgkmcnt(0)
    v_cmp_gt_u32 vcc, 2, v92
    s_cmp_gt_u32 s50, 2000000
    s_nop 3
    s_cbranch_scc1 ps_38
    s_cbranch_vccz ps_38
    s_sleep 1
    s_branch ps_37
ps_38:
    s_cmp_lg_u32 s28, 10
    s_cbranch_scc1 B_nf1
    v_lshl_add_u32 v4, v1, 3, s31
    v_lshlrev_b32 v4, 7, v4
    v_mov_b32 v5, s30
    s_lshl_b32 s14, s29, 2
    s_add_u32 s14, s14, 8192
    s_waitcnt vmcnt(0)
    s_and_b64 exec, s[98:99], 0xffff
    buffer_store_dword v5, v4, s[8:11], s14 offen
    s_and_b64 exec, s[100:101], 0xffff
    buffer_store_dword v5, v4, s[8:11], s14 offen sc1
    s_mov_b64 exec, -1
B_nf1:
    s_sub_u32 s35, s28, 10
    s_lshl_b32 s14, s32, 7
    s_lshl_b32 s15, s35, 5
    s_add_u32 s14, s14, s15
    s_add_u32 s14, s14, 8192
    v_lshlrev_b32 v4, 2, v1
    s_mul_i32 s15, s32, 20608
    s_add_u32 s15, s15, 12582912
    s_lshl_b32 s35, s35, 11
    s_add_u32 s15, s15, s35
    s_add_u32 s16, s35, 69600
    s_mov_b32 s17, 3
    s_mov_b32 s50, 0
B_ur:
    s_mov_b32 exec_lo, 0xff
    s_mov_b32 exec_hi, 0x0
    buffer_load_dword v5, v4, s[8:11], s14 offen sc1
    s_add_u32 s50, s50, 1
    s_waitcnt vmcnt(0)
    v_cmp_ne_u32 vcc, s30, v5
    s_mov_b64 exec, -1
    s_cmp_gt_u32 s50, 200000
    s_cselect_b32 s18, 0, vcc_lo
    s_bitcmp0_b32 s17, 0
    s_nop 0
    s_cbranch_scc1 B_ur0
    s_and_b32 s19, s18, 15
    s_cbranch_scc1 B_ur0
    s_bitset0_b32 s17, 0
    s_mov_b32 m0, s16
    s_mov_b32 s19, s15
    buffer_load_dwordx4 v95, s[8:11], s19 offen offset:0 sc1 lds
    s_add_u32 m0, m0, 4608
    s_add_u32 s19, s19, 4096
    buffer_load_dwordx4 v95, s[8:11], s19 offen offset:0 sc1 lds
    s_add_u32 m0, m0, 4608
    s_add_u32 s19, s19, 4096
    buffer_load_dwordx4 v95, s[8:11], s19 offen offset:0 sc1 lds
    s_add_u32 m0, m0, 4608
    s_add_u32 s19, s19, 4096
    buffer_load_dwordx4 v95, s[8:11], s19 offen offset:0 sc1 lds
    s_add_u32 m0, m0, 4608
    s_add_u32 s19, s19, 4096
    buffer_load_dwordx4 v95, s[8:11], s19 offen offset:0 sc1 lds
B_ur0:
    s_bitcmp0_b32 s17, 1
    s_cbranch_scc1 B_ur1
    s_and_b32 s19, s18, 240
    s_cbranch_scc1 B_ur1
    s_bitset0_b32 s17, 1
    s_mov_b32 m0, s16
    s_mov_b32 s19, s15
    buffer_load_dwordx4 v95, s[8:11], s19 offen offset:1024 sc1 lds
    s_add_u32 m0, m0, 4608
    s_add_u32 s19, s19, 4096
    buffer_load_dwordx4 v95, s[8:11], s19 offen offset:1024 sc1 lds
    s_add_u32 m0, m0, 4608
    s_add_u32 s19, s19, 4096
    buffer_load_dwordx4 v95, s[8:11], s19 offen offset:1024 sc1 lds
    s_add_u32 m0, m0, 4608
    s_add_u32 s19, s19, 4096
    buffer_load_dwordx4 v95, s[8:11], s19 offen offset:1024 sc1 lds
    s_add_u32 m0, m0, 4608
    s_add_u32 s19, s19, 4096
    buffer_load_dwordx4 v95, s[8:11], s19 offen offset:1024 sc1 lds
B_ur1:
    s_cmp_eq_u32 s17, 0
    s_cbranch_scc1 B_urd
    s_sleep 1
    s_branch B_ur
B_urd:
    s_waitcnt vmcnt(0)
B_b3:
    s_lshl_b32 s35, s28, 2
    s_add_u32 s35, s35, 141248
    v_mov_b32 v4, s35
    v_mov_b32 v5, 1
    ds_write_b32 v4, v5
    s_min_u32 s37, s28, 4
    s_mul_i32 s38, s29, 5
    s_mul_i32 s54, s31, 20608
    s_add_u32 s38, s38, s37
    v_lshlrev_b32 v154, 5, v2
    s_lshl_b32 s38, s38, 8
    v_lshlrev_b32 v156, 2, v1
    s_add_u32 s54, s54, s38
    v_lshlrev_b32 v11, 4, v1
    s_add_u32 s54, s54, 12582912
    s_lshl_b32 s37, s37, 1
    v_lshl_add_u32 v154, v3, 3, v154
    s_lshl_b32 s37, 3, s37
    s_lshl_b32 s39, s28, 11
    v_add_u32 v155, 141248, v156
    s_add_u32 s39, s39, 141632
    v_add_u32 v156, 141184, v156
    v_add_u32 v153, s39, v11
    v_add_u32 v154, s39, v154
    s_mov_b32 s35, 9728
    s_mov_b32 s36, 13824
    s_mov_b32 s96, 0
    s_mov_b32 s97, -1
    s_cmp_gt_u32 s28, 7
    s_cbranch_scc1 B_pre
    buffer_load_dwordx4 v[12:15], v11, s[24:27], s36 offen
    s_mov_b32 exec_lo, s37
    s_mov_b32 exec_hi, 0
    s_mov_b32 s50, 0
kw_39:
    ds_read_b32 v11, v155
    s_add_u32 s50, s50, 1
    s_waitcnt lgkmcnt(0)
    v_cmp_ne_u32 vcc, 1, v11
    s_cmp_gt_u32 s50, 2000000
    s_nop 3
    s_cbranch_scc1 kw_40
    s_cbranch_vccz kw_40
    s_sleep 1
    s_branch kw_39
kw_40:
    s_mov_b64 exec, -1
    s_cmp_gt_u32 s28, 3
    s_cbranch_scc1 B_quart
    s_setprio 1
    ds_read2_b32 v[16:17], v158 offset0:128 offset1:129
    ds_read2_b32 v[18:19], v158 offset0:130 offset1:131
    ds_read2_b32 v[20:21], v158 offset0:0 offset1:1
    ds_read2_b32 v[22:23], v158 offset0:2 offset1:3
    ds_read2_b32 v[24:25], v158 offset0:144 offset1:145
    ds_read2_b32 v[26:27], v158 offset0:146 offset1:147
    ds_read2_b32 v[28:29], v158 offset0:16 offset1:17
    ds_read2_b32 v[30:31], v158 offset0:18 offset1:19
    ds_read2_b32 v[32:33], v158 offset0:160 offset1:161
    ds_read2_b32 v[34:35], v158 offset0:162 offset1:163
    ds_read2_b32 v[36:37], v158 offset0:32 offset1:33
    ds_read2_b32 v[38:39], v158 offset0:34 offset1:35
    ds_read2_b32 v[40:41], v158 offset0:176 offset1:177
    ds_read2_b32 v[42:43], v158 offset0:178 offset1:179
    ds_read2_b32 v[44:45], v158 offset0:48 offset1:49
    ds_read2_b32 v[46:47], v158 offset0:50 offset1:51
    ds_read2_b32 v[48:49], v158 offset0:192 offset1:193
    ds_read2_b32 v[50:51], v158 offset0:194 offset1:195
    ds_read2_b32 v[52:53], v158 offset0:64 offset1:65
    ds_read2_b32 v[54:55], v158 offset0:66 offset1:67
    ds_read2_b32 v[56:57], v158 offset0:208 offset1:209
    ds_read2_b32 v[58:59], v158 offset0:210 offset1:211
    ds_read2_b32 v[60:61], v158 offset0:80 offset1:81
    ds_read2_b32 v[62:63], v158 offset0:82 offset1:83
    ds_read2_b32 v[64:65], v158 offset0:224 offset1:225
    ds_read2_b32 v[66:67], v158 offset0:226 offset1:227
    ds_read2_b32 v[68:69], v158 offset0:96 offset1:97
    ds_read2_b32 v[70:71], v158 offset0:98 offset1:99
    ds_read2_b32 v[72:73], v158 offset0:240 offset1:241
    ds_read2_b32 v[74:75], v158 offset0:242 offset1:243
    ds_read2_b32 v[76:77], v158 offset0:112 offset1:113
    ds_read2_b32 v[78:79], v158 offset0:114 offset1:115
    v_subrev_u32 v11, 64, v158
    ds_read2_b32 v[80:81], v11 offset0:0 offset1:1
    ds_read2_b32 v[82:83], v11 offset0:2 offset1:3
    s_mov_b32 exec_lo, 0xc00
    s_mov_b32 exec_hi, 0x0
    s_mov_b32 s50, 0
uw_41:
    ds_read_b32 v11, v155
    s_add_u32 s50, s50, 1
    s_waitcnt lgkmcnt(0)
    v_cmp_ne_u32 vcc, 1, v11
    s_cmp_gt_u32 s50, 2000000
    s_nop 3
    s_cbranch_scc1 uw_42
    s_cbranch_vccz uw_42
    s_sleep 1
    s_branch uw_41
uw_42:
    s_mov_b64 exec, -1
    v_mov_b32 v10, 141176
    ds_read_b32 v10, v10
    s_waitcnt lgkmcnt(0)
    v_readfirstlane_b32 s98, v10
    s_nop 1
    s_mov_b32 s99, s98
    s_not_b64 s[100:101], s[98:99]
    ds_read_b128 v[116:119], v157 offset:0
    ds_read_b128 v[120:123], v157 offset:64
    ds_read_b128 v[124:127], v157 offset:128
    ds_read_b128 v[128:131], v157 offset:192
    ds_read_b128 v[132:135], v157 offset:256
    ds_read_b128 v[136:139], v157 offset:320
    ds_read_b128 v[140:143], v157 offset:384
    s_waitcnt lgkmcnt(6)
    v_mfma_f32_16x16x32_bf16 v[84:87], v[16:19], v[116:119], 0
    v_mfma_f32_16x16x32_bf16 v[88:91], v[20:23], v[116:119], 0
    ds_read_b128 v[144:147], v157 offset:448
    s_waitcnt lgkmcnt(6)
    v_mfma_f32_16x16x32_bf16 v[84:87], v[24:27], v[120:123], v[84:87]
    v_mfma_f32_16x16x32_bf16 v[88:91], v[28:31], v[120:123], v[88:91]
    ds_read_b128 v[116:119], v157 offset:512
    s_waitcnt lgkmcnt(6)
    v_mfma_f32_16x16x32_bf16 v[84:87], v[32:35], v[124:127], v[84:87]
    v_mfma_f32_16x16x32_bf16 v[88:91], v[36:39], v[124:127], v[88:91]
    ds_read_b128 v[120:123], v157 offset:576
    s_waitcnt lgkmcnt(6)
    v_mfma_f32_16x16x32_bf16 v[84:87], v[40:43], v[128:131], v[84:87]
    v_mfma_f32_16x16x32_bf16 v[88:91], v[44:47], v[128:131], v[88:91]
    ds_read_b128 v[124:127], v157 offset:640
    s_waitcnt lgkmcnt(6)
    v_mfma_f32_16x16x32_bf16 v[84:87], v[48:51], v[132:135], v[84:87]
    v_mfma_f32_16x16x32_bf16 v[88:91], v[52:55], v[132:135], v[88:91]
    ds_read_b128 v[128:131], v157 offset:704
    s_waitcnt lgkmcnt(6)
    v_mfma_f32_16x16x32_bf16 v[84:87], v[56:59], v[136:139], v[84:87]
    v_mfma_f32_16x16x32_bf16 v[88:91], v[60:63], v[136:139], v[88:91]
    ds_read_b128 v[132:135], v157 offset:768
    s_waitcnt lgkmcnt(6)
    v_mfma_f32_16x16x32_bf16 v[84:87], v[64:67], v[140:143], v[84:87]
    v_mfma_f32_16x16x32_bf16 v[88:91], v[68:71], v[140:143], v[88:91]
    ds_read_b128 v[136:139], v157 offset:832
    s_waitcnt lgkmcnt(6)
    v_mfma_f32_16x16x32_bf16 v[84:87], v[72:75], v[144:147], v[84:87]
    v_mfma_f32_16x16x32_bf16 v[88:91], v[76:79], v[144:147], v[88:91]
    v_mfma_f32_16x16x32_bf16 v[92:95], v[80:83], v[144:147], 0
    ds_read_b128 v[140:143], v157 offset:896
    s_waitcnt lgkmcnt(6)
    v_mfma_f32_16x16x32_bf16 v[88:91], v[16:19], v[116:119], v[88:91]
    v_mfma_f32_16x16x32_bf16 v[92:95], v[20:23], v[116:119], v[92:95]
    ds_read_b128 v[144:147], v157 offset:960
    s_waitcnt lgkmcnt(6)
    v_mfma_f32_16x16x32_bf16 v[88:91], v[24:27], v[120:123], v[88:91]
    v_mfma_f32_16x16x32_bf16 v[92:95], v[28:31], v[120:123], v[92:95]
    ds_read_b128 v[116:119], v157 offset:1024
    v_cvt_pk_bf16_f32 v84, v84, v85
    v_cvt_pk_bf16_f32 v85, v86, v87
    ds_write_b64 v154, v[84:85] offset:0
    s_waitcnt lgkmcnt(7)
    v_mfma_f32_16x16x32_bf16 v[88:91], v[32:35], v[124:127], v[88:91]
    v_mfma_f32_16x16x32_bf16 v[92:95], v[36:39], v[124:127], v[92:95]
    ds_read_b128 v[120:123], v157 offset:1088
    s_waitcnt lgkmcnt(7)
    v_mfma_f32_16x16x32_bf16 v[88:91], v[40:43], v[128:131], v[88:91]
    v_mfma_f32_16x16x32_bf16 v[92:95], v[44:47], v[128:131], v[92:95]
    ds_read_b128 v[124:127], v157 offset:1152
    s_waitcnt lgkmcnt(7)
    v_mfma_f32_16x16x32_bf16 v[88:91], v[48:51], v[132:135], v[88:91]
    v_mfma_f32_16x16x32_bf16 v[92:95], v[52:55], v[132:135], v[92:95]
    ds_read_b128 v[128:131], v157 offset:1216
    s_waitcnt lgkmcnt(7)
    v_mfma_f32_16x16x32_bf16 v[88:91], v[56:59], v[136:139], v[88:91]
    v_mfma_f32_16x16x32_bf16 v[92:95], v[60:63], v[136:139], v[92:95]
    ds_read_b128 v[132:135], v157 offset:1280
    s_waitcnt lgkmcnt(7)
    v_mfma_f32_16x16x32_bf16 v[88:91], v[64:67], v[140:143], v[88:91]
    v_mfma_f32_16x16x32_bf16 v[92:95], v[68:71], v[140:143], v[92:95]
    ds_read_b128 v[136:139], v157 offset:1344
    s_waitcnt lgkmcnt(7)
    v_mfma_f32_16x16x32_bf16 v[88:91], v[72:75], v[144:147], v[88:91]
    v_mfma_f32_16x16x32_bf16 v[92:95], v[76:79], v[144:147], v[92:95]
    v_mfma_f32_16x16x32_bf16 v[96:99], v[80:83], v[144:147], 0
    ds_read_b128 v[140:143], v157 offset:1408
    s_waitcnt lgkmcnt(7)
    v_mfma_f32_16x16x32_bf16 v[92:95], v[16:19], v[116:119], v[92:95]
    v_mfma_f32_16x16x32_bf16 v[96:99], v[20:23], v[116:119], v[96:99]
    ds_read_b128 v[144:147], v157 offset:1472
    s_waitcnt lgkmcnt(6)
    v_mfma_f32_16x16x32_bf16 v[92:95], v[24:27], v[120:123], v[92:95]
    v_mfma_f32_16x16x32_bf16 v[96:99], v[28:31], v[120:123], v[96:99]
    ds_read_b128 v[116:119], v157 offset:1536
    v_cvt_pk_bf16_f32 v88, v88, v89
    v_cvt_pk_bf16_f32 v89, v90, v91
    ds_write_b64 v154, v[88:89] offset:512
    ds_read_b128 v[84:87], v153 offset:0
    s_waitcnt lgkmcnt(8)
    v_mfma_f32_16x16x32_bf16 v[92:95], v[32:35], v[124:127], v[92:95]
    v_mfma_f32_16x16x32_bf16 v[96:99], v[36:39], v[124:127], v[96:99]
    ds_read_b128 v[120:123], v157 offset:1600
    s_waitcnt lgkmcnt(8)
    v_mfma_f32_16x16x32_bf16 v[92:95], v[40:43], v[128:131], v[92:95]
    v_mfma_f32_16x16x32_bf16 v[96:99], v[44:47], v[128:131], v[96:99]
    ds_read_b128 v[124:127], v157 offset:1664
    s_waitcnt lgkmcnt(8)
    v_mfma_f32_16x16x32_bf16 v[92:95], v[48:51], v[132:135], v[92:95]
    v_mfma_f32_16x16x32_bf16 v[96:99], v[52:55], v[132:135], v[96:99]
    ds_read_b128 v[128:131], v157 offset:1728
    s_waitcnt lgkmcnt(8)
    v_mfma_f32_16x16x32_bf16 v[92:95], v[56:59], v[136:139], v[92:95]
    v_mfma_f32_16x16x32_bf16 v[96:99], v[60:63], v[136:139], v[96:99]
    ds_read_b128 v[132:135], v157 offset:1792
    s_waitcnt lgkmcnt(8)
    v_mfma_f32_16x16x32_bf16 v[92:95], v[64:67], v[140:143], v[92:95]
    v_mfma_f32_16x16x32_bf16 v[96:99], v[68:71], v[140:143], v[96:99]
    ds_read_b128 v[136:139], v157 offset:1856
    s_waitcnt lgkmcnt(8)
    v_mfma_f32_16x16x32_bf16 v[92:95], v[72:75], v[144:147], v[92:95]
    v_mfma_f32_16x16x32_bf16 v[96:99], v[76:79], v[144:147], v[96:99]
    v_mfma_f32_16x16x32_bf16 v[100:103], v[80:83], v[144:147], 0
    ds_read_b128 v[140:143], v157 offset:1920
    s_waitcnt lgkmcnt(8)
    v_mfma_f32_16x16x32_bf16 v[96:99], v[16:19], v[116:119], v[96:99]
    v_mfma_f32_16x16x32_bf16 v[100:103], v[20:23], v[116:119], v[100:103]
    ds_read_b128 v[144:147], v157 offset:1984
    s_waitcnt lgkmcnt(6)
    v_mfma_f32_16x16x32_bf16 v[96:99], v[24:27], v[120:123], v[96:99]
    v_mfma_f32_16x16x32_bf16 v[100:103], v[28:31], v[120:123], v[100:103]
    ds_read_b128 v[116:119], v157 offset:2048
    s_waitcnt lgkmcnt(6)
    v_mfma_f32_16x16x32_bf16 v[96:99], v[32:35], v[124:127], v[96:99]
    v_mfma_f32_16x16x32_bf16 v[100:103], v[36:39], v[124:127], v[100:103]
    ds_read_b128 v[120:123], v157 offset:2112
    s_waitcnt lgkmcnt(6)
    v_mfma_f32_16x16x32_bf16 v[96:99], v[40:43], v[128:131], v[96:99]
    v_mfma_f32_16x16x32_bf16 v[100:103], v[44:47], v[128:131], v[100:103]
    ds_read_b128 v[124:127], v157 offset:2176
    s_waitcnt lgkmcnt(6)
    v_mfma_f32_16x16x32_bf16 v[96:99], v[48:51], v[132:135], v[96:99]
    v_mfma_f32_16x16x32_bf16 v[100:103], v[52:55], v[132:135], v[100:103]
    ds_read_b128 v[128:131], v157 offset:2240
    s_waitcnt lgkmcnt(6)
    v_mfma_f32_16x16x32_bf16 v[96:99], v[56:59], v[136:139], v[96:99]
    v_mfma_f32_16x16x32_bf16 v[100:103], v[60:63], v[136:139], v[100:103]
    ds_read_b128 v[132:135], v157 offset:2304
    s_waitcnt lgkmcnt(6)
    v_mfma_f32_16x16x32_bf16 v[96:99], v[64:67], v[140:143], v[96:99]
    v_mfma_f32_16x16x32_bf16 v[100:103], v[68:71], v[140:143], v[100:103]
    ds_read_b128 v[136:139], v157 offset:2368
    s_waitcnt lgkmcnt(6)
    v_mfma_f32_16x16x32_bf16 v[96:99], v[72:75], v[144:147], v[96:99]
    v_mfma_f32_16x16x32_bf16 v[100:103], v[76:79], v[144:147], v[100:103]
    v_mfma_f32_16x16x32_bf16 v[104:107], v[80:83], v[144:147], 0
    ds_read_b128 v[140:143], v157 offset:2432
    s_waitcnt lgkmcnt(6)
    v_mfma_f32_16x16x32_bf16 v[100:103], v[16:19], v[116:119], v[100:103]
    v_mfma_f32_16x16x32_bf16 v[104:107], v[20:23], v[116:119], v[104:107]
    ds_read_b128 v[144:147], v157 offset:2496
    s_waitcnt lgkmcnt(6)
    v_mfma_f32_16x16x32_bf16 v[100:103], v[24:27], v[120:123], v[100:103]
    v_mfma_f32_16x16x32_bf16 v[104:107], v[28:31], v[120:123], v[104:107]
    ds_read_b128 v[116:119], v157 offset:2560
    s_waitcnt lgkmcnt(6)
    v_mfma_f32_16x16x32_bf16 v[100:103], v[32:35], v[124:127], v[100:103]
    v_mfma_f32_16x16x32_bf16 v[104:107], v[36:39], v[124:127], v[104:107]
    ds_read_b128 v[120:123], v157 offset:2624
    s_waitcnt lgkmcnt(6)
    v_mfma_f32_16x16x32_bf16 v[100:103], v[40:43], v[128:131], v[100:103]
    v_mfma_f32_16x16x32_bf16 v[104:107], v[44:47], v[128:131], v[104:107]
    ds_read_b128 v[124:127], v157 offset:2688
    s_waitcnt lgkmcnt(6)
    v_mfma_f32_16x16x32_bf16 v[100:103], v[48:51], v[132:135], v[100:103]
    v_mfma_f32_16x16x32_bf16 v[104:107], v[52:55], v[132:135], v[104:107]
    ds_read_b128 v[128:131], v157 offset:2752
    s_waitcnt lgkmcnt(6)
    v_mfma_f32_16x16x32_bf16 v[100:103], v[56:59], v[136:139], v[100:103]
    v_mfma_f32_16x16x32_bf16 v[104:107], v[60:63], v[136:139], v[104:107]
    ds_read_b128 v[132:135], v157 offset:2816
    s_waitcnt lgkmcnt(6)
    v_mfma_f32_16x16x32_bf16 v[100:103], v[64:67], v[140:143], v[100:103]
    v_mfma_f32_16x16x32_bf16 v[104:107], v[68:71], v[140:143], v[104:107]
    ds_read_b128 v[136:139], v157 offset:2880
    s_waitcnt lgkmcnt(6)
    v_mfma_f32_16x16x32_bf16 v[100:103], v[72:75], v[144:147], v[100:103]
    v_mfma_f32_16x16x32_bf16 v[104:107], v[76:79], v[144:147], v[104:107]
    v_mfma_f32_16x16x32_bf16 v[108:111], v[80:83], v[144:147], 0
    ds_read_b128 v[140:143], v157 offset:2944
    s_waitcnt lgkmcnt(6)
    v_mfma_f32_16x16x32_bf16 v[104:107], v[16:19], v[116:119], v[104:107]
    v_mfma_f32_16x16x32_bf16 v[108:111], v[20:23], v[116:119], v[108:111]
    ds_read_b128 v[144:147], v157 offset:3008
    s_waitcnt lgkmcnt(6)
    v_mfma_f32_16x16x32_bf16 v[104:107], v[24:27], v[120:123], v[104:107]
    v_mfma_f32_16x16x32_bf16 v[108:111], v[28:31], v[120:123], v[108:111]
    ds_read_b128 v[116:119], v157 offset:3072
    s_waitcnt lgkmcnt(6)
    v_mfma_f32_16x16x32_bf16 v[104:107], v[32:35], v[124:127], v[104:107]
    v_mfma_f32_16x16x32_bf16 v[108:111], v[36:39], v[124:127], v[108:111]
    ds_read_b128 v[120:123], v157 offset:3136
    s_waitcnt lgkmcnt(6)
    v_mfma_f32_16x16x32_bf16 v[104:107], v[40:43], v[128:131], v[104:107]
    v_mfma_f32_16x16x32_bf16 v[108:111], v[44:47], v[128:131], v[108:111]
    ds_read_b128 v[124:127], v157 offset:3200
    s_waitcnt lgkmcnt(6)
    v_mfma_f32_16x16x32_bf16 v[104:107], v[48:51], v[132:135], v[104:107]
    v_mfma_f32_16x16x32_bf16 v[108:111], v[52:55], v[132:135], v[108:111]
    ds_read_b128 v[128:131], v157 offset:3264
    s_waitcnt lgkmcnt(6)
    v_mfma_f32_16x16x32_bf16 v[104:107], v[56:59], v[136:139], v[104:107]
    v_mfma_f32_16x16x32_bf16 v[108:111], v[60:63], v[136:139], v[108:111]
    ds_read_b128 v[132:135], v157 offset:3328
    s_waitcnt lgkmcnt(6)
    v_mfma_f32_16x16x32_bf16 v[104:107], v[64:67], v[140:143], v[104:107]
    v_mfma_f32_16x16x32_bf16 v[108:111], v[68:71], v[140:143], v[108:111]
    ds_read_b128 v[136:139], v157 offset:3392
    s_waitcnt lgkmcnt(6)
    v_mfma_f32_16x16x32_bf16 v[104:107], v[72:75], v[144:147], v[104:107]
    v_mfma_f32_16x16x32_bf16 v[108:111], v[76:79], v[144:147], v[108:111]
    v_mfma_f32_16x16x32_bf16 v[112:115], v[80:83], v[144:147], 0
    ds_read_b128 v[140:143], v157 offset:3456
    ds_read_u16 v10, v164
    s_waitcnt lgkmcnt(7)
    v_mfma_f32_16x16x32_bf16 v[108:111], v[16:19], v[116:119], v[108:111]
    v_mfma_f32_16x16x32_bf16 v[112:115], v[20:23], v[116:119], v[112:115]
    ds_read_b128 v[144:147], v157 offset:3520
    ds_read2_b32 v[20:21], v159 offset0:32 offset1:33
    ds_read2_b32 v[22:23], v159 offset0:34 offset1:35
    s_waitcnt lgkmcnt(9)
    v_mfma_f32_16x16x32_bf16 v[108:111], v[24:27], v[120:123], v[108:111]
    v_mfma_f32_16x16x32_bf16 v[112:115], v[28:31], v[120:123], v[112:115]
    ds_read_b128 v[116:119], v157 offset:3584
    ds_read2_b32 v[28:29], v159 offset0:16 offset1:17
    ds_read2_b32 v[30:31], v159 offset0:18 offset1:19
    s_waitcnt lgkmcnt(11)
    v_mfma_f32_16x16x32_bf16 v[108:111], v[32:35], v[124:127], v[108:111]
    v_mfma_f32_16x16x32_bf16 v[112:115], v[36:39], v[124:127], v[112:115]
    ds_read_b128 v[120:123], v157 offset:3648
    ds_read2_b32 v[36:37], v159 offset0:0 offset1:1
    ds_read2_b32 v[38:39], v159 offset0:2 offset1:3
    s_waitcnt lgkmcnt(13)
    v_mfma_f32_16x16x32_bf16 v[108:111], v[40:43], v[128:131], v[108:111]
    v_mfma_f32_16x16x32_bf16 v[112:115], v[44:47], v[128:131], v[112:115]
    ds_read_b128 v[124:127], v157 offset:3712
    ds_read2_b32 v[44:45], v159 offset0:96 offset1:97
    ds_read2_b32 v[46:47], v159 offset0:98 offset1:99
    s_waitcnt lgkmcnt(15)
    v_mfma_f32_16x16x32_bf16 v[108:111], v[48:51], v[132:135], v[108:111]
    v_mfma_f32_16x16x32_bf16 v[112:115], v[52:55], v[132:135], v[112:115]
    ds_read_b128 v[128:131], v157 offset:3776
    ds_read2_b32 v[52:53], v159 offset0:80 offset1:81
    ds_read2_b32 v[54:55], v159 offset0:82 offset1:83
    s_waitcnt lgkmcnt(15)
    v_mfma_f32_16x16x32_bf16 v[108:111], v[56:59], v[136:139], v[108:111]
    v_mfma_f32_16x16x32_bf16 v[112:115], v[60:63], v[136:139], v[112:115]
    ds_read_b128 v[132:135], v157 offset:3840
    ds_read2_b32 v[60:61], v159 offset0:64 offset1:65
    ds_read2_b32 v[62:63], v159 offset0:66 offset1:67
    v_mfma_f32_16x16x32_bf16 v[108:111], v[64:67], v[140:143], v[108:111]
    v_mfma_f32_16x16x32_bf16 v[112:115], v[68:71], v[140:143], v[112:115]
    ds_read_b128 v[136:139], v157 offset:3904
    ds_read2_b32 v[68:69], v160 offset0:24 offset1:25
    ds_read2_b32 v[70:71], v160 offset0:26 offset1:27
    s_waitcnt lgkmcnt(15)
    v_mfma_f32_16x16x32_bf16 v[108:111], v[72:75], v[144:147], v[108:111]
    v_mfma_f32_16x16x32_bf16 v[112:115], v[76:79], v[144:147], v[112:115]
    ds_read_b128 v[140:143], v157 offset:3968
    ds_read2_b32 v[76:77], v160 offset0:16 offset1:17
    ds_read2_b32 v[78:79], v160 offset0:18 offset1:19
    v_mfma_f32_16x16x32_bf16 v[112:115], v[16:19], v[116:119], v[112:115]
    ds_read_b128 v[144:147], v157 offset:4032
    ds_read2_b32 v[16:17], v160 offset0:8 offset1:9
    ds_read2_b32 v[18:19], v160 offset0:10 offset1:11
    s_waitcnt lgkmcnt(15)
    v_mfma_f32_16x16x32_bf16 v[112:115], v[24:27], v[120:123], v[112:115]
    ds_read_b128 v[116:119], v157 offset:448
    ds_read2_b32 v[24:25], v160 offset0:0 offset1:1
    ds_read2_b32 v[26:27], v160 offset0:2 offset1:3
    v_mfma_f32_16x16x32_bf16 v[112:115], v[32:35], v[124:127], v[112:115]
    ds_read_b32 v152, v156
    ds_read_b128 v[120:123], v157 offset:960
    ds_read2_b32 v[32:33], v160 offset0:120 offset1:121
    ds_read2_b32 v[34:35], v160 offset0:122 offset1:123
    s_waitcnt lgkmcnt(15)
    v_mfma_f32_16x16x32_bf16 v[112:115], v[40:43], v[128:131], v[112:115]
    ds_read_b128 v[124:127], v157 offset:1472
    ds_read2_b32 v[40:41], v160 offset0:112 offset1:113
    ds_read2_b32 v[42:43], v160 offset0:114 offset1:115
    v_mfma_f32_16x16x32_bf16 v[112:115], v[48:51], v[132:135], v[112:115]
    ds_read_b128 v[128:131], v157 offset:1984
    ds_read2_b32 v[48:49], v160 offset0:104 offset1:105
    ds_read2_b32 v[50:51], v160 offset0:106 offset1:107
    v_mfma_f32_16x16x32_bf16 v[112:115], v[56:59], v[136:139], v[112:115]
    s_waitcnt lgkmcnt(9)
    v_cmp_ne_u32 vcc, 1, v152
    s_nop 1
    s_and_b32 s35, vcc_lo, 15
    s_nop 2
    s_cbranch_scc0 sok_43
    s_mov_b32 exec_lo, 0xf
    s_mov_b32 exec_hi, 0x0
    s_mov_b32 s50, 0
sr_44:
    ds_read_b32 v11, v156
    s_add_u32 s50, s50, 1
    s_waitcnt lgkmcnt(0)
    v_cmp_ne_u32 vcc, 1, v11
    s_cmp_gt_u32 s50, 2000000
    s_nop 3
    s_cbranch_scc1 sr_45
    s_cbranch_vccz sr_45
    s_sleep 1
    s_branch sr_44
sr_45:
    s_mov_b64 exec, -1
sok_43:
    ds_read_b64_tr_b16 v[132:133], v161 offset:0
    ds_read_b64_tr_b16 v[134:135], v161 offset:80
    v_min_u32 v84, -2, v84
    s_cmp_eq_u32 s98, 0
    s_nop 0
    s_cbranch_scc1 snd_46
    s_add_u32 s55, s54, 0
    buffer_store_dwordx4 v[84:87], v163, s[8:11], s55 offen nt
    s_nop 1
    s_branch snd_47
snd_46:
    s_add_u32 s55, s54, 0
    buffer_store_dwordx4 v[84:87], v163, s[8:11], s55 offen sc1
    s_nop 1
snd_47:
    ds_read2_b32 v[56:57], v160 offset0:96 offset1:97
    ds_read2_b32 v[58:59], v160 offset0:98 offset1:99
    v_mfma_f32_16x16x32_bf16 v[112:115], v[64:67], v[140:143], v[112:115]
    ds_read_b64_tr_b16 v[136:137], v161 offset:3880
    ds_read_b64_tr_b16 v[138:139], v161 offset:3960
    v_mfma_f32_16x16x32_bf16 v[112:115], v[72:75], v[144:147], v[112:115]
    ds_read_b64_tr_b16 v[140:141], v162 offset:7760
    ds_read_b64_tr_b16 v[142:143], v162 offset:7920
    v_lshl_or_b32 v10, v10, 16, v10
    s_waitcnt vmcnt(1)
    v_and_b32 v80, v10, v12
    v_and_b32 v81, v10, v13
    v_and_b32 v82, v10, v14
    v_and_b32 v83, v10, v15
    s_nop 1
    v_mfma_f32_16x16x32_bf16 v[100:103], v[80:83], v[116:119], v[100:103]
    ds_read_b64_tr_b16 v[144:145], v162 offset:10360
    ds_read_b64_tr_b16 v[146:147], v162 offset:10520
    s_waitcnt lgkmcnt(15)
    v_mfma_f32_16x16x32_bf16 v[104:107], v[80:83], v[120:123], v[104:107]
    ds_read_b64_tr_b16 v[116:117], v161 offset:640
    ds_read_b64_tr_b16 v[118:119], v161 offset:720
    v_mfma_f32_16x16x32_bf16 v[108:111], v[80:83], v[124:127], v[108:111]
    ds_read_b64_tr_b16 v[120:121], v161 offset:4520
    ds_read_b64_tr_b16 v[122:123], v161 offset:4600
    s_waitcnt lgkmcnt(15)
    v_mfma_f32_16x16x32_bf16 v[112:115], v[80:83], v[128:131], v[112:115]
    ds_read_b64_tr_b16 v[124:125], v162 offset:9040
    ds_read_b64_tr_b16 v[126:127], v162 offset:9200
    s_waitcnt lgkmcnt(14)
    v_mfma_f32_16x16x32_bf16 v[92:95], v[132:135], v[20:23], v[92:95]
    v_mfma_f32_16x16x32_bf16 v[96:99], v[132:135], v[28:31], v[96:99]
    v_mfma_f32_16x16x32_bf16 v[100:103], v[132:135], v[36:39], v[100:103]
    ds_read_b64_tr_b16 v[128:129], v162 offset:11640
    ds_read_b64_tr_b16 v[130:131], v162 offset:11800
    s_waitcnt lgkmcnt(12)
    v_mfma_f32_16x16x32_bf16 v[92:95], v[136:139], v[44:47], v[92:95]
    v_mfma_f32_16x16x32_bf16 v[96:99], v[136:139], v[52:55], v[96:99]
    v_mfma_f32_16x16x32_bf16 v[100:103], v[136:139], v[60:63], v[100:103]
    ds_read_b64_tr_b16 v[132:133], v161 offset:1280
    ds_read_b64_tr_b16 v[134:135], v161 offset:1360
    s_waitcnt lgkmcnt(12)
    v_mfma_f32_16x16x32_bf16 v[100:103], v[140:143], v[68:71], v[100:103]
    v_mfma_f32_16x16x32_bf16 v[104:107], v[140:143], v[76:79], v[104:107]
    v_mfma_f32_16x16x32_bf16 v[108:111], v[140:143], v[16:19], v[108:111]
    v_mfma_f32_16x16x32_bf16 v[112:115], v[140:143], v[24:27], v[112:115]
    ds_read_b64_tr_b16 v[136:137], v161 offset:5160
    ds_read_b64_tr_b16 v[138:139], v161 offset:5240
    s_waitcnt lgkmcnt(12)
    v_mfma_f32_16x16x32_bf16 v[100:103], v[144:147], v[32:35], v[100:103]
    v_mfma_f32_16x16x32_bf16 v[104:107], v[144:147], v[40:43], v[104:107]
    v_mfma_f32_16x16x32_bf16 v[108:111], v[144:147], v[48:51], v[108:111]
    v_mfma_f32_16x16x32_bf16 v[112:115], v[144:147], v[56:59], v[112:115]
    ds_read_b64_tr_b16 v[140:141], v161 offset:1920
    ds_read_b64_tr_b16 v[142:143], v161 offset:2000
    v_cvt_pk_bf16_f32 v92, v92, v93
    v_cvt_pk_bf16_f32 v93, v94, v95
    ds_write_b64 v154, v[92:93] offset:1024
    s_waitcnt lgkmcnt(13)
    v_mfma_f32_16x16x32_bf16 v[96:99], v[116:119], v[20:23], v[96:99]
    v_mfma_f32_16x16x32_bf16 v[100:103], v[116:119], v[28:31], v[100:103]
    v_mfma_f32_16x16x32_bf16 v[104:107], v[116:119], v[36:39], v[104:107]
    ds_read_b64_tr_b16 v[144:145], v161 offset:5800
    ds_read_b64_tr_b16 v[146:147], v161 offset:5880
    s_waitcnt lgkmcnt(13)
    v_mfma_f32_16x16x32_bf16 v[96:99], v[120:123], v[44:47], v[96:99]
    v_mfma_f32_16x16x32_bf16 v[100:103], v[120:123], v[52:55], v[100:103]
    v_mfma_f32_16x16x32_bf16 v[104:107], v[120:123], v[60:63], v[104:107]
    ds_read_b64_tr_b16 v[116:117], v161 offset:2560
    ds_read_b64_tr_b16 v[118:119], v161 offset:2640
    s_waitcnt lgkmcnt(13)
    v_mfma_f32_16x16x32_bf16 v[108:111], v[124:127], v[68:71], v[108:111]
    v_mfma_f32_16x16x32_bf16 v[112:115], v[124:127], v[76:79], v[112:115]
    ds_read_b64_tr_b16 v[120:121], v161 offset:6440
    ds_read_b64_tr_b16 v[122:123], v161 offset:6520
    s_waitcnt lgkmcnt(13)
    v_mfma_f32_16x16x32_bf16 v[108:111], v[128:131], v[32:35], v[108:111]
    v_mfma_f32_16x16x32_bf16 v[112:115], v[128:131], v[40:43], v[112:115]
    ds_read_b64_tr_b16 v[124:125], v161 offset:3200
    ds_read_b64_tr_b16 v[126:127], v161 offset:3280
    v_cvt_pk_bf16_f32 v96, v96, v97
    v_cvt_pk_bf16_f32 v97, v98, v99
    ds_write_b64 v154, v[96:97] offset:1536
    ds_read_b128 v[92:95], v153 offset:1024
    s_waitcnt lgkmcnt(15)
    v_mfma_f32_16x16x32_bf16 v[100:103], v[132:135], v[20:23], v[100:103]
    v_mfma_f32_16x16x32_bf16 v[104:107], v[132:135], v[28:31], v[104:107]
    v_mfma_f32_16x16x32_bf16 v[108:111], v[132:135], v[36:39], v[108:111]
    ds_read_b64_tr_b16 v[128:129], v161 offset:7080
    ds_read_b64_tr_b16 v[130:131], v161 offset:7160
    s_waitcnt lgkmcnt(15)
    v_mfma_f32_16x16x32_bf16 v[100:103], v[136:139], v[44:47], v[100:103]
    v_mfma_f32_16x16x32_bf16 v[104:107], v[136:139], v[52:55], v[104:107]
    v_mfma_f32_16x16x32_bf16 v[108:111], v[136:139], v[60:63], v[108:111]
    s_waitcnt lgkmcnt(13)
    v_mfma_f32_16x16x32_bf16 v[104:107], v[140:143], v[20:23], v[104:107]
    v_mfma_f32_16x16x32_bf16 v[108:111], v[140:143], v[28:31], v[108:111]
    v_mfma_f32_16x16x32_bf16 v[112:115], v[140:143], v[36:39], v[112:115]
    s_waitcnt lgkmcnt(2)
    v_min_u32 v92, -2, v92
    s_cmp_eq_u32 s98, 0
    s_nop 4
    s_cbranch_scc1 snd_48
    s_add_u32 s55, s54, 659456
    buffer_store_dwordx4 v[92:95], v163, s[8:11], s55 offen nt
    s_nop 1
    s_branch snd_49
snd_48:
    s_add_u32 s55, s54, 659456
    buffer_store_dwordx4 v[92:95], v163, s[8:11], s55 offen sc1
    s_nop 1
snd_49:
    v_mfma_f32_16x16x32_bf16 v[104:107], v[144:147], v[44:47], v[104:107]
    v_mfma_f32_16x16x32_bf16 v[108:111], v[144:147], v[52:55], v[108:111]
    v_mfma_f32_16x16x32_bf16 v[112:115], v[144:147], v[60:63], v[112:115]
    v_cvt_pk_bf16_f32 v100, v100, v101
    v_cvt_pk_bf16_f32 v101, v102, v103
    ds_write_b64 v154, v[100:101] offset:0
    v_mfma_f32_16x16x32_bf16 v[108:111], v[116:119], v[20:23], v[108:111]
    v_mfma_f32_16x16x32_bf16 v[112:115], v[116:119], v[28:31], v[112:115]
    v_mfma_f32_16x16x32_bf16 v[108:111], v[120:123], v[44:47], v[108:111]
    v_mfma_f32_16x16x32_bf16 v[112:115], v[120:123], v[52:55], v[112:115]
    v_cvt_pk_bf16_f32 v104, v104, v105
    v_cvt_pk_bf16_f32 v105, v106, v107
    ds_write_b64 v154, v[104:105] offset:512
    ds_read_b128 v[100:103], v153 offset:0
    v_mfma_f32_16x16x32_bf16 v[112:115], v[124:127], v[20:23], v[112:115]
    s_waitcnt lgkmcnt(3)
    v_mfma_f32_16x16x32_bf16 v[112:115], v[128:131], v[44:47], v[112:115]
    v_cvt_pk_bf16_f32 v108, v108, v109
    v_cvt_pk_bf16_f32 v109, v110, v111
    ds_write_b64 v154, v[108:109] offset:1024
    s_nop 4
    v_cvt_pk_bf16_f32 v112, v112, v113
    v_cvt_pk_bf16_f32 v113, v114, v115
    ds_write_b64 v154, v[112:113] offset:1536
    ds_read_b128 v[108:111], v153 offset:1024
    s_waitcnt lgkmcnt(3)
    v_min_u32 v100, -2, v100
    s_waitcnt lgkmcnt(0)
    v_min_u32 v108, -2, v108
    s_cmp_eq_u32 s98, 0
    s_nop 0
    s_cbranch_scc1 snd_50
    s_add_u32 s55, s54, 1318912
    buffer_store_dwordx4 v[100:103], v163, s[8:11], s55 offen nt
    s_add_u32 s55, s54, 1978368
    buffer_store_dwordx4 v[108:111], v163, s[8:11], s55 offen nt
    s_nop 1
    s_branch snd_51
snd_50:
    s_add_u32 s55, s54, 1318912
    buffer_store_dwordx4 v[100:103], v163, s[8:11], s55 offen sc1
    s_add_u32 s55, s54, 1978368
    buffer_store_dwordx4 v[108:111], v163, s[8:11], s55 offen sc1
    s_nop 1
snd_51:
    s_branch B_cdone
B_quart:
    s_setprio 0
    s_cmp_lg_u32 s28, 4
    s_cbranch_scc1 B_q1
    ds_read2_b32 v[16:17], v158 offset0:128 offset1:129
    ds_read2_b32 v[18:19], v158 offset0:130 offset1:131
    ds_read2_b32 v[20:21], v158 offset0:144 offset1:145
    ds_read2_b32 v[22:23], v158 offset0:146 offset1:147
    ds_read2_b32 v[24:25], v158 offset0:160 offset1:161
    ds_read2_b32 v[26:27], v158 offset0:162 offset1:163
    ds_read2_b32 v[28:29], v158 offset0:176 offset1:177
    ds_read2_b32 v[30:31], v158 offset0:178 offset1:179
    ds_read2_b32 v[32:33], v158 offset0:192 offset1:193
    ds_read2_b32 v[34:35], v158 offset0:194 offset1:195
    ds_read2_b32 v[36:37], v158 offset0:208 offset1:209
    ds_read2_b32 v[38:39], v158 offset0:210 offset1:211
    ds_read2_b32 v[40:41], v158 offset0:224 offset1:225
    ds_read2_b32 v[42:43], v158 offset0:226 offset1:227
    ds_read2_b32 v[44:45], v158 offset0:240 offset1:241
    ds_read2_b32 v[46:47], v158 offset0:242 offset1:243
    v_subrev_u32 v11, 64, v158
    ds_read2_b32 v[48:49], v11 offset0:0 offset1:1
    ds_read2_b32 v[50:51], v11 offset0:2 offset1:3
    ds_read2_b32 v[52:53], v158 offset0:0 offset1:1
    ds_read2_b32 v[54:55], v158 offset0:2 offset1:3
    ds_read2_b32 v[56:57], v158 offset0:16 offset1:17
    ds_read2_b32 v[58:59], v158 offset0:18 offset1:19
    ds_read2_b32 v[60:61], v158 offset0:32 offset1:33
    ds_read2_b32 v[62:63], v158 offset0:34 offset1:35
    ds_read2_b32 v[64:65], v158 offset0:48 offset1:49
    ds_read2_b32 v[66:67], v158 offset0:50 offset1:51
    ds_read2_b32 v[68:69], v158 offset0:64 offset1:65
    ds_read2_b32 v[70:71], v158 offset0:66 offset1:67
    ds_read2_b32 v[72:73], v158 offset0:80 offset1:81
    ds_read2_b32 v[74:75], v158 offset0:82 offset1:83
    ds_read2_b32 v[76:77], v158 offset0:96 offset1:97
    ds_read2_b32 v[78:79], v158 offset0:98 offset1:99
    ds_read2_b32 v[80:81], v158 offset0:112 offset1:113
    ds_read2_b32 v[82:83], v158 offset0:114 offset1:115
    s_mov_b32 exec_lo, 0xc00
    s_mov_b32 exec_hi, 0x0
    s_mov_b32 s50, 0
uw_52:
    ds_read_b32 v11, v155
    s_add_u32 s50, s50, 1
    s_waitcnt lgkmcnt(0)
    v_cmp_ne_u32 vcc, 1, v11
    s_cmp_gt_u32 s50, 2000000
    s_nop 3
    s_cbranch_scc1 uw_53
    s_cbranch_vccz uw_53
    s_sleep 1
    s_branch uw_52
uw_53:
    s_mov_b64 exec, -1
    v_mov_b32 v10, 141176
    ds_read_b32 v10, v10
    s_waitcnt lgkmcnt(0)
    v_readfirstlane_b32 s98, v10
    s_nop 1
    s_mov_b32 s99, s98
    s_not_b64 s[100:101], s[98:99]
    ds_read_b128 v[116:119], v157 offset:0
    ds_read_b128 v[120:123], v157 offset:64
    ds_read_b128 v[124:127], v157 offset:128
    ds_read_b128 v[128:131], v157 offset:192
    ds_read_b128 v[132:135], v157 offset:256
    ds_read_b128 v[136:139], v157 offset:320
    ds_read_b128 v[140:143], v157 offset:384
    s_waitcnt lgkmcnt(6)
    v_mfma_f32_16x16x32_bf16 v[84:87], v[16:19], v[116:119], 0
    ds_read_b128 v[144:147], v157 offset:448
    s_waitcnt lgkmcnt(6)
    v_mfma_f32_16x16x32_bf16 v[84:87], v[20:23], v[120:123], v[84:87]
    ds_read_b128 v[116:119], v157 offset:3008
    s_waitcnt lgkmcnt(6)
    v_mfma_f32_16x16x32_bf16 v[84:87], v[24:27], v[124:127], v[84:87]
    ds_read_b128 v[120:123], v157 offset:3072
    s_waitcnt lgkmcnt(6)
    v_mfma_f32_16x16x32_bf16 v[84:87], v[28:31], v[128:131], v[84:87]
    ds_read_b128 v[124:127], v157 offset:3136
    s_waitcnt lgkmcnt(6)
    v_mfma_f32_16x16x32_bf16 v[84:87], v[32:35], v[132:135], v[84:87]
    ds_read_b128 v[128:131], v157 offset:3200
    s_waitcnt lgkmcnt(6)
    v_mfma_f32_16x16x32_bf16 v[84:87], v[36:39], v[136:139], v[84:87]
    ds_read_b128 v[132:135], v157 offset:3264
    s_waitcnt lgkmcnt(6)
    v_mfma_f32_16x16x32_bf16 v[84:87], v[40:43], v[140:143], v[84:87]
    ds_read_b128 v[136:139], v157 offset:3328
    s_waitcnt lgkmcnt(6)
    v_mfma_f32_16x16x32_bf16 v[84:87], v[44:47], v[144:147], v[84:87]
    ds_read_b128 v[140:143], v157 offset:3392
    s_waitcnt lgkmcnt(6)
    v_mfma_f32_16x16x32_bf16 v[88:91], v[48:51], v[116:119], 0
    ds_read_b128 v[144:147], v157 offset:3456
    ds_read_u16 v10, v164
    s_waitcnt lgkmcnt(7)
    v_mfma_f32_16x16x32_bf16 v[88:91], v[52:55], v[120:123], v[88:91]
    ds_read_b128 v[116:119], v157 offset:3520
    v_cvt_pk_bf16_f32 v84, v84, v85
    v_cvt_pk_bf16_f32 v85, v86, v87
    ds_write_b64 v154, v[84:85] offset:0
    ds_read2_b32 v[52:53], v160 offset0:0 offset1:1
    ds_read2_b32 v[54:55], v160 offset0:2 offset1:3
    s_waitcnt lgkmcnt(10)
    v_mfma_f32_16x16x32_bf16 v[88:91], v[56:59], v[124:127], v[88:91]
    ds_read_b128 v[120:123], v157 offset:3584
    ds_read2_b32 v[56:57], v160 offset0:96 offset1:97
    ds_read2_b32 v[58:59], v160 offset0:98 offset1:99
    s_waitcnt lgkmcnt(12)
    v_mfma_f32_16x16x32_bf16 v[88:91], v[60:63], v[128:131], v[88:91]
    ds_read_b128 v[124:127], v157 offset:3648
    ds_read2_b32 v[60:61], v160 offset0:16 offset1:17
    ds_read2_b32 v[62:63], v160 offset0:18 offset1:19
    s_waitcnt lgkmcnt(14)
    v_mfma_f32_16x16x32_bf16 v[88:91], v[64:67], v[132:135], v[88:91]
    ds_read_b128 v[128:131], v157 offset:3712
    ds_read2_b32 v[64:65], v160 offset0:112 offset1:113
    ds_read2_b32 v[66:67], v160 offset0:114 offset1:115
    s_waitcnt lgkmcnt(15)
    v_mfma_f32_16x16x32_bf16 v[88:91], v[68:71], v[136:139], v[88:91]
    ds_read_b128 v[132:135], v157 offset:3776
    ds_read2_b32 v[68:69], v159 offset0:0 offset1:1
    ds_read2_b32 v[70:71], v159 offset0:2 offset1:3
    v_mfma_f32_16x16x32_bf16 v[88:91], v[72:75], v[140:143], v[88:91]
    ds_read_b128 v[136:139], v157 offset:3840
    ds_read2_b32 v[72:73], v159 offset0:64 offset1:65
    ds_read2_b32 v[74:75], v159 offset0:66 offset1:67
    s_waitcnt lgkmcnt(15)
    v_mfma_f32_16x16x32_bf16 v[88:91], v[76:79], v[144:147], v[88:91]
    ds_read_b128 v[140:143], v157 offset:3904
    ds_read2_b32 v[76:77], v159 offset0:16 offset1:17
    ds_read2_b32 v[78:79], v159 offset0:18 offset1:19
    v_mfma_f32_16x16x32_bf16 v[88:91], v[80:83], v[116:119], v[88:91]
    ds_read_b32 v152, v156
    ds_read_b128 v[144:147], v157 offset:3968
    ds_read2_b32 v[80:81], v159 offset0:80 offset1:81
    ds_read2_b32 v[82:83], v159 offset0:82 offset1:83
    s_waitcnt lgkmcnt(15)
    v_mfma_f32_16x16x32_bf16 v[88:91], v[16:19], v[120:123], v[88:91]
    ds_read_b128 v[116:119], v157 offset:4032
    ds_read2_b32 v[16:17], v159 offset0:32 offset1:33
    ds_read2_b32 v[18:19], v159 offset0:34 offset1:35
    v_mfma_f32_16x16x32_bf16 v[88:91], v[20:23], v[124:127], v[88:91]
    ds_read_b128 v[120:123], v157 offset:1984
    ds_read2_b32 v[20:21], v159 offset0:96 offset1:97
    ds_read2_b32 v[22:23], v159 offset0:98 offset1:99
    v_mfma_f32_16x16x32_bf16 v[88:91], v[24:27], v[128:131], v[88:91]
    s_waitcnt lgkmcnt(9)
    v_cmp_ne_u32 vcc, 1, v152
    s_nop 1
    s_and_b32 s35, vcc_lo, 15
    s_nop 2
    s_cbranch_scc0 sok_54
    s_mov_b32 exec_lo, 0xf
    s_mov_b32 exec_hi, 0x0
    s_mov_b32 s50, 0
sr_55:
    ds_read_b32 v11, v156
    s_add_u32 s50, s50, 1
    s_waitcnt lgkmcnt(0)
    v_cmp_ne_u32 vcc, 1, v11
    s_cmp_gt_u32 s50, 2000000
    s_nop 3
    s_cbranch_scc1 sr_56
    s_cbranch_vccz sr_56
    s_sleep 1
    s_branch sr_55
sr_56:
    s_mov_b64 exec, -1
sok_54:
    ds_read_b64_tr_b16 v[124:125], v162 offset:7760
    ds_read_b64_tr_b16 v[126:127], v162 offset:7920
    v_mfma_f32_16x16x32_bf16 v[88:91], v[28:31], v[132:135], v[88:91]
    ds_read_b64_tr_b16 v[128:129], v162 offset:10360
    ds_read_b64_tr_b16 v[130:131], v162 offset:10520
    v_mfma_f32_16x16x32_bf16 v[88:91], v[32:35], v[136:139], v[88:91]
    ds_read_b64_tr_b16 v[132:133], v162 offset:9040
    ds_read_b64_tr_b16 v[134:135], v162 offset:9200
    v_mfma_f32_16x16x32_bf16 v[88:91], v[36:39], v[140:143], v[88:91]
    ds_read_b64_tr_b16 v[136:137], v162 offset:11640
    ds_read_b64_tr_b16 v[138:139], v162 offset:11800
    s_waitcnt lgkmcnt(15)
    v_mfma_f32_16x16x32_bf16 v[88:91], v[40:43], v[144:147], v[88:91]
    ds_read_b64_tr_b16 v[140:141], v161 offset:1920
    ds_read_b64_tr_b16 v[142:143], v161 offset:2000
    s_waitcnt lgkmcnt(15)
    v_mfma_f32_16x16x32_bf16 v[88:91], v[44:47], v[116:119], v[88:91]
    ds_read_b64_tr_b16 v[144:145], v161 offset:5800
    ds_read_b64_tr_b16 v[146:147], v161 offset:5880
    v_lshl_or_b32 v10, v10, 16, v10
    s_waitcnt vmcnt(0)
    v_and_b32 v48, v10, v12
    v_and_b32 v49, v10, v13
    v_and_b32 v50, v10, v14
    v_and_b32 v51, v10, v15
    s_waitcnt lgkmcnt(14)
    s_nop 0
    v_mfma_f32_16x16x32_bf16 v[88:91], v[48:51], v[120:123], v[88:91]
    ds_read_b64_tr_b16 v[116:117], v161 offset:2560
    ds_read_b64_tr_b16 v[118:119], v161 offset:2640
    s_waitcnt lgkmcnt(12)
    v_mfma_f32_16x16x32_bf16 v[88:91], v[124:127], v[52:55], v[88:91]
    ds_read_b64_tr_b16 v[120:121], v161 offset:6440
    ds_read_b64_tr_b16 v[122:123], v161 offset:6520
    s_waitcnt lgkmcnt(12)
    v_mfma_f32_16x16x32_bf16 v[88:91], v[128:131], v[56:59], v[88:91]
    ds_read_b64_tr_b16 v[124:125], v161 offset:3200
    ds_read_b64_tr_b16 v[126:127], v161 offset:3280
    s_waitcnt lgkmcnt(12)
    v_mfma_f32_16x16x32_bf16 v[88:91], v[132:135], v[60:63], v[88:91]
    ds_read_b64_tr_b16 v[128:129], v161 offset:7080
    ds_read_b64_tr_b16 v[130:131], v161 offset:7160
    s_waitcnt lgkmcnt(12)
    v_mfma_f32_16x16x32_bf16 v[88:91], v[136:139], v[64:67], v[88:91]
    s_waitcnt lgkmcnt(10)
    v_mfma_f32_16x16x32_bf16 v[88:91], v[140:143], v[68:71], v[88:91]
    s_waitcnt lgkmcnt(8)
    v_mfma_f32_16x16x32_bf16 v[88:91], v[144:147], v[72:75], v[88:91]
    s_waitcnt lgkmcnt(6)
    v_mfma_f32_16x16x32_bf16 v[88:91], v[116:119], v[76:79], v[88:91]
    s_waitcnt lgkmcnt(4)
    v_mfma_f32_16x16x32_bf16 v[88:91], v[120:123], v[80:83], v[88:91]
    s_waitcnt lgkmcnt(2)
    v_mfma_f32_16x16x32_bf16 v[88:91], v[124:127], v[16:19], v[88:91]
    s_waitcnt lgkmcnt(0)
    v_mfma_f32_16x16x32_bf16 v[88:91], v[128:131], v[20:23], v[88:91]
    s_nop 7
    v_cvt_pk_bf16_f32 v88, v88, v89
    v_cvt_pk_bf16_f32 v89, v90, v91
    ds_write_b64 v154, v[88:89] offset:512
    ds_read_b128 v[84:87], v153 offset:0
    s_waitcnt lgkmcnt(0)
    v_min_u32 v84, -2, v84
    v_mov_b32 v88, 1978368
    v_cndmask_b32 v88, 0, v88, s[96:97]
    v_add_u32 v88, v88, v163
    s_cmp_eq_u32 s98, 0
    s_nop 0
    s_cbranch_scc1 snd_57
    s_add_u32 s55, s54, 0
    buffer_store_dwordx4 v[84:87], v88, s[8:11], s55 offen nt
    s_nop 1
    s_branch snd_58
snd_57:
    s_add_u32 s55, s54, 0
    buffer_store_dwordx4 v[84:87], v88, s[8:11], s55 offen sc1
    s_nop 1
snd_58:
    s_branch B_cdone
B_q1:
    s_cmp_lg_u32 s28, 5
    s_cbranch_scc1 B_q2
    ds_read2_b32 v[16:17], v158 offset0:0 offset1:1
    ds_read2_b32 v[18:19], v158 offset0:2 offset1:3
    ds_read2_b32 v[20:21], v158 offset0:16 offset1:17
    ds_read2_b32 v[22:23], v158 offset0:18 offset1:19
    ds_read2_b32 v[24:25], v158 offset0:32 offset1:33
    ds_read2_b32 v[26:27], v158 offset0:34 offset1:35
    ds_read2_b32 v[28:29], v158 offset0:48 offset1:49
    ds_read2_b32 v[30:31], v158 offset0:50 offset1:51
    ds_read2_b32 v[32:33], v158 offset0:64 offset1:65
    ds_read2_b32 v[34:35], v158 offset0:66 offset1:67
    ds_read2_b32 v[36:37], v158 offset0:80 offset1:81
    ds_read2_b32 v[38:39], v158 offset0:82 offset1:83
    ds_read2_b32 v[40:41], v158 offset0:96 offset1:97
    ds_read2_b32 v[42:43], v158 offset0:98 offset1:99
    ds_read2_b32 v[44:45], v158 offset0:112 offset1:113
    ds_read2_b32 v[46:47], v158 offset0:114 offset1:115
    ds_read2_b32 v[48:49], v158 offset0:128 offset1:129
    ds_read2_b32 v[50:51], v158 offset0:130 offset1:131
    ds_read2_b32 v[52:53], v158 offset0:144 offset1:145
    ds_read2_b32 v[54:55], v158 offset0:146 offset1:147
    ds_read2_b32 v[56:57], v158 offset0:160 offset1:161
    ds_read2_b32 v[58:59], v158 offset0:162 offset1:163
    ds_read2_b32 v[60:61], v158 offset0:176 offset1:177
    ds_read2_b32 v[62:63], v158 offset0:178 offset1:179
    ds_read2_b32 v[64:65], v158 offset0:192 offset1:193
    ds_read2_b32 v[66:67], v158 offset0:194 offset1:195
    ds_read2_b32 v[68:69], v158 offset0:208 offset1:209
    ds_read2_b32 v[70:71], v158 offset0:210 offset1:211
    ds_read2_b32 v[72:73], v158 offset0:224 offset1:225
    ds_read2_b32 v[74:75], v158 offset0:226 offset1:227
    ds_read2_b32 v[76:77], v158 offset0:240 offset1:241
    ds_read2_b32 v[78:79], v158 offset0:242 offset1:243
    v_subrev_u32 v11, 64, v158
    ds_read2_b32 v[80:81], v11 offset0:0 offset1:1
    ds_read2_b32 v[82:83], v11 offset0:2 offset1:3
    s_mov_b32 exec_lo, 0xc00
    s_mov_b32 exec_hi, 0x0
    s_mov_b32 s50, 0
uw_59:
    ds_read_b32 v11, v155
    s_add_u32 s50, s50, 1
    s_waitcnt lgkmcnt(0)
    v_cmp_ne_u32 vcc, 1, v11
    s_cmp_gt_u32 s50, 2000000
    s_nop 3
    s_cbranch_scc1 uw_60
    s_cbranch_vccz uw_60
    s_sleep 1
    s_branch uw_59
uw_60:
    s_mov_b64 exec, -1
    v_mov_b32 v10, 141176
    ds_read_b32 v10, v10
    s_waitcnt lgkmcnt(0)
    v_readfirstlane_b32 s98, v10
    s_nop 1
    s_mov_b32 s99, s98
    s_not_b64 s[100:101], s[98:99]
    ds_read_b128 v[116:119], v157 offset:0
    ds_read_b128 v[120:123], v157 offset:64
    ds_read_b128 v[124:127], v157 offset:128
    ds_read_b128 v[128:131], v157 offset:192
    ds_read_b128 v[132:135], v157 offset:256
    ds_read_b128 v[136:139], v157 offset:320
    ds_read_b128 v[140:143], v157 offset:384
    s_waitcnt lgkmcnt(6)
    v_mfma_f32_16x16x32_bf16 v[84:87], v[16:19], v[116:119], 0
    ds_read_b128 v[144:147], v157 offset:448
    s_waitcnt lgkmcnt(6)
    v_mfma_f32_16x16x32_bf16 v[84:87], v[20:23], v[120:123], v[84:87]
    ds_read_b128 v[116:119], v157 offset:512
    s_waitcnt lgkmcnt(6)
    v_mfma_f32_16x16x32_bf16 v[84:87], v[24:27], v[124:127], v[84:87]
    ds_read_b128 v[120:123], v157 offset:576
    s_waitcnt lgkmcnt(6)
    v_mfma_f32_16x16x32_bf16 v[84:87], v[28:31], v[128:131], v[84:87]
    ds_read_b128 v[124:127], v157 offset:640
    s_waitcnt lgkmcnt(6)
    v_mfma_f32_16x16x32_bf16 v[84:87], v[32:35], v[132:135], v[84:87]
    ds_read_b128 v[128:131], v157 offset:704
    s_waitcnt lgkmcnt(6)
    v_mfma_f32_16x16x32_bf16 v[84:87], v[36:39], v[136:139], v[84:87]
    ds_read_b128 v[132:135], v157 offset:768
    s_waitcnt lgkmcnt(6)
    v_mfma_f32_16x16x32_bf16 v[84:87], v[40:43], v[140:143], v[84:87]
    ds_read_b128 v[136:139], v157 offset:832
    s_waitcnt lgkmcnt(6)
    v_mfma_f32_16x16x32_bf16 v[84:87], v[44:47], v[144:147], v[84:87]
    ds_read_b128 v[140:143], v157 offset:896
    s_waitcnt lgkmcnt(6)
    v_mfma_f32_16x16x32_bf16 v[84:87], v[48:51], v[116:119], v[84:87]
    ds_read_b128 v[144:147], v157 offset:960
    s_waitcnt lgkmcnt(6)
    v_mfma_f32_16x16x32_bf16 v[84:87], v[52:55], v[120:123], v[84:87]
    ds_read_b128 v[116:119], v157 offset:2496
    s_waitcnt lgkmcnt(6)
    v_mfma_f32_16x16x32_bf16 v[84:87], v[56:59], v[124:127], v[84:87]
    ds_read_b128 v[120:123], v157 offset:2560
    s_waitcnt lgkmcnt(6)
    v_mfma_f32_16x16x32_bf16 v[84:87], v[60:63], v[128:131], v[84:87]
    ds_read_b128 v[124:127], v157 offset:2624
    s_waitcnt lgkmcnt(6)
    v_mfma_f32_16x16x32_bf16 v[84:87], v[64:67], v[132:135], v[84:87]
    ds_read_b128 v[128:131], v157 offset:2688
    s_waitcnt lgkmcnt(6)
    v_mfma_f32_16x16x32_bf16 v[84:87], v[68:71], v[136:139], v[84:87]
    ds_read_b128 v[132:135], v157 offset:2752
    s_waitcnt lgkmcnt(6)
    v_mfma_f32_16x16x32_bf16 v[84:87], v[72:75], v[140:143], v[84:87]
    ds_read_b128 v[136:139], v157 offset:2816
    s_waitcnt lgkmcnt(6)
    v_mfma_f32_16x16x32_bf16 v[84:87], v[76:79], v[144:147], v[84:87]
    ds_read_b128 v[140:143], v157 offset:2880
    s_waitcnt lgkmcnt(6)
    v_mfma_f32_16x16x32_bf16 v[88:91], v[80:83], v[116:119], 0
    ds_read_b128 v[144:147], v157 offset:2944
    ds_read_u16 v10, v164
    s_waitcnt lgkmcnt(7)
    v_mfma_f32_16x16x32_bf16 v[88:91], v[16:19], v[120:123], v[88:91]
    ds_read_b128 v[116:119], v157 offset:3008
    v_cvt_pk_bf16_f32 v84, v84, v85
    v_cvt_pk_bf16_f32 v85, v86, v87
    ds_write_b64 v154, v[84:85] offset:0
    ds_read2_b32 v[16:17], v160 offset0:8 offset1:9
    ds_read2_b32 v[18:19], v160 offset0:10 offset1:11
    s_waitcnt lgkmcnt(10)
    v_mfma_f32_16x16x32_bf16 v[88:91], v[20:23], v[124:127], v[88:91]
    ds_read_b128 v[120:123], v157 offset:3072
    ds_read2_b32 v[20:21], v160 offset0:104 offset1:105
    ds_read2_b32 v[22:23], v160 offset0:106 offset1:107
    s_waitcnt lgkmcnt(12)
    v_mfma_f32_16x16x32_bf16 v[88:91], v[24:27], v[128:131], v[88:91]
    ds_read_b128 v[124:127], v157 offset:3136
    ds_read2_b32 v[24:25], v160 offset0:24 offset1:25
    ds_read2_b32 v[26:27], v160 offset0:26 offset1:27
    s_waitcnt lgkmcnt(14)
    v_mfma_f32_16x16x32_bf16 v[88:91], v[28:31], v[132:135], v[88:91]
    ds_read_b128 v[128:131], v157 offset:3200
    ds_read2_b32 v[28:29], v160 offset0:120 offset1:121
    ds_read2_b32 v[30:31], v160 offset0:122 offset1:123
    s_waitcnt lgkmcnt(15)
    v_mfma_f32_16x16x32_bf16 v[88:91], v[32:35], v[136:139], v[88:91]
    ds_read_b128 v[132:135], v157 offset:3264
    ds_read2_b32 v[32:33], v159 offset0:0 offset1:1
    ds_read2_b32 v[34:35], v159 offset0:2 offset1:3
    v_mfma_f32_16x16x32_bf16 v[88:91], v[36:39], v[140:143], v[88:91]
    ds_read_b128 v[136:139], v157 offset:3328
    ds_read2_b32 v[36:37], v159 offset0:64 offset1:65
    ds_read2_b32 v[38:39], v159 offset0:66 offset1:67
    s_waitcnt lgkmcnt(15)
    v_mfma_f32_16x16x32_bf16 v[88:91], v[40:43], v[144:147], v[88:91]
    ds_read_b128 v[140:143], v157 offset:3392
    ds_read2_b32 v[40:41], v159 offset0:16 offset1:17
    ds_read2_b32 v[42:43], v159 offset0:18 offset1:19
    v_mfma_f32_16x16x32_bf16 v[88:91], v[44:47], v[116:119], v[88:91]
    ds_read_b32 v152, v156
    ds_read_b128 v[144:147], v157 offset:3456
    ds_read2_b32 v[44:45], v159 offset0:80 offset1:81
    ds_read2_b32 v[46:47], v159 offset0:82 offset1:83
    s_waitcnt lgkmcnt(15)
    v_mfma_f32_16x16x32_bf16 v[88:91], v[48:51], v[120:123], v[88:91]
    ds_read_b128 v[116:119], v157 offset:3520
    ds_read2_b32 v[48:49], v159 offset0:32 offset1:33
    ds_read2_b32 v[50:51], v159 offset0:34 offset1:35
    v_mfma_f32_16x16x32_bf16 v[88:91], v[52:55], v[124:127], v[88:91]
    ds_read_b128 v[120:123], v157 offset:1472
    ds_read2_b32 v[52:53], v159 offset0:96 offset1:97
    ds_read2_b32 v[54:55], v159 offset0:98 offset1:99
    v_mfma_f32_16x16x32_bf16 v[88:91], v[56:59], v[128:131], v[88:91]
    s_waitcnt lgkmcnt(9)
    v_cmp_ne_u32 vcc, 1, v152
    s_nop 1
    s_and_b32 s35, vcc_lo, 15
    s_nop 2
    s_cbranch_scc0 sok_61
    s_mov_b32 exec_lo, 0xf
    s_mov_b32 exec_hi, 0x0
    s_mov_b32 s50, 0
sr_62:
    ds_read_b32 v11, v156
    s_add_u32 s50, s50, 1
    s_waitcnt lgkmcnt(0)
    v_cmp_ne_u32 vcc, 1, v11
    s_cmp_gt_u32 s50, 2000000
    s_nop 3
    s_cbranch_scc1 sr_63
    s_cbranch_vccz sr_63
    s_sleep 1
    s_branch sr_62
sr_63:
    s_mov_b64 exec, -1
sok_61:
    ds_read_b64_tr_b16 v[124:125], v162 offset:7760
    ds_read_b64_tr_b16 v[126:127], v162 offset:7920
    v_mfma_f32_16x16x32_bf16 v[88:91], v[60:63], v[132:135], v[88:91]
    ds_read_b64_tr_b16 v[128:129], v162 offset:10360
    ds_read_b64_tr_b16 v[130:131], v162 offset:10520
    v_mfma_f32_16x16x32_bf16 v[88:91], v[64:67], v[136:139], v[88:91]
    ds_read_b64_tr_b16 v[132:133], v162 offset:9040
    ds_read_b64_tr_b16 v[134:135], v162 offset:9200
    v_mfma_f32_16x16x32_bf16 v[88:91], v[68:71], v[140:143], v[88:91]
    ds_read_b64_tr_b16 v[136:137], v162 offset:11640
    ds_read_b64_tr_b16 v[138:139], v162 offset:11800
    s_waitcnt lgkmcnt(15)
    v_mfma_f32_16x16x32_bf16 v[88:91], v[72:75], v[144:147], v[88:91]
    ds_read_b64_tr_b16 v[140:141], v161 offset:1280
    ds_read_b64_tr_b16 v[142:143], v161 offset:1360
    s_waitcnt lgkmcnt(15)
    v_mfma_f32_16x16x32_bf16 v[88:91], v[76:79], v[116:119], v[88:91]
    ds_read_b64_tr_b16 v[144:145], v161 offset:5160
    ds_read_b64_tr_b16 v[146:147], v161 offset:5240
    v_lshl_or_b32 v10, v10, 16, v10
    s_waitcnt vmcnt(0)
    v_and_b32 v80, v10, v12
    v_and_b32 v81, v10, v13
    v_and_b32 v82, v10, v14
    v_and_b32 v83, v10, v15
    s_waitcnt lgkmcnt(14)
    s_nop 0
    v_mfma_f32_16x16x32_bf16 v[88:91], v[80:83], v[120:123], v[88:91]
    ds_read_b64_tr_b16 v[116:117], v161 offset:1920
    ds_read_b64_tr_b16 v[118:119], v161 offset:2000
    s_waitcnt lgkmcnt(12)
    v_mfma_f32_16x16x32_bf16 v[88:91], v[124:127], v[16:19], v[88:91]
    ds_read_b64_tr_b16 v[120:121], v161 offset:5800
    ds_read_b64_tr_b16 v[122:123], v161 offset:5880
    s_waitcnt lgkmcnt(12)
    v_mfma_f32_16x16x32_bf16 v[88:91], v[128:131], v[20:23], v[88:91]
    ds_read_b64_tr_b16 v[124:125], v161 offset:2560
    ds_read_b64_tr_b16 v[126:127], v161 offset:2640
    s_waitcnt lgkmcnt(12)
    v_mfma_f32_16x16x32_bf16 v[88:91], v[132:135], v[24:27], v[88:91]
    ds_read_b64_tr_b16 v[128:129], v161 offset:6440
    ds_read_b64_tr_b16 v[130:131], v161 offset:6520
    s_waitcnt lgkmcnt(12)
    v_mfma_f32_16x16x32_bf16 v[88:91], v[136:139], v[28:31], v[88:91]
    s_waitcnt lgkmcnt(10)
    v_mfma_f32_16x16x32_bf16 v[88:91], v[140:143], v[32:35], v[88:91]
    s_waitcnt lgkmcnt(8)
    v_mfma_f32_16x16x32_bf16 v[88:91], v[144:147], v[36:39], v[88:91]
    s_waitcnt lgkmcnt(6)
    v_mfma_f32_16x16x32_bf16 v[88:91], v[116:119], v[40:43], v[88:91]
    s_waitcnt lgkmcnt(4)
    v_mfma_f32_16x16x32_bf16 v[88:91], v[120:123], v[44:47], v[88:91]
    s_waitcnt lgkmcnt(2)
    v_mfma_f32_16x16x32_bf16 v[88:91], v[124:127], v[48:51], v[88:91]
    s_waitcnt lgkmcnt(0)
    v_mfma_f32_16x16x32_bf16 v[88:91], v[128:131], v[52:55], v[88:91]
    s_nop 7
    v_cvt_pk_bf16_f32 v88, v88, v89
    v_cvt_pk_bf16_f32 v89, v90, v91
    ds_write_b64 v154, v[88:89] offset:512
    ds_read_b128 v[84:87], v153 offset:0
    s_waitcnt lgkmcnt(0)
    v_min_u32 v84, -2, v84
    v_mov_b32 v88, 1318912
    v_cndmask_b32 v88, 0, v88, s[96:97]
    v_add_u32 v88, v88, v163
    s_cmp_eq_u32 s98, 0
    s_nop 0
    s_cbranch_scc1 snd_64
    s_add_u32 s55, s54, 329728
    buffer_store_dwordx4 v[84:87], v88, s[8:11], s55 offen nt
    s_nop 1
    s_branch snd_65
snd_64:
    s_add_u32 s55, s54, 329728
    buffer_store_dwordx4 v[84:87], v88, s[8:11], s55 offen sc1
    s_nop 1
snd_65:
    s_branch B_cdone
B_q2:
    s_cmp_lg_u32 s28, 6
    s_cbranch_scc1 B_q3
    v_subrev_u32 v11, 64, v158
    ds_read2_b32 v[16:17], v11 offset0:0 offset1:1
    ds_read2_b32 v[18:19], v11 offset0:2 offset1:3
    ds_read2_b32 v[20:21], v158 offset0:0 offset1:1
    ds_read2_b32 v[22:23], v158 offset0:2 offset1:3
    ds_read2_b32 v[24:25], v158 offset0:16 offset1:17
    ds_read2_b32 v[26:27], v158 offset0:18 offset1:19
    ds_read2_b32 v[28:29], v158 offset0:32 offset1:33
    ds_read2_b32 v[30:31], v158 offset0:34 offset1:35
    ds_read2_b32 v[32:33], v158 offset0:48 offset1:49
    ds_read2_b32 v[34:35], v158 offset0:50 offset1:51
    ds_read2_b32 v[36:37], v158 offset0:64 offset1:65
    ds_read2_b32 v[38:39], v158 offset0:66 offset1:67
    ds_read2_b32 v[40:41], v158 offset0:80 offset1:81
    ds_read2_b32 v[42:43], v158 offset0:82 offset1:83
    ds_read2_b32 v[44:45], v158 offset0:96 offset1:97
    ds_read2_b32 v[46:47], v158 offset0:98 offset1:99
    ds_read2_b32 v[48:49], v158 offset0:112 offset1:113
    ds_read2_b32 v[50:51], v158 offset0:114 offset1:115
    ds_read2_b32 v[52:53], v158 offset0:128 offset1:129
    ds_read2_b32 v[54:55], v158 offset0:130 offset1:131
    ds_read2_b32 v[56:57], v158 offset0:144 offset1:145
    ds_read2_b32 v[58:59], v158 offset0:146 offset1:147
    ds_read2_b32 v[60:61], v158 offset0:160 offset1:161
    ds_read2_b32 v[62:63], v158 offset0:162 offset1:163
    ds_read2_b32 v[64:65], v158 offset0:176 offset1:177
    ds_read2_b32 v[66:67], v158 offset0:178 offset1:179
    ds_read2_b32 v[68:69], v158 offset0:192 offset1:193
    ds_read2_b32 v[70:71], v158 offset0:194 offset1:195
    ds_read2_b32 v[72:73], v158 offset0:208 offset1:209
    ds_read2_b32 v[74:75], v158 offset0:210 offset1:211
    ds_read2_b32 v[76:77], v158 offset0:224 offset1:225
    ds_read2_b32 v[78:79], v158 offset0:226 offset1:227
    ds_read2_b32 v[80:81], v158 offset0:240 offset1:241
    ds_read2_b32 v[82:83], v158 offset0:242 offset1:243
    s_mov_b32 exec_lo, 0xc00
    s_mov_b32 exec_hi, 0x0
    s_mov_b32 s50, 0
uw_66:
    ds_read_b32 v11, v155
    s_add_u32 s50, s50, 1
    s_waitcnt lgkmcnt(0)
    v_cmp_ne_u32 vcc, 1, v11
    s_cmp_gt_u32 s50, 2000000
    s_nop 3
    s_cbranch_scc1 uw_67
    s_cbranch_vccz uw_67
    s_sleep 1
    s_branch uw_66
uw_67:
    s_mov_b64 exec, -1
    v_mov_b32 v10, 141176
    ds_read_b32 v10, v10
    s_waitcnt lgkmcnt(0)
    v_readfirstlane_b32 s98, v10
    s_nop 1
    s_mov_b32 s99, s98
    s_not_b64 s[100:101], s[98:99]
    ds_read_b128 v[116:119], v157 offset:448
    ds_read_b128 v[120:123], v157 offset:512
    ds_read_b128 v[124:127], v157 offset:576
    ds_read_b128 v[128:131], v157 offset:640
    ds_read_b128 v[132:135], v157 offset:704
    ds_read_b128 v[136:139], v157 offset:768
    ds_read_b128 v[140:143], v157 offset:832
    s_waitcnt lgkmcnt(6)
    v_mfma_f32_16x16x32_bf16 v[84:87], v[16:19], v[116:119], 0
    ds_read_b128 v[144:147], v157 offset:896
    s_waitcnt lgkmcnt(6)
    v_mfma_f32_16x16x32_bf16 v[84:87], v[20:23], v[120:123], v[84:87]
    ds_read_b128 v[116:119], v157 offset:960
    s_waitcnt lgkmcnt(6)
    v_mfma_f32_16x16x32_bf16 v[84:87], v[24:27], v[124:127], v[84:87]
    ds_read_b128 v[120:123], v157 offset:1024
    s_waitcnt lgkmcnt(6)
    v_mfma_f32_16x16x32_bf16 v[84:87], v[28:31], v[128:131], v[84:87]
    ds_read_b128 v[124:127], v157 offset:1088
    s_waitcnt lgkmcnt(6)
    v_mfma_f32_16x16x32_bf16 v[84:87], v[32:35], v[132:135], v[84:87]
    ds_read_b128 v[128:131], v157 offset:1152
    s_waitcnt lgkmcnt(6)
    v_mfma_f32_16x16x32_bf16 v[84:87], v[36:39], v[136:139], v[84:87]
    ds_read_b128 v[132:135], v157 offset:1216
    s_waitcnt lgkmcnt(6)
    v_mfma_f32_16x16x32_bf16 v[84:87], v[40:43], v[140:143], v[84:87]
    ds_read_b128 v[136:139], v157 offset:1280
    s_waitcnt lgkmcnt(6)
    v_mfma_f32_16x16x32_bf16 v[84:87], v[44:47], v[144:147], v[84:87]
    ds_read_b128 v[140:143], v157 offset:1344
    s_waitcnt lgkmcnt(6)
    v_mfma_f32_16x16x32_bf16 v[84:87], v[48:51], v[116:119], v[84:87]
    ds_read_b128 v[144:147], v157 offset:1408
    s_waitcnt lgkmcnt(6)
    v_mfma_f32_16x16x32_bf16 v[84:87], v[52:55], v[120:123], v[84:87]
    ds_read_b128 v[116:119], v157 offset:1472
    s_waitcnt lgkmcnt(6)
    v_mfma_f32_16x16x32_bf16 v[84:87], v[56:59], v[124:127], v[84:87]
    ds_read_b128 v[120:123], v157 offset:1984
    s_waitcnt lgkmcnt(6)
    v_mfma_f32_16x16x32_bf16 v[84:87], v[60:63], v[128:131], v[84:87]
    ds_read_b128 v[124:127], v157 offset:2048
    s_waitcnt lgkmcnt(6)
    v_mfma_f32_16x16x32_bf16 v[84:87], v[64:67], v[132:135], v[84:87]
    ds_read_b128 v[128:131], v157 offset:2112
    s_waitcnt lgkmcnt(6)
    v_mfma_f32_16x16x32_bf16 v[84:87], v[68:71], v[136:139], v[84:87]
    ds_read_b128 v[132:135], v157 offset:2176
    s_waitcnt lgkmcnt(6)
    v_mfma_f32_16x16x32_bf16 v[84:87], v[72:75], v[140:143], v[84:87]
    ds_read_b128 v[136:139], v157 offset:2240
    s_waitcnt lgkmcnt(6)
    v_mfma_f32_16x16x32_bf16 v[84:87], v[76:79], v[144:147], v[84:87]
    ds_read_b128 v[140:143], v157 offset:2304
    s_waitcnt lgkmcnt(6)
    v_mfma_f32_16x16x32_bf16 v[84:87], v[80:83], v[116:119], v[84:87]
    ds_read_b128 v[144:147], v157 offset:2368
    s_waitcnt lgkmcnt(6)
    v_mfma_f32_16x16x32_bf16 v[88:91], v[16:19], v[120:123], 0
    ds_read_b128 v[116:119], v157 offset:2432
    ds_read_u16 v10, v164
    s_waitcnt lgkmcnt(7)
    v_mfma_f32_16x16x32_bf16 v[88:91], v[20:23], v[124:127], v[88:91]
    ds_read_b128 v[120:123], v157 offset:2496
    ds_read2_b32 v[20:21], v159 offset0:32 offset1:33
    ds_read2_b32 v[22:23], v159 offset0:34 offset1:35
    s_waitcnt lgkmcnt(9)
    v_mfma_f32_16x16x32_bf16 v[88:91], v[24:27], v[128:131], v[88:91]
    ds_read_b128 v[124:127], v157 offset:2560
    ds_read2_b32 v[24:25], v159 offset0:96 offset1:97
    ds_read2_b32 v[26:27], v159 offset0:98 offset1:99
    s_waitcnt lgkmcnt(11)
    v_mfma_f32_16x16x32_bf16 v[88:91], v[28:31], v[132:135], v[88:91]
    ds_read_b128 v[128:131], v157 offset:2624
    ds_read2_b32 v[28:29], v160 offset0:16 offset1:17
    ds_read2_b32 v[30:31], v160 offset0:18 offset1:19
    s_waitcnt lgkmcnt(13)
    v_mfma_f32_16x16x32_bf16 v[88:91], v[32:35], v[136:139], v[88:91]
    ds_read_b128 v[132:135], v157 offset:2688
    ds_read2_b32 v[32:33], v160 offset0:112 offset1:113
    ds_read2_b32 v[34:35], v160 offset0:114 offset1:115
    s_waitcnt lgkmcnt(15)
    v_mfma_f32_16x16x32_bf16 v[88:91], v[36:39], v[140:143], v[88:91]
    ds_read_b128 v[136:139], v157 offset:2752
    ds_read2_b32 v[36:37], v159 offset0:0 offset1:1
    ds_read2_b32 v[38:39], v159 offset0:2 offset1:3
    s_waitcnt lgkmcnt(15)
    v_mfma_f32_16x16x32_bf16 v[88:91], v[40:43], v[144:147], v[88:91]
    ds_read_b128 v[140:143], v157 offset:2816
    ds_read2_b32 v[40:41], v159 offset0:64 offset1:65
    ds_read2_b32 v[42:43], v159 offset0:66 offset1:67
    v_mfma_f32_16x16x32_bf16 v[88:91], v[44:47], v[116:119], v[88:91]
    ds_read_b128 v[144:147], v157 offset:2880
    ds_read2_b32 v[44:45], v159 offset0:16 offset1:17
    ds_read2_b32 v[46:47], v159 offset0:18 offset1:19
    s_waitcnt lgkmcnt(15)
    v_mfma_f32_16x16x32_bf16 v[88:91], v[48:51], v[120:123], v[88:91]
    ds_read_b32 v152, v156
    ds_read_b128 v[116:119], v157 offset:2944
    ds_read2_b32 v[48:49], v159 offset0:80 offset1:81
    ds_read2_b32 v[50:51], v159 offset0:82 offset1:83
    v_mfma_f32_16x16x32_bf16 v[88:91], v[52:55], v[124:127], v[88:91]
    ds_read_b128 v[120:123], v157 offset:3008
    s_waitcnt lgkmcnt(15)
    v_mfma_f32_16x16x32_bf16 v[88:91], v[56:59], v[128:131], v[88:91]
    ds_read_b128 v[124:127], v157 offset:960
    v_mfma_f32_16x16x32_bf16 v[88:91], v[60:63], v[132:135], v[88:91]
    s_waitcnt lgkmcnt(5)
    v_cmp_ne_u32 vcc, 1, v152
    s_nop 1
    s_and_b32 s35, vcc_lo, 15
    s_nop 2
    s_cbranch_scc0 sok_68
    s_mov_b32 exec_lo, 0xf
    s_mov_b32 exec_hi, 0x0
    s_mov_b32 s50, 0
sr_69:
    ds_read_b32 v11, v156
    s_add_u32 s50, s50, 1
    s_waitcnt lgkmcnt(0)
    v_cmp_ne_u32 vcc, 1, v11
    s_cmp_gt_u32 s50, 2000000
    s_nop 3
    s_cbranch_scc1 sr_70
    s_cbranch_vccz sr_70
    s_sleep 1
    s_branch sr_69
sr_70:
    s_mov_b64 exec, -1
sok_68:
    ds_read_b64_tr_b16 v[128:129], v161 offset:0
    ds_read_b64_tr_b16 v[130:131], v161 offset:80
    v_mfma_f32_16x16x32_bf16 v[88:91], v[64:67], v[136:139], v[88:91]
    ds_read_b64_tr_b16 v[132:133], v161 offset:3880
    ds_read_b64_tr_b16 v[134:135], v161 offset:3960
    v_mfma_f32_16x16x32_bf16 v[88:91], v[68:71], v[140:143], v[88:91]
    ds_read_b64_tr_b16 v[136:137], v162 offset:7760
    ds_read_b64_tr_b16 v[138:139], v162 offset:7920
    v_mfma_f32_16x16x32_bf16 v[88:91], v[72:75], v[144:147], v[88:91]
    ds_read_b64_tr_b16 v[140:141], v162 offset:10360
    ds_read_b64_tr_b16 v[142:143], v162 offset:10520
    s_waitcnt lgkmcnt(12)
    v_mfma_f32_16x16x32_bf16 v[88:91], v[76:79], v[116:119], v[88:91]
    ds_read_b64_tr_b16 v[144:145], v161 offset:640
    ds_read_b64_tr_b16 v[146:147], v161 offset:720
    s_waitcnt lgkmcnt(11)
    v_mfma_f32_16x16x32_bf16 v[88:91], v[80:83], v[120:123], v[88:91]
    ds_read_b64_tr_b16 v[116:117], v161 offset:4520
    ds_read_b64_tr_b16 v[118:119], v161 offset:4600
    v_lshl_or_b32 v10, v10, 16, v10
    s_waitcnt vmcnt(0)
    v_and_b32 v16, v10, v12
    v_and_b32 v17, v10, v13
    v_and_b32 v18, v10, v14
    v_and_b32 v19, v10, v15
    s_waitcnt lgkmcnt(12)
    s_nop 0
    v_mfma_f32_16x16x32_bf16 v[88:91], v[16:19], v[124:127], v[88:91]
    ds_read_b64_tr_b16 v[120:121], v161 offset:1280
    ds_read_b64_tr_b16 v[122:123], v161 offset:1360
    s_waitcnt lgkmcnt(12)
    v_mfma_f32_16x16x32_bf16 v[84:87], v[128:131], v[20:23], v[84:87]
    ds_read_b64_tr_b16 v[124:125], v161 offset:5160
    ds_read_b64_tr_b16 v[126:127], v161 offset:5240
    s_waitcnt lgkmcnt(12)
    v_mfma_f32_16x16x32_bf16 v[84:87], v[132:135], v[24:27], v[84:87]
    ds_read_b64_tr_b16 v[128:129], v161 offset:1920
    ds_read_b64_tr_b16 v[130:131], v161 offset:2000
    s_waitcnt lgkmcnt(12)
    v_mfma_f32_16x16x32_bf16 v[88:91], v[136:139], v[28:31], v[88:91]
    ds_read_b64_tr_b16 v[132:133], v161 offset:5800
    ds_read_b64_tr_b16 v[134:135], v161 offset:5880
    s_waitcnt lgkmcnt(12)
    v_mfma_f32_16x16x32_bf16 v[88:91], v[140:143], v[32:35], v[88:91]
    v_cvt_pk_bf16_f32 v84, v84, v85
    v_cvt_pk_bf16_f32 v85, v86, v87
    ds_write_b64 v154, v[84:85] offset:0
    s_waitcnt lgkmcnt(11)
    v_mfma_f32_16x16x32_bf16 v[88:91], v[144:147], v[36:39], v[88:91]
    s_waitcnt lgkmcnt(9)
    v_mfma_f32_16x16x32_bf16 v[88:91], v[116:119], v[40:43], v[88:91]
    s_waitcnt lgkmcnt(7)
    v_mfma_f32_16x16x32_bf16 v[88:91], v[120:123], v[44:47], v[88:91]
    s_waitcnt lgkmcnt(5)
    v_mfma_f32_16x16x32_bf16 v[88:91], v[124:127], v[48:51], v[88:91]
    s_waitcnt lgkmcnt(3)
    v_mfma_f32_16x16x32_bf16 v[88:91], v[128:131], v[20:23], v[88:91]
    s_waitcnt lgkmcnt(1)
    v_mfma_f32_16x16x32_bf16 v[88:91], v[132:135], v[24:27], v[88:91]
    s_nop 7
    v_cvt_pk_bf16_f32 v88, v88, v89
    v_cvt_pk_bf16_f32 v89, v90, v91
    ds_write_b64 v154, v[88:89] offset:512
    ds_read_b128 v[84:87], v153 offset:0
    s_waitcnt lgkmcnt(0)
    v_min_u32 v84, -2, v84
    v_mov_b32 v88, 659456
    v_cndmask_b32 v88, 0, v88, s[96:97]
    v_add_u32 v88, v88, v163
    s_cmp_eq_u32 s98, 0
    s_nop 0
    s_cbranch_scc1 snd_71
    s_add_u32 s55, s54, 659456
    buffer_store_dwordx4 v[84:87], v88, s[8:11], s55 offen nt
    s_nop 1
    s_branch snd_72
snd_71:
    s_add_u32 s55, s54, 659456
    buffer_store_dwordx4 v[84:87], v88, s[8:11], s55 offen sc1
    s_nop 1
snd_72:
    s_branch B_cdone
B_q3:
    v_subrev_u32 v11, 64, v158
    ds_read2_b32 v[16:17], v11 offset0:0 offset1:1
    ds_read2_b32 v[18:19], v11 offset0:2 offset1:3
    ds_read2_b32 v[20:21], v158 offset0:0 offset1:1
    ds_read2_b32 v[22:23], v158 offset0:2 offset1:3
    ds_read2_b32 v[24:25], v158 offset0:16 offset1:17
    ds_read2_b32 v[26:27], v158 offset0:18 offset1:19
    ds_read2_b32 v[28:29], v158 offset0:32 offset1:33
    ds_read2_b32 v[30:31], v158 offset0:34 offset1:35
    ds_read2_b32 v[32:33], v158 offset0:48 offset1:49
    ds_read2_b32 v[34:35], v158 offset0:50 offset1:51
    ds_read2_b32 v[36:37], v158 offset0:64 offset1:65
    ds_read2_b32 v[38:39], v158 offset0:66 offset1:67
    ds_read2_b32 v[40:41], v158 offset0:80 offset1:81
    ds_read2_b32 v[42:43], v158 offset0:82 offset1:83
    ds_read2_b32 v[44:45], v158 offset0:96 offset1:97
    ds_read2_b32 v[46:47], v158 offset0:98 offset1:99
    ds_read2_b32 v[48:49], v158 offset0:112 offset1:113
    ds_read2_b32 v[50:51], v158 offset0:114 offset1:115
    ds_read2_b32 v[52:53], v158 offset0:128 offset1:129
    ds_read2_b32 v[54:55], v158 offset0:130 offset1:131
    ds_read2_b32 v[56:57], v158 offset0:144 offset1:145
    ds_read2_b32 v[58:59], v158 offset0:146 offset1:147
    ds_read2_b32 v[60:61], v158 offset0:160 offset1:161
    ds_read2_b32 v[62:63], v158 offset0:162 offset1:163
    ds_read2_b32 v[64:65], v158 offset0:176 offset1:177
    ds_read2_b32 v[66:67], v158 offset0:178 offset1:179
    ds_read2_b32 v[68:69], v158 offset0:192 offset1:193
    ds_read2_b32 v[70:71], v158 offset0:194 offset1:195
    ds_read2_b32 v[72:73], v158 offset0:208 offset1:209
    ds_read2_b32 v[74:75], v158 offset0:210 offset1:211
    ds_read2_b32 v[76:77], v158 offset0:224 offset1:225
    ds_read2_b32 v[78:79], v158 offset0:226 offset1:227
    ds_read2_b32 v[80:81], v158 offset0:240 offset1:241
    ds_read2_b32 v[82:83], v158 offset0:242 offset1:243
    s_mov_b32 exec_lo, 0xc00
    s_mov_b32 exec_hi, 0x0
    s_mov_b32 s50, 0
uw_73:
    ds_read_b32 v11, v155
    s_add_u32 s50, s50, 1
    s_waitcnt lgkmcnt(0)
    v_cmp_ne_u32 vcc, 1, v11
    s_cmp_gt_u32 s50, 2000000
    s_nop 3
    s_cbranch_scc1 uw_74
    s_cbranch_vccz uw_74
    s_sleep 1
    s_branch uw_73
uw_74:
    s_mov_b64 exec, -1
    v_mov_b32 v10, 141176
    ds_read_b32 v10, v10
    s_waitcnt lgkmcnt(0)
    v_readfirstlane_b32 s98, v10
    s_nop 1
    s_mov_b32 s99, s98
    s_not_b64 s[100:101], s[98:99]
    ds_read_b128 v[116:119], v157 offset:960
    ds_read_b128 v[120:123], v157 offset:1024
    ds_read_b128 v[124:127], v157 offset:1088
    ds_read_b128 v[128:131], v157 offset:1152
    ds_read_b128 v[132:135], v157 offset:1216
    ds_read_b128 v[136:139], v157 offset:1280
    ds_read_b128 v[140:143], v157 offset:1344
    s_waitcnt lgkmcnt(6)
    v_mfma_f32_16x16x32_bf16 v[84:87], v[16:19], v[116:119], 0
    ds_read_b128 v[144:147], v157 offset:1408
    s_waitcnt lgkmcnt(6)
    v_mfma_f32_16x16x32_bf16 v[84:87], v[20:23], v[120:123], v[84:87]
    ds_read_b128 v[116:119], v157 offset:1472
    s_waitcnt lgkmcnt(6)
    v_mfma_f32_16x16x32_bf16 v[84:87], v[24:27], v[124:127], v[84:87]
    ds_read_b128 v[120:123], v157 offset:1536
    s_waitcnt lgkmcnt(6)
    v_mfma_f32_16x16x32_bf16 v[84:87], v[28:31], v[128:131], v[84:87]
    ds_read_b128 v[124:127], v157 offset:1600
    s_waitcnt lgkmcnt(6)
    v_mfma_f32_16x16x32_bf16 v[84:87], v[32:35], v[132:135], v[84:87]
    ds_read_b128 v[128:131], v157 offset:1664
    s_waitcnt lgkmcnt(6)
    v_mfma_f32_16x16x32_bf16 v[84:87], v[36:39], v[136:139], v[84:87]
    ds_read_b128 v[132:135], v157 offset:1728
    s_waitcnt lgkmcnt(6)
    v_mfma_f32_16x16x32_bf16 v[84:87], v[40:43], v[140:143], v[84:87]
    ds_read_b128 v[136:139], v157 offset:1792
    s_waitcnt lgkmcnt(6)
    v_mfma_f32_16x16x32_bf16 v[84:87], v[44:47], v[144:147], v[84:87]
    ds_read_b128 v[140:143], v157 offset:1856
    s_waitcnt lgkmcnt(6)
    v_mfma_f32_16x16x32_bf16 v[84:87], v[48:51], v[116:119], v[84:87]
    v_mfma_f32_16x16x32_bf16 v[88:91], v[16:19], v[116:119], 0
    ds_read_b128 v[144:147], v157 offset:1920
    ds_read_u16 v10, v164
    s_waitcnt lgkmcnt(7)
    v_mfma_f32_16x16x32_bf16 v[84:87], v[52:55], v[120:123], v[84:87]
    v_mfma_f32_16x16x32_bf16 v[88:91], v[20:23], v[120:123], v[88:91]
    ds_read_b128 v[116:119], v157 offset:1984
    ds_read2_b32 v[20:21], v159 offset0:16 offset1:17
    ds_read2_b32 v[22:23], v159 offset0:18 offset1:19
    s_waitcnt lgkmcnt(9)
    v_mfma_f32_16x16x32_bf16 v[84:87], v[56:59], v[124:127], v[84:87]
    v_mfma_f32_16x16x32_bf16 v[88:91], v[24:27], v[124:127], v[88:91]
    ds_read_b128 v[120:123], v157 offset:2048
    ds_read2_b32 v[24:25], v159 offset0:0 offset1:1
    ds_read2_b32 v[26:27], v159 offset0:2 offset1:3
    s_waitcnt lgkmcnt(11)
    v_mfma_f32_16x16x32_bf16 v[84:87], v[60:63], v[128:131], v[84:87]
    v_mfma_f32_16x16x32_bf16 v[88:91], v[28:31], v[128:131], v[88:91]
    ds_read_b128 v[124:127], v157 offset:2112
    ds_read2_b32 v[28:29], v159 offset0:80 offset1:81
    ds_read2_b32 v[30:31], v159 offset0:82 offset1:83
    s_waitcnt lgkmcnt(13)
    v_mfma_f32_16x16x32_bf16 v[84:87], v[64:67], v[132:135], v[84:87]
    v_mfma_f32_16x16x32_bf16 v[88:91], v[32:35], v[132:135], v[88:91]
    ds_read_b128 v[128:131], v157 offset:2176
    ds_read2_b32 v[32:33], v159 offset0:64 offset1:65
    ds_read2_b32 v[34:35], v159 offset0:66 offset1:67
    s_waitcnt lgkmcnt(15)
    v_mfma_f32_16x16x32_bf16 v[84:87], v[68:71], v[136:139], v[84:87]
    v_mfma_f32_16x16x32_bf16 v[88:91], v[36:39], v[136:139], v[88:91]
    ds_read_b128 v[132:135], v157 offset:2240
    ds_read2_b32 v[36:37], v160 offset0:24 offset1:25
    ds_read2_b32 v[38:39], v160 offset0:26 offset1:27
    s_waitcnt lgkmcnt(15)
    v_mfma_f32_16x16x32_bf16 v[84:87], v[72:75], v[140:143], v[84:87]
    v_mfma_f32_16x16x32_bf16 v[88:91], v[40:43], v[140:143], v[88:91]
    ds_read_b128 v[136:139], v157 offset:2304
    ds_read2_b32 v[40:41], v160 offset0:120 offset1:121
    ds_read2_b32 v[42:43], v160 offset0:122 offset1:123
    v_mfma_f32_16x16x32_bf16 v[84:87], v[76:79], v[144:147], v[84:87]
    v_mfma_f32_16x16x32_bf16 v[88:91], v[44:47], v[144:147], v[88:91]
    ds_read_b128 v[140:143], v157 offset:2368
    ds_read2_b32 v[44:45], v159 offset0:32 offset1:33
    ds_read2_b32 v[46:47], v159 offset0:34 offset1:35
    s_waitcnt lgkmcnt(15)
    v_mfma_f32_16x16x32_bf16 v[84:87], v[80:83], v[116:119], v[84:87]
    v_mfma_f32_16x16x32_bf16 v[88:91], v[48:51], v[116:119], v[88:91]
    ds_read_b32 v152, v156
    ds_read_b128 v[144:147], v157 offset:2432
    ds_read2_b32 v[48:49], v159 offset0:96 offset1:97
    ds_read2_b32 v[50:51], v159 offset0:98 offset1:99
    v_mfma_f32_16x16x32_bf16 v[88:91], v[52:55], v[120:123], v[88:91]
    ds_read_b128 v[116:119], v157 offset:2496
    s_waitcnt lgkmcnt(15)
    v_mfma_f32_16x16x32_bf16 v[88:91], v[56:59], v[124:127], v[88:91]
    ds_read_b128 v[120:123], v157 offset:448
    v_mfma_f32_16x16x32_bf16 v[88:91], v[60:63], v[128:131], v[88:91]
    s_waitcnt lgkmcnt(5)
    v_cmp_ne_u32 vcc, 1, v152
    s_nop 1
    s_and_b32 s35, vcc_lo, 15
    s_nop 2
    s_cbranch_scc0 sok_75
    s_mov_b32 exec_lo, 0xf
    s_mov_b32 exec_hi, 0x0
    s_mov_b32 s50, 0
sr_76:
    ds_read_b32 v11, v156
    s_add_u32 s50, s50, 1
    s_waitcnt lgkmcnt(0)
    v_cmp_ne_u32 vcc, 1, v11
    s_cmp_gt_u32 s50, 2000000
    s_nop 3
    s_cbranch_scc1 sr_77
    s_cbranch_vccz sr_77
    s_sleep 1
    s_branch sr_76
sr_77:
    s_mov_b64 exec, -1
sok_75:
    ds_read_b64_tr_b16 v[124:125], v161 offset:0
    ds_read_b64_tr_b16 v[126:127], v161 offset:80
    v_mfma_f32_16x16x32_bf16 v[88:91], v[64:67], v[132:135], v[88:91]
    ds_read_b64_tr_b16 v[128:129], v161 offset:3880
    ds_read_b64_tr_b16 v[130:131], v161 offset:3960
    v_mfma_f32_16x16x32_bf16 v[88:91], v[68:71], v[136:139], v[88:91]
    ds_read_b64_tr_b16 v[132:133], v162 offset:7760
    ds_read_b64_tr_b16 v[134:135], v162 offset:7920
    v_mfma_f32_16x16x32_bf16 v[88:91], v[72:75], v[140:143], v[88:91]
    ds_read_b64_tr_b16 v[136:137], v162 offset:10360
    ds_read_b64_tr_b16 v[138:139], v162 offset:10520
    s_waitcnt lgkmcnt(12)
    v_mfma_f32_16x16x32_bf16 v[88:91], v[76:79], v[144:147], v[88:91]
    ds_read_b64_tr_b16 v[140:141], v161 offset:640
    ds_read_b64_tr_b16 v[142:143], v161 offset:720
    s_waitcnt lgkmcnt(11)
    v_mfma_f32_16x16x32_bf16 v[88:91], v[80:83], v[116:119], v[88:91]
    ds_read_b64_tr_b16 v[144:145], v161 offset:4520
    ds_read_b64_tr_b16 v[146:147], v161 offset:4600
    v_lshl_or_b32 v10, v10, 16, v10
    s_waitcnt vmcnt(0)
    v_and_b32 v16, v10, v12
    v_and_b32 v17, v10, v13
    v_and_b32 v18, v10, v14
    v_and_b32 v19, v10, v15
    s_waitcnt lgkmcnt(12)
    s_nop 0
    v_mfma_f32_16x16x32_bf16 v[88:91], v[16:19], v[120:123], v[88:91]
    ds_read_b64_tr_b16 v[116:117], v161 offset:1280
    ds_read_b64_tr_b16 v[118:119], v161 offset:1360
    s_waitcnt lgkmcnt(12)
    v_mfma_f32_16x16x32_bf16 v[84:87], v[124:127], v[20:23], v[84:87]
    v_mfma_f32_16x16x32_bf16 v[88:91], v[124:127], v[24:27], v[88:91]
    ds_read_b64_tr_b16 v[120:121], v161 offset:5160
    ds_read_b64_tr_b16 v[122:123], v161 offset:5240
    s_waitcnt lgkmcnt(12)
    v_mfma_f32_16x16x32_bf16 v[84:87], v[128:131], v[28:31], v[84:87]
    v_mfma_f32_16x16x32_bf16 v[88:91], v[128:131], v[32:35], v[88:91]
    s_waitcnt lgkmcnt(10)
    v_mfma_f32_16x16x32_bf16 v[88:91], v[132:135], v[36:39], v[88:91]
    s_waitcnt lgkmcnt(8)
    v_mfma_f32_16x16x32_bf16 v[88:91], v[136:139], v[40:43], v[88:91]
    s_waitcnt lgkmcnt(6)
    v_mfma_f32_16x16x32_bf16 v[84:87], v[140:143], v[44:47], v[84:87]
    v_mfma_f32_16x16x32_bf16 v[88:91], v[140:143], v[20:23], v[88:91]
    s_waitcnt lgkmcnt(4)
    v_mfma_f32_16x16x32_bf16 v[84:87], v[144:147], v[48:51], v[84:87]
    v_mfma_f32_16x16x32_bf16 v[88:91], v[144:147], v[28:31], v[88:91]
    s_waitcnt lgkmcnt(2)
    v_mfma_f32_16x16x32_bf16 v[88:91], v[116:119], v[44:47], v[88:91]
    s_waitcnt lgkmcnt(0)
    v_mfma_f32_16x16x32_bf16 v[88:91], v[120:123], v[48:51], v[88:91]
    s_nop 2
    v_cvt_pk_bf16_f32 v84, v84, v85
    v_cvt_pk_bf16_f32 v85, v86, v87
    ds_write_b64 v154, v[84:85] offset:0
    s_nop 1
    v_cvt_pk_bf16_f32 v88, v88, v89
    v_cvt_pk_bf16_f32 v89, v90, v91
    ds_write_b64 v154, v[88:89] offset:512
    ds_read_b128 v[84:87], v153 offset:0
    s_waitcnt lgkmcnt(0)
    v_min_u32 v84, -2, v84
    s_cmp_eq_u32 s98, 0
    s_nop 0
    s_cbranch_scc1 snd_78
    s_add_u32 s55, s54, 989184
    buffer_store_dwordx4 v[84:87], v163, s[8:11], s55 offen nt
    s_nop 1
    s_branch snd_79
snd_78:
    s_add_u32 s55, s54, 989184
    buffer_store_dwordx4 v[84:87], v163, s[8:11], s55 offen sc1
    s_nop 1
snd_79:
    s_branch B_cdone
B_pre:
    s_lshl_b32 s15, s31, 8
    s_add_u32 s15, s15, 256
    s_load_dword s59, s[8:9], s15
    buffer_load_dwordx4 v[16:19], v11, s[24:27], s35 offen offset:0
    buffer_load_dwordx4 v[20:23], v11, s[24:27], s35 offen offset:1024
    buffer_load_dwordx4 v[24:27], v11, s[24:27], s35 offen offset:2048
    buffer_load_dwordx4 v[28:31], v11, s[24:27], s35 offen offset:3072
    s_setprio 2
    s_cmp_lt_u32 s28, 10
    s_cbranch_scc1 B_noann
    v_mov_b32 v88, -1
    v_mov_b32 v89, -1
    v_mov_b32 v90, -1
    v_mov_b32 v91, -1
    s_sub_u32 s14, s28, 10
    s_lshl_b32 s14, s14, 11
    s_add_u32 s14, s14, s57
    s_cmp_eq_u32 s98, 0
    s_cbranch_scc1 snd_80
    buffer_store_dwordx4 v[88:91], v95, s[8:11], s14 offen offset:0
    buffer_store_dwordx4 v[88:91], v95, s[8:11], s14 offen offset:1024
    s_add_u32 s14, s14, 4096
    buffer_store_dwordx4 v[88:91], v95, s[8:11], s14 offen offset:0
    buffer_store_dwordx4 v[88:91], v95, s[8:11], s14 offen offset:1024
    s_add_u32 s14, s14, 4096
    buffer_store_dwordx4 v[88:91], v95, s[8:11], s14 offen offset:0
    buffer_store_dwordx4 v[88:91], v95, s[8:11], s14 offen offset:1024
    s_add_u32 s14, s14, 4096
    buffer_store_dwordx4 v[88:91], v95, s[8:11], s14 offen offset:0
    buffer_store_dwordx4 v[88:91], v95, s[8:11], s14 offen offset:1024
    s_add_u32 s14, s14, 4096
    buffer_store_dwordx4 v[88:91], v95, s[8:11], s14 offen offset:0
    buffer_store_dwordx4 v[88:91], v95, s[8:11], s14 offen offset:1024
    s_nop 1
    s_branch snd_81
snd_80:
    buffer_store_dwordx4 v[88:91], v95, s[8:11], s14 offen offset:0 sc1
    buffer_store_dwordx4 v[88:91], v95, s[8:11], s14 offen offset:1024 sc1
    s_add_u32 s14, s14, 4096
    buffer_store_dwordx4 v[88:91], v95, s[8:11], s14 offen offset:0 sc1
    buffer_store_dwordx4 v[88:91], v95, s[8:11], s14 offen offset:1024 sc1
    s_add_u32 s14, s14, 4096
    buffer_store_dwordx4 v[88:91], v95, s[8:11], s14 offen offset:0 sc1
    buffer_store_dwordx4 v[88:91], v95, s[8:11], s14 offen offset:1024 sc1
    s_add_u32 s14, s14, 4096
    buffer_store_dwordx4 v[88:91], v95, s[8:11], s14 offen offset:0 sc1
    buffer_store_dwordx4 v[88:91], v95, s[8:11], s14 offen offset:1024 sc1
    s_add_u32 s14, s14, 4096
    buffer_store_dwordx4 v[88:91], v95, s[8:11], s14 offen offset:0 sc1
    buffer_store_dwordx4 v[88:91], v95, s[8:11], s14 offen offset:1024 sc1
    s_nop 1
snd_81:
B_noann:
    v_lshlrev_b32 v4, 5, v2
    v_lshl_add_u32 v4, v3, 4, v4
    v_add_u32 v4, 69568, v4
    v_mul_u32_u24 v5, 40, v2
    v_lshl_add_u32 v6, v3, 3, v5
    v_add_u32 v5, 16, v6
    v_add_u32 v7, 24, v6
    v_cmp_gt_u32 vcc, 2, v3
    s_nop 1
    v_cndmask_b32 v5, v7, v5, vcc
    v_mov_b32 v8, 0
    v_mov_b32 v9, 0
    v_mul_u32_u24 v10, 43, v1
    v_lshrrev_b32 v10, 8, v10
    v_mul_u32_u24 v11, 6, v10
    v_sub_u32 v11, v1, v11
    v_mul_u32_u24 v10, 12920, v10
    v_lshrrev_b32 v12, 1, v11
    v_mul_u32_u24 v12, 3880, v12
    v_and_b32 v11, 1, v11
    v_lshl_add_u32 v10, v11, 3, v10
    v_add_u32 v10, v10, v12
    v_mov_b32 v13, v10
    s_mov_b32 exec_lo, 0xfff
    s_mov_b32 exec_hi, 0x0
    s_mov_b32 s50, 0
aw_82:
    ds_read_b32 v11, v155
    s_add_u32 s50, s50, 1
    s_waitcnt lgkmcnt(0)
    v_cmp_ne_u32 vcc, 1, v11
    s_cmp_gt_u32 s50, 2000000
    s_nop 3
    s_cbranch_scc1 aw_83
    s_cbranch_vccz aw_83
    s_sleep 1
    s_branch aw_82
aw_83:
    s_mov_b64 exec, -1
    v_mov_b32 v10, 141176
    ds_read_b32 v10, v10
    s_waitcnt lgkmcnt(0)
    v_readfirstlane_b32 s98, v10
    s_nop 1
    s_mov_b32 s99, s98
    s_not_b64 s[100:101], s[98:99]
    s_mov_b32 exec_lo, 0x3fffffff
    s_mov_b32 exec_hi, 0x0
    ds_write_b64 v13, v[8:9]
    s_mov_b64 exec, -1
    s_cmp_lg_u32 s28, 8
    s_cbranch_scc1 B_pre1
    ds_read_b128 v[32:35], v4 offset:0
    ds_read_b128 v[36:39], v4 offset:18432
    ds_read_b128 v[40:43], v4 offset:14336
    ds_read_b128 v[44:47], v4 offset:10240
    ds_read_b128 v[48:51], v4 offset:6144
    ds_read_b128 v[52:55], v4 offset:15872
    ds_read_b128 v[56:59], v4 offset:11776
    s_waitcnt vmcnt(3) lgkmcnt(6)
    v_mfma_f32_16x16x32_bf16 v[64:67], v[16:19], v[32:35], 0
    s_waitcnt vmcnt(2)
    v_mfma_f32_16x16x32_bf16 v[68:71], v[20:23], v[32:35], 0
    s_waitcnt vmcnt(1)
    v_mfma_f32_16x16x32_bf16 v[72:75], v[24:27], v[32:35], 0
    s_nop 3
    v_cvt_pk_bf16_f32 v128, v64, v65
    v_cvt_pk_bf16_f32 v129, v66, v67
    s_waitcnt vmcnt(0)
    v_mfma_f32_16x16x32_bf16 v[76:79], v[28:31], v[32:35], 0
    v_cvt_pk_bf16_f32 v130, v68, v69
    v_cvt_pk_bf16_f32 v131, v70, v71
    s_waitcnt lgkmcnt(5)
    v_mfma_f32_16x16x32_bf16 v[80:83], v[16:19], v[36:39], 0
    v_cvt_pk_bf16_f32 v132, v72, v73
    v_cvt_pk_bf16_f32 v133, v74, v75
    v_mfma_f32_16x16x32_bf16 v[84:87], v[20:23], v[36:39], 0
    s_nop 0
    v_cvt_pk_bf16_f32 v134, v76, v77
    v_cvt_pk_bf16_f32 v135, v78, v79
    v_mfma_f32_16x16x32_bf16 v[88:91], v[24:27], v[36:39], 0
    s_nop 0
    v_cvt_pk_bf16_f32 v136, v80, v81
    v_cvt_pk_bf16_f32 v137, v82, v83
    v_mfma_f32_16x16x32_bf16 v[92:95], v[28:31], v[36:39], 0
    v_cvt_pk_bf16_f32 v138, v84, v85
    v_cvt_pk_bf16_f32 v139, v86, v87
    s_waitcnt lgkmcnt(4)
    v_mfma_f32_16x16x32_bf16 v[96:99], v[16:19], v[40:43], 0
    v_cvt_pk_bf16_f32 v140, v88, v89
    v_cvt_pk_bf16_f32 v141, v90, v91
    v_mfma_f32_16x16x32_bf16 v[100:103], v[20:23], v[40:43], 0
    s_nop 0
    v_cvt_pk_bf16_f32 v142, v92, v93
    v_cvt_pk_bf16_f32 v143, v94, v95
    v_mfma_f32_16x16x32_bf16 v[104:107], v[24:27], v[40:43], 0
    ds_write_b64 v5, v[128:129] offset:0
    ds_write_b64 v5, v[130:131] offset:3880
    v_mfma_f32_16x16x32_bf16 v[108:111], v[28:31], v[40:43], 0
    ds_write_b64 v5, v[132:133] offset:7760
    ds_write_b64 v6, v[134:135] offset:10360
    s_waitcnt lgkmcnt(7)
    v_mfma_f32_16x16x32_bf16 v[112:115], v[16:19], v[44:47], 0
    ds_write_b64 v5, v[136:137] offset:51680
    ds_write_b64 v5, v[138:139] offset:55560
    v_mfma_f32_16x16x32_bf16 v[116:119], v[20:23], v[44:47], 0
    ds_write_b64 v5, v[140:141] offset:59440
    ds_write_b64 v6, v[142:143] offset:62040
    v_mfma_f32_16x16x32_bf16 v[120:123], v[24:27], v[44:47], 0
    v_cvt_pk_bf16_f32 v128, v96, v97
    v_cvt_pk_bf16_f32 v129, v98, v99
    v_mfma_f32_16x16x32_bf16 v[124:127], v[28:31], v[44:47], 0
    v_cvt_pk_bf16_f32 v130, v100, v101
    v_cvt_pk_bf16_f32 v131, v102, v103
    s_waitcnt lgkmcnt(10)
    v_mfma_f32_16x16x32_bf16 v[64:67], v[16:19], v[48:51], 0
    v_cvt_pk_bf16_f32 v132, v104, v105
    v_cvt_pk_bf16_f32 v133, v106, v107
    v_mfma_f32_16x16x32_bf16 v[68:71], v[20:23], v[48:51], 0
    v_cvt_pk_bf16_f32 v134, v108, v109
    v_cvt_pk_bf16_f32 v135, v110, v111
    v_mfma_f32_16x16x32_bf16 v[72:75], v[24:27], v[48:51], 0
    v_cvt_pk_bf16_f32 v136, v112, v113
    v_cvt_pk_bf16_f32 v137, v114, v115
    v_mfma_f32_16x16x32_bf16 v[76:79], v[28:31], v[48:51], 0
    v_cvt_pk_bf16_f32 v138, v116, v117
    v_cvt_pk_bf16_f32 v139, v118, v119
    s_waitcnt lgkmcnt(9)
    v_mfma_f32_16x16x32_bf16 v[80:83], v[16:19], v[52:55], 0
    v_cvt_pk_bf16_f32 v140, v120, v121
    v_cvt_pk_bf16_f32 v141, v122, v123
    v_mfma_f32_16x16x32_bf16 v[84:87], v[20:23], v[52:55], 0
    v_cvt_pk_bf16_f32 v142, v124, v125
    v_cvt_pk_bf16_f32 v143, v126, v127
    s_waitcnt lgkmcnt(8)
    v_mfma_f32_16x16x32_bf16 v[88:91], v[16:19], v[56:59], 0
    ds_write_b64 v5, v[128:129] offset:39400
    ds_write_b64 v5, v[130:131] offset:43280
    v_mfma_f32_16x16x32_bf16 v[92:95], v[20:23], v[56:59], 0
    ds_write_b64 v5, v[132:133] offset:47160
    ds_write_b64 v6, v[134:135] offset:49760
    ds_write_b64 v5, v[136:137] offset:27120
    ds_write_b64 v5, v[138:139] offset:31000
    ds_write_b64 v5, v[140:141] offset:34880
    ds_write_b64 v6, v[142:143] offset:37480
    v_cvt_pk_bf16_f32 v128, v64, v65
    v_cvt_pk_bf16_f32 v129, v66, v67
    v_cvt_pk_bf16_f32 v130, v68, v69
    v_cvt_pk_bf16_f32 v131, v70, v71
    v_cvt_pk_bf16_f32 v132, v72, v73
    v_cvt_pk_bf16_f32 v133, v74, v75
    v_cvt_pk_bf16_f32 v134, v76, v77
    v_cvt_pk_bf16_f32 v135, v78, v79
    v_cvt_pk_bf16_f32 v136, v80, v81
    v_cvt_pk_bf16_f32 v137, v82, v83
    v_cvt_pk_bf16_f32 v138, v84, v85
    v_cvt_pk_bf16_f32 v139, v86, v87
    v_cvt_pk_bf16_f32 v140, v88, v89
    v_cvt_pk_bf16_f32 v141, v90, v91
    v_cvt_pk_bf16_f32 v142, v92, v93
    v_cvt_pk_bf16_f32 v143, v94, v95
    ds_write_b64 v5, v[128:129] offset:14840
    ds_write_b64 v5, v[130:131] offset:18720
    ds_write_b64 v5, v[132:133] offset:22600
    ds_write_b64 v6, v[134:135] offset:25200
    ds_write_b64 v5, v[136:137] offset:41320
    ds_write_b64 v5, v[138:139] offset:45200
    ds_write_b64 v5, v[140:141] offset:29040
    ds_write_b64 v5, v[142:143] offset:32920
    s_branch B_pre_done
B_pre1:
    s_cmp_lg_u32 s28, 9
    s_cbranch_scc1 B_pre2
    ds_read_b128 v[32:35], v4 offset:4608
    ds_read_b128 v[36:39], v4 offset:512
    ds_read_b128 v[40:43], v4 offset:18944
    ds_read_b128 v[44:47], v4 offset:14848
    ds_read_b128 v[48:51], v4 offset:10752
    ds_read_b128 v[52:55], v4 offset:2048
    ds_read_b128 v[56:59], v4 offset:20480
    ds_read_b128 v[60:63], v4 offset:16384
    s_waitcnt vmcnt(3) lgkmcnt(7)
    v_mfma_f32_16x16x32_bf16 v[64:67], v[16:19], v[32:35], 0
    s_waitcnt vmcnt(2)
    v_mfma_f32_16x16x32_bf16 v[68:71], v[20:23], v[32:35], 0
    s_waitcnt vmcnt(1)
    v_mfma_f32_16x16x32_bf16 v[72:75], v[24:27], v[32:35], 0
    s_nop 3
    v_cvt_pk_bf16_f32 v128, v64, v65
    v_cvt_pk_bf16_f32 v129, v66, v67
    s_waitcnt vmcnt(0)
    v_mfma_f32_16x16x32_bf16 v[76:79], v[28:31], v[32:35], 0
    v_cvt_pk_bf16_f32 v130, v68, v69
    v_cvt_pk_bf16_f32 v131, v70, v71
    s_waitcnt lgkmcnt(6)
    v_mfma_f32_16x16x32_bf16 v[80:83], v[16:19], v[36:39], 0
    ds_write_b64 v5, v[128:129] offset:12920
    ds_write_b64 v5, v[130:131] offset:16800
    v_mfma_f32_16x16x32_bf16 v[84:87], v[20:23], v[36:39], 0
    v_cvt_pk_bf16_f32 v132, v72, v73
    v_cvt_pk_bf16_f32 v133, v74, v75
    v_mfma_f32_16x16x32_bf16 v[88:91], v[24:27], v[36:39], 0
    v_cvt_pk_bf16_f32 v134, v76, v77
    v_cvt_pk_bf16_f32 v135, v78, v79
    v_mfma_f32_16x16x32_bf16 v[92:95], v[28:31], v[36:39], 0
    v_cvt_pk_bf16_f32 v136, v80, v81
    v_cvt_pk_bf16_f32 v137, v82, v83
    s_waitcnt lgkmcnt(7)
    v_mfma_f32_16x16x32_bf16 v[96:99], v[16:19], v[40:43], 0
    v_cvt_pk_bf16_f32 v138, v84, v85
    v_cvt_pk_bf16_f32 v139, v86, v87
    v_mfma_f32_16x16x32_bf16 v[100:103], v[20:23], v[40:43], 0
    v_cvt_pk_bf16_f32 v140, v88, v89
    v_cvt_pk_bf16_f32 v141, v90, v91
    v_mfma_f32_16x16x32_bf16 v[104:107], v[24:27], v[40:43], 0
    v_cvt_pk_bf16_f32 v142, v92, v93
    v_cvt_pk_bf16_f32 v143, v94, v95
    v_mfma_f32_16x16x32_bf16 v[108:111], v[28:31], v[40:43], 0
    v_cvt_pk_bf16_f32 v128, v96, v97
    v_cvt_pk_bf16_f32 v129, v98, v99
    s_waitcnt lgkmcnt(6)
    v_mfma_f32_16x16x32_bf16 v[112:115], v[16:19], v[44:47], 0
    v_cvt_pk_bf16_f32 v130, v100, v101
    v_cvt_pk_bf16_f32 v131, v102, v103
    v_mfma_f32_16x16x32_bf16 v[116:119], v[20:23], v[44:47], 0
    ds_write_b64 v5, v[132:133] offset:20680
    ds_write_b64 v6, v[134:135] offset:23280
    v_mfma_f32_16x16x32_bf16 v[120:123], v[24:27], v[44:47], 0
    ds_write_b64 v5, v[136:137] offset:640
    ds_write_b64 v5, v[138:139] offset:4520
    v_mfma_f32_16x16x32_bf16 v[124:127], v[28:31], v[44:47], 0
    ds_write_b64 v5, v[140:141] offset:8400
    ds_write_b64 v6, v[142:143] offset:11000
    s_waitcnt lgkmcnt(11)
    v_mfma_f32_16x16x32_bf16 v[64:67], v[16:19], v[48:51], 0
    ds_write_b64 v5, v[128:129] offset:52320
    ds_write_b64 v5, v[130:131] offset:56200
    v_mfma_f32_16x16x32_bf16 v[68:71], v[20:23], v[48:51], 0
    v_cvt_pk_bf16_f32 v132, v104, v105
    v_cvt_pk_bf16_f32 v133, v106, v107
    v_mfma_f32_16x16x32_bf16 v[72:75], v[24:27], v[48:51], 0
    v_cvt_pk_bf16_f32 v134, v108, v109
    v_cvt_pk_bf16_f32 v135, v110, v111
    v_mfma_f32_16x16x32_bf16 v[76:79], v[28:31], v[48:51], 0
    v_cvt_pk_bf16_f32 v136, v112, v113
    v_cvt_pk_bf16_f32 v137, v114, v115
    s_waitcnt lgkmcnt(12)
    v_mfma_f32_16x16x32_bf16 v[80:83], v[16:19], v[52:55], 0
    v_cvt_pk_bf16_f32 v138, v116, v117
    v_cvt_pk_bf16_f32 v139, v118, v119
    v_mfma_f32_16x16x32_bf16 v[84:87], v[20:23], v[52:55], 0
    v_cvt_pk_bf16_f32 v140, v120, v121
    v_cvt_pk_bf16_f32 v141, v122, v123
    s_waitcnt lgkmcnt(11)
    v_mfma_f32_16x16x32_bf16 v[88:91], v[16:19], v[56:59], 0
    v_cvt_pk_bf16_f32 v142, v124, v125
    v_cvt_pk_bf16_f32 v143, v126, v127
    v_mfma_f32_16x16x32_bf16 v[92:95], v[20:23], v[56:59], 0
    v_cvt_pk_bf16_f32 v128, v64, v65
    v_cvt_pk_bf16_f32 v129, v66, v67
    s_waitcnt lgkmcnt(10)
    v_mfma_f32_16x16x32_bf16 v[96:99], v[16:19], v[60:63], 0
    v_cvt_pk_bf16_f32 v130, v68, v69
    v_cvt_pk_bf16_f32 v131, v70, v71
    v_mfma_f32_16x16x32_bf16 v[100:103], v[20:23], v[60:63], 0
    ds_write_b64 v5, v[132:133] offset:60080
    ds_write_b64 v6, v[134:135] offset:62680
    ds_write_b64 v5, v[136:137] offset:40040
    ds_write_b64 v5, v[138:139] offset:43920
    ds_write_b64 v5, v[140:141] offset:47800
    ds_write_b64 v6, v[142:143] offset:50400
    ds_write_b64 v5, v[128:129] offset:27760
    ds_write_b64 v5, v[130:131] offset:31640
    v_cvt_pk_bf16_f32 v132, v72, v73
    v_cvt_pk_bf16_f32 v133, v74, v75
    v_cvt_pk_bf16_f32 v134, v76, v77
    v_cvt_pk_bf16_f32 v135, v78, v79
    v_cvt_pk_bf16_f32 v136, v80, v81
    v_cvt_pk_bf16_f32 v137, v82, v83
    v_cvt_pk_bf16_f32 v138, v84, v85
    v_cvt_pk_bf16_f32 v139, v86, v87
    v_cvt_pk_bf16_f32 v140, v88, v89
    v_cvt_pk_bf16_f32 v141, v90, v91
    v_cvt_pk_bf16_f32 v142, v92, v93
    v_cvt_pk_bf16_f32 v143, v94, v95
    v_cvt_pk_bf16_f32 v128, v96, v97
    v_cvt_pk_bf16_f32 v129, v98, v99
    v_cvt_pk_bf16_f32 v130, v100, v101
    v_cvt_pk_bf16_f32 v131, v102, v103
    ds_write_b64 v5, v[132:133] offset:35520
    ds_write_b64 v6, v[134:135] offset:38120
    ds_write_b64 v5, v[136:137] offset:2560
    ds_write_b64 v5, v[138:139] offset:6440
    ds_write_b64 v5, v[140:141] offset:54240
    ds_write_b64 v5, v[142:143] offset:58120
    ds_write_b64 v5, v[128:129] offset:41960
    ds_write_b64 v5, v[130:131] offset:45840
    s_branch B_pre_done
B_pre2:
    s_cmp_lg_u32 s28, 10
    s_cbranch_scc1 B_pre3
    ds_read_b128 v[32:35], v4 offset:9216
    ds_read_b128 v[36:39], v4 offset:5120
    ds_read_b128 v[40:43], v4 offset:1024
    ds_read_b128 v[44:47], v4 offset:19456
    ds_read_b128 v[48:51], v4 offset:15360
    ds_read_b128 v[52:55], v4 offset:6656
    ds_read_b128 v[56:59], v4 offset:2560
    ds_read_b128 v[60:63], v4 offset:20992
    s_waitcnt vmcnt(3) lgkmcnt(7)
    v_mfma_f32_16x16x32_bf16 v[64:67], v[16:19], v[32:35], 0
    s_waitcnt vmcnt(2)
    v_mfma_f32_16x16x32_bf16 v[68:71], v[20:23], v[32:35], 0
    s_waitcnt vmcnt(1)
    v_mfma_f32_16x16x32_bf16 v[72:75], v[24:27], v[32:35], 0
    s_nop 3
    v_cvt_pk_bf16_f32 v128, v64, v65
    v_cvt_pk_bf16_f32 v129, v66, v67
    s_waitcnt vmcnt(0)
    v_mfma_f32_16x16x32_bf16 v[76:79], v[28:31], v[32:35], 0
    v_cvt_pk_bf16_f32 v130, v68, v69
    v_cvt_pk_bf16_f32 v131, v70, v71
    s_waitcnt lgkmcnt(6)
    v_mfma_f32_16x16x32_bf16 v[80:83], v[16:19], v[36:39], 0
    ds_write_b64 v5, v[128:129] offset:25840
    ds_write_b64 v5, v[130:131] offset:29720
    v_mfma_f32_16x16x32_bf16 v[84:87], v[20:23], v[36:39], 0
    v_cvt_pk_bf16_f32 v132, v72, v73
    v_cvt_pk_bf16_f32 v133, v74, v75
    v_mfma_f32_16x16x32_bf16 v[88:91], v[24:27], v[36:39], 0
    v_cvt_pk_bf16_f32 v134, v76, v77
    v_cvt_pk_bf16_f32 v135, v78, v79
    v_mfma_f32_16x16x32_bf16 v[92:95], v[28:31], v[36:39], 0
    v_cvt_pk_bf16_f32 v136, v80, v81
    v_cvt_pk_bf16_f32 v137, v82, v83
    s_waitcnt lgkmcnt(7)
    v_mfma_f32_16x16x32_bf16 v[96:99], v[16:19], v[40:43], 0
    v_cvt_pk_bf16_f32 v138, v84, v85
    v_cvt_pk_bf16_f32 v139, v86, v87
    v_mfma_f32_16x16x32_bf16 v[100:103], v[20:23], v[40:43], 0
    v_cvt_pk_bf16_f32 v140, v88, v89
    v_cvt_pk_bf16_f32 v141, v90, v91
    v_mfma_f32_16x16x32_bf16 v[104:107], v[24:27], v[40:43], 0
    v_cvt_pk_bf16_f32 v142, v92, v93
    v_cvt_pk_bf16_f32 v143, v94, v95
    v_mfma_f32_16x16x32_bf16 v[108:111], v[28:31], v[40:43], 0
    v_cvt_pk_bf16_f32 v128, v96, v97
    v_cvt_pk_bf16_f32 v129, v98, v99
    s_waitcnt lgkmcnt(6)
    v_mfma_f32_16x16x32_bf16 v[112:115], v[16:19], v[44:47], 0
    v_cvt_pk_bf16_f32 v130, v100, v101
    v_cvt_pk_bf16_f32 v131, v102, v103
    v_mfma_f32_16x16x32_bf16 v[116:119], v[20:23], v[44:47], 0
    ds_write_b64 v5, v[132:133] offset:33600
    ds_write_b64 v6, v[134:135] offset:36200
    v_mfma_f32_16x16x32_bf16 v[120:123], v[24:27], v[44:47], 0
    ds_write_b64 v5, v[136:137] offset:13560
    ds_write_b64 v5, v[138:139] offset:17440
    v_mfma_f32_16x16x32_bf16 v[124:127], v[28:31], v[44:47], 0
    ds_write_b64 v5, v[140:141] offset:21320
    ds_write_b64 v6, v[142:143] offset:23920
    s_waitcnt lgkmcnt(11)
    v_mfma_f32_16x16x32_bf16 v[64:67], v[16:19], v[48:51], 0
    ds_write_b64 v5, v[128:129] offset:1280
    ds_write_b64 v5, v[130:131] offset:5160
    v_mfma_f32_16x16x32_bf16 v[68:71], v[20:23], v[48:51], 0
    v_cvt_pk_bf16_f32 v132, v104, v105
    v_cvt_pk_bf16_f32 v133, v106, v107
    v_mfma_f32_16x16x32_bf16 v[72:75], v[24:27], v[48:51], 0
    v_cvt_pk_bf16_f32 v134, v108, v109
    v_cvt_pk_bf16_f32 v135, v110, v111
    v_mfma_f32_16x16x32_bf16 v[76:79], v[28:31], v[48:51], 0
    v_cvt_pk_bf16_f32 v136, v112, v113
    v_cvt_pk_bf16_f32 v137, v114, v115
    s_waitcnt lgkmcnt(12)
    v_mfma_f32_16x16x32_bf16 v[80:83], v[16:19], v[52:55], 0
    v_cvt_pk_bf16_f32 v138, v116, v117
    v_cvt_pk_bf16_f32 v139, v118, v119
    v_mfma_f32_16x16x32_bf16 v[84:87], v[20:23], v[52:55], 0
    v_cvt_pk_bf16_f32 v140, v120, v121
    v_cvt_pk_bf16_f32 v141, v122, v123
    s_waitcnt lgkmcnt(11)
    v_mfma_f32_16x16x32_bf16 v[88:91], v[16:19], v[56:59], 0
    v_cvt_pk_bf16_f32 v142, v124, v125
    v_cvt_pk_bf16_f32 v143, v126, v127
    v_mfma_f32_16x16x32_bf16 v[92:95], v[20:23], v[56:59], 0
    v_cvt_pk_bf16_f32 v128, v64, v65
    v_cvt_pk_bf16_f32 v129, v66, v67
    s_waitcnt lgkmcnt(10)
    v_mfma_f32_16x16x32_bf16 v[96:99], v[16:19], v[60:63], 0
    v_cvt_pk_bf16_f32 v130, v68, v69
    v_cvt_pk_bf16_f32 v131, v70, v71
    v_mfma_f32_16x16x32_bf16 v[100:103], v[20:23], v[60:63], 0
    ds_write_b64 v5, v[132:133] offset:9040
    ds_write_b64 v6, v[134:135] offset:11640
    ds_write_b64 v5, v[136:137] offset:52960
    ds_write_b64 v5, v[138:139] offset:56840
    ds_write_b64 v5, v[140:141] offset:60720
    ds_write_b64 v6, v[142:143] offset:63320
    ds_write_b64 v5, v[128:129] offset:40680
    ds_write_b64 v5, v[130:131] offset:44560
    v_cvt_pk_bf16_f32 v132, v72, v73
    v_cvt_pk_bf16_f32 v133, v74, v75
    v_cvt_pk_bf16_f32 v134, v76, v77
    v_cvt_pk_bf16_f32 v135, v78, v79
    v_cvt_pk_bf16_f32 v136, v80, v81
    v_cvt_pk_bf16_f32 v137, v82, v83
    v_cvt_pk_bf16_f32 v138, v84, v85
    v_cvt_pk_bf16_f32 v139, v86, v87
    v_cvt_pk_bf16_f32 v140, v88, v89
    v_cvt_pk_bf16_f32 v141, v90, v91
    v_cvt_pk_bf16_f32 v142, v92, v93
    v_cvt_pk_bf16_f32 v143, v94, v95
    v_cvt_pk_bf16_f32 v128, v96, v97
    v_cvt_pk_bf16_f32 v129, v98, v99
    v_cvt_pk_bf16_f32 v130, v100, v101
    v_cvt_pk_bf16_f32 v131, v102, v103
    ds_write_b64 v5, v[132:133] offset:48440
    ds_write_b64 v6, v[134:135] offset:51040
    ds_write_b64 v5, v[136:137] offset:15480
    ds_write_b64 v5, v[138:139] offset:19360
    ds_write_b64 v5, v[140:141] offset:3200
    ds_write_b64 v5, v[142:143] offset:7080
    ds_write_b64 v5, v[128:129] offset:54880
    ds_write_b64 v5, v[130:131] offset:58760
    s_branch B_pre_done
B_pre3:
    ds_read_b128 v[32:35], v4 offset:13824
    ds_read_b128 v[36:39], v4 offset:9728
    ds_read_b128 v[40:43], v4 offset:5632
    ds_read_b128 v[44:47], v4 offset:1536
    ds_read_b128 v[48:51], v4 offset:19968
    ds_read_b128 v[52:55], v4 offset:11264
    ds_read_b128 v[56:59], v4 offset:7168
    s_waitcnt vmcnt(3) lgkmcnt(6)
    v_mfma_f32_16x16x32_bf16 v[64:67], v[16:19], v[32:35], 0
    s_waitcnt vmcnt(2)
    v_mfma_f32_16x16x32_bf16 v[68:71], v[20:23], v[32:35], 0
    s_waitcnt vmcnt(1)
    v_mfma_f32_16x16x32_bf16 v[72:75], v[24:27], v[32:35], 0
    s_nop 3
    v_cvt_pk_bf16_f32 v128, v64, v65
    v_cvt_pk_bf16_f32 v129, v66, v67
    s_waitcnt vmcnt(0)
    v_mfma_f32_16x16x32_bf16 v[76:79], v[28:31], v[32:35], 0
    v_cvt_pk_bf16_f32 v130, v68, v69
    v_cvt_pk_bf16_f32 v131, v70, v71
    s_waitcnt lgkmcnt(5)
    v_mfma_f32_16x16x32_bf16 v[80:83], v[16:19], v[36:39], 0
    v_cvt_pk_bf16_f32 v132, v72, v73
    v_cvt_pk_bf16_f32 v133, v74, v75
    v_mfma_f32_16x16x32_bf16 v[84:87], v[20:23], v[36:39], 0
    s_nop 0
    v_cvt_pk_bf16_f32 v134, v76, v77
    v_cvt_pk_bf16_f32 v135, v78, v79
    v_mfma_f32_16x16x32_bf16 v[88:91], v[24:27], v[36:39], 0
    s_nop 0
    v_cvt_pk_bf16_f32 v136, v80, v81
    v_cvt_pk_bf16_f32 v137, v82, v83
    v_mfma_f32_16x16x32_bf16 v[92:95], v[28:31], v[36:39], 0
    v_cvt_pk_bf16_f32 v138, v84, v85
    v_cvt_pk_bf16_f32 v139, v86, v87
    s_waitcnt lgkmcnt(4)
    v_mfma_f32_16x16x32_bf16 v[96:99], v[16:19], v[40:43], 0
    v_cvt_pk_bf16_f32 v140, v88, v89
    v_cvt_pk_bf16_f32 v141, v90, v91
    v_mfma_f32_16x16x32_bf16 v[100:103], v[20:23], v[40:43], 0
    s_nop 0
    v_cvt_pk_bf16_f32 v142, v92, v93
    v_cvt_pk_bf16_f32 v143, v94, v95
    v_mfma_f32_16x16x32_bf16 v[104:107], v[24:27], v[40:43], 0
    ds_write_b64 v5, v[128:129] offset:38760
    ds_write_b64 v5, v[130:131] offset:42640
    v_mfma_f32_16x16x32_bf16 v[108:111], v[28:31], v[40:43], 0
    ds_write_b64 v5, v[132:133] offset:46520
    ds_write_b64 v6, v[134:135] offset:49120
    s_waitcnt lgkmcnt(7)
    v_mfma_f32_16x16x32_bf16 v[112:115], v[16:19], v[44:47], 0
    ds_write_b64 v5, v[136:137] offset:26480
    ds_write_b64 v5, v[138:139] offset:30360
    v_mfma_f32_16x16x32_bf16 v[116:119], v[20:23], v[44:47], 0
    ds_write_b64 v5, v[140:141] offset:34240
    ds_write_b64 v6, v[142:143] offset:36840
    v_mfma_f32_16x16x32_bf16 v[120:123], v[24:27], v[44:47], 0
    v_cvt_pk_bf16_f32 v128, v96, v97
    v_cvt_pk_bf16_f32 v129, v98, v99
    v_mfma_f32_16x16x32_bf16 v[124:127], v[28:31], v[44:47], 0
    v_cvt_pk_bf16_f32 v130, v100, v101
    v_cvt_pk_bf16_f32 v131, v102, v103
    s_waitcnt lgkmcnt(10)
    v_mfma_f32_16x16x32_bf16 v[64:67], v[16:19], v[48:51], 0
    v_cvt_pk_bf16_f32 v132, v104, v105
    v_cvt_pk_bf16_f32 v133, v106, v107
    v_mfma_f32_16x16x32_bf16 v[68:71], v[20:23], v[48:51], 0
    v_cvt_pk_bf16_f32 v134, v108, v109
    v_cvt_pk_bf16_f32 v135, v110, v111
    v_mfma_f32_16x16x32_bf16 v[72:75], v[24:27], v[48:51], 0
    v_cvt_pk_bf16_f32 v136, v112, v113
    v_cvt_pk_bf16_f32 v137, v114, v115
    v_mfma_f32_16x16x32_bf16 v[76:79], v[28:31], v[48:51], 0
    v_cvt_pk_bf16_f32 v138, v116, v117
    v_cvt_pk_bf16_f32 v139, v118, v119
    s_waitcnt lgkmcnt(9)
    v_mfma_f32_16x16x32_bf16 v[80:83], v[16:19], v[52:55], 0
    v_cvt_pk_bf16_f32 v140, v120, v121
    v_cvt_pk_bf16_f32 v141, v122, v123
    v_mfma_f32_16x16x32_bf16 v[84:87], v[20:23], v[52:55], 0
    v_cvt_pk_bf16_f32 v142, v124, v125
    v_cvt_pk_bf16_f32 v143, v126, v127
    s_waitcnt lgkmcnt(8)
    v_mfma_f32_16x16x32_bf16 v[88:91], v[16:19], v[56:59], 0
    ds_write_b64 v5, v[128:129] offset:14200
    ds_write_b64 v5, v[130:131] offset:18080
    v_mfma_f32_16x16x32_bf16 v[92:95], v[20:23], v[56:59], 0
    ds_write_b64 v5, v[132:133] offset:21960
    ds_write_b64 v6, v[134:135] offset:24560
    ds_write_b64 v5, v[136:137] offset:1920
    ds_write_b64 v5, v[138:139] offset:5800
    ds_write_b64 v5, v[140:141] offset:9680
    ds_write_b64 v6, v[142:143] offset:12280
    v_cvt_pk_bf16_f32 v128, v64, v65
    v_cvt_pk_bf16_f32 v129, v66, v67
    v_cvt_pk_bf16_f32 v130, v68, v69
    v_cvt_pk_bf16_f32 v131, v70, v71
    v_cvt_pk_bf16_f32 v132, v72, v73
    v_cvt_pk_bf16_f32 v133, v74, v75
    v_cvt_pk_bf16_f32 v134, v76, v77
    v_cvt_pk_bf16_f32 v135, v78, v79
    v_cvt_pk_bf16_f32 v136, v80, v81
    v_cvt_pk_bf16_f32 v137, v82, v83
    v_cvt_pk_bf16_f32 v138, v84, v85
    v_cvt_pk_bf16_f32 v139, v86, v87
    v_cvt_pk_bf16_f32 v140, v88, v89
    v_cvt_pk_bf16_f32 v141, v90, v91
    v_cvt_pk_bf16_f32 v142, v92, v93
    v_cvt_pk_bf16_f32 v143, v94, v95
    ds_write_b64 v5, v[128:129] offset:53600
    ds_write_b64 v5, v[130:131] offset:57480
    ds_write_b64 v5, v[132:133] offset:61360
    ds_write_b64 v6, v[134:135] offset:63960
    ds_write_b64 v5, v[136:137] offset:28400
    ds_write_b64 v5, v[138:139] offset:32280
    ds_write_b64 v5, v[140:141] offset:16120
    ds_write_b64 v5, v[142:143] offset:20000
    s_branch B_pre_done
B_pre_done:
    s_cmp_lt_u32 s28, 10
    s_cbranch_scc1 B_noann2
    v_lshl_add_u32 v4, v1, 3, s31
    v_lshlrev_b32 v4, 7, v4
    v_mov_b32 v5, s30
    s_lshl_b32 s14, s29, 3
    s_sub_u32 s15, s28, 10
    s_lshl_b32 s15, s15, 2
    s_add_u32 s14, s14, s15
    s_add_u32 s14, s14, 24576
    s_waitcnt vmcnt(0)
    s_and_b64 exec, s[98:99], 0xffff
    buffer_store_dword v5, v4, s[8:11], s14 offen
    s_and_b64 exec, s[100:101], 0xffff
    buffer_store_dword v5, v4, s[8:11], s14 offen sc1
    s_mov_b64 exec, -1
B_noann2:
    s_cmp_lg_u32 s28, 8
    s_cbranch_scc1 B_nocp
    s_add_u32 s30, s59, 1
    s_lshl_b32 s14, s32, 7
    s_add_u32 s14, s14, 24576
    v_lshlrev_b32 v4, 2, v1
    s_mov_b32 exec_lo, 0xffffffff
    s_mov_b32 exec_hi, 0x0
    s_mov_b32 s50, 0
fp_84:
    buffer_load_dword v5, v4, s[8:11], s14 offen sc1
    s_add_u32 s50, s50, 1
    s_waitcnt vmcnt(0)
    v_cmp_ne_u32 vcc, s30, v5
    s_cmp_gt_u32 s50, 200000
    s_nop 3
    s_cbranch_scc1 fp_85
    s_cbranch_vccz fp_85
    s_sleep 2
    s_branch fp_84
fp_85:
    s_mov_b64 exec, -1
B_nocp:
    s_lshl_b32 s35, s28, 2
    s_add_u32 s35, s35, 141152
    v_mov_b32 v4, s35
    v_mov_b32 v5, 1
    ds_write_b32 v4, v5
    s_sub_u32 s35, s28, 8
    s_mul_i32 s36, s35, 5120
    v_lshl_add_u32 v4, v1, 4, s36
    v_add_u32 v5, 4096, v4
    s_mul_i32 s36, s35, 5760
    s_add_u32 s36, s36, 110400
    v_mul_u32_u24 v6, 288, v3
    v_lshl_add_u32 v6, v2, 4, v6
    v_add_u32 v6, s36, v6
    s_mov_b64 s[96:97], -1
    s_sleep 8
    s_cmp_eq_u32 s98, 0
    s_cbranch_scc1 snd_86
    s_mov_b64 exec, s[96:97]
    s_mov_b32 s50, 0
    buffer_load_dwordx4 v[32:35], v4, s[8:11], s57 offen offset:0 sc1
    buffer_load_dwordx4 v[36:39], v4, s[8:11], s57 offen offset:1024 sc1
    buffer_load_dwordx4 v[40:43], v4, s[8:11], s57 offen offset:2048 sc1
    buffer_load_dwordx4 v[44:47], v4, s[8:11], s57 offen offset:3072 sc1
    buffer_load_dwordx4 v[48:51], v5, s[8:11], s57 offen offset:0 sc1
pollc_90:
    s_mov_b32 s41, 0
    s_waitcnt vmcnt(4)
    v_cmp_eq_u32 s[42:43], -1, v32
    s_nop 1
    s_cmp_lg_u64 s[42:43], 0
    s_addc_u32 s41, s41, s41
    s_waitcnt vmcnt(3)
    v_cmp_eq_u32 s[44:45], -1, v36
    s_nop 1
    s_cmp_lg_u64 s[44:45], 0
    s_addc_u32 s41, s41, s41
    s_waitcnt vmcnt(2)
    v_cmp_eq_u32 s[46:47], -1, v40
    s_nop 1
    s_cmp_lg_u64 s[46:47], 0
    s_addc_u32 s41, s41, s41
    s_waitcnt vmcnt(1)
    v_cmp_eq_u32 s[42:43], -1, v44
    s_nop 1
    s_cmp_lg_u64 s[42:43], 0
    s_addc_u32 s41, s41, s41
    s_waitcnt vmcnt(0)
    v_cmp_eq_u32 s[44:45], -1, v48
    s_nop 1
    s_cmp_lg_u64 s[44:45], 0
    s_addc_u32 s41, s41, s41
    s_cmp_eq_u32 s41, 0
    s_cbranch_scc1 polld_89
    s_add_u32 s50, s50, 1
    s_cmp_gt_u32 s50, 200000
    s_cbranch_scc1 polld_89
    s_sleep 1
    s_bitcmp0_b32 s41, 4
    s_cbranch_scc1 psk_91
    buffer_load_dwordx4 v[32:35], v4, s[8:11], s57 offen offset:0 sc1
psk_91:
    s_bitcmp0_b32 s41, 3
    s_cbranch_scc1 psk_92
    buffer_load_dwordx4 v[36:39], v4, s[8:11], s57 offen offset:1024 sc1
psk_92:
    s_bitcmp0_b32 s41, 2
    s_cbranch_scc1 psk_93
    buffer_load_dwordx4 v[40:43], v4, s[8:11], s57 offen offset:2048 sc1
psk_93:
    s_bitcmp0_b32 s41, 1
    s_cbranch_scc1 psk_94
    buffer_load_dwordx4 v[44:47], v4, s[8:11], s57 offen offset:3072 sc1
psk_94:
    s_bitcmp0_b32 s41, 0
    s_cbranch_scc1 psk_95
    buffer_load_dwordx4 v[48:51], v5, s[8:11], s57 offen offset:0 sc1
psk_95:
    s_waitcnt vmcnt(0)
    s_branch pollc_90
polld_89:
    s_mov_b64 exec, -1
    s_branch snd_87
snd_86:
    s_mov_b64 exec, s[96:97]
    s_mov_b32 s50, 0
    buffer_load_dwordx4 v[32:35], v4, s[8:11], s57 offen offset:0 sc1
    buffer_load_dwordx4 v[36:39], v4, s[8:11], s57 offen offset:1024 sc1
    buffer_load_dwordx4 v[40:43], v4, s[8:11], s57 offen offset:2048 sc1
    buffer_load_dwordx4 v[44:47], v4, s[8:11], s57 offen offset:3072 sc1
    buffer_load_dwordx4 v[48:51], v5, s[8:11], s57 offen offset:0 sc1
pollc_98:
    s_mov_b32 s41, 0
    s_waitcnt vmcnt(4)
    v_cmp_eq_u32 s[42:43], -1, v32
    s_nop 1
    s_cmp_lg_u64 s[42:43], 0
    s_addc_u32 s41, s41, s41
    s_waitcnt vmcnt(3)
    v_cmp_eq_u32 s[44:45], -1, v36
    s_nop 1
    s_cmp_lg_u64 s[44:45], 0
    s_addc_u32 s41, s41, s41
    s_waitcnt vmcnt(2)
    v_cmp_eq_u32 s[46:47], -1, v40
    s_nop 1
    s_cmp_lg_u64 s[46:47], 0
    s_addc_u32 s41, s41, s41
    s_waitcnt vmcnt(1)
    v_cmp_eq_u32 s[42:43], -1, v44
    s_nop 1
    s_cmp_lg_u64 s[42:43], 0
    s_addc_u32 s41, s41, s41
    s_waitcnt vmcnt(0)
    v_cmp_eq_u32 s[44:45], -1, v48
    s_nop 1
    s_cmp_lg_u64 s[44:45], 0
    s_addc_u32 s41, s41, s41
    s_cmp_eq_u32 s41, 0
    s_cbranch_scc1 polld_97
    s_add_u32 s50, s50, 1
    s_cmp_gt_u32 s50, 200000
    s_cbranch_scc1 polld_97
    s_sleep 1
    s_bitcmp0_b32 s41, 4
    s_cbranch_scc1 psk_99
    buffer_load_dwordx4 v[32:35], v4, s[8:11], s57 offen offset:0 sc1
psk_99:
    s_bitcmp0_b32 s41, 3
    s_cbranch_scc1 psk_100
    buffer_load_dwordx4 v[36:39], v4, s[8:11], s57 offen offset:1024 sc1
psk_100:
    s_bitcmp0_b32 s41, 2
    s_cbranch_scc1 psk_101
    buffer_load_dwordx4 v[40:43], v4, s[8:11], s57 offen offset:2048 sc1
psk_101:
    s_bitcmp0_b32 s41, 1
    s_cbranch_scc1 psk_102
    buffer_load_dwordx4 v[44:47], v4, s[8:11], s57 offen offset:3072 sc1
psk_102:
    s_bitcmp0_b32 s41, 0
    s_cbranch_scc1 psk_103
    buffer_load_dwordx4 v[48:51], v5, s[8:11], s57 offen offset:0 sc1
psk_103:
    s_waitcnt vmcnt(0)
    s_branch pollc_98
polld_97:
    s_mov_b64 exec, -1
snd_87:
    ds_write_b128 v6, v[32:35] offset:0
    ds_write_b128 v6, v[36:39] offset:1152
    ds_write_b128 v6, v[40:43] offset:2304
    ds_write_b128 v6, v[44:47] offset:3456
    ds_write_b128 v6, v[48:51] offset:4608
B_cdone:
    v_bfe_u32 v5, v1, 2, 2
    v_add_u32 v24, 0, v1
    v_lshl_add_u32 v5, v3, 3, v5
    v_add_u32 v28, 64, v1
    v_add_u32 v32, 128, v1
    v_mul_u32_u24 v5, 288, v5
    v_and_b32 v6, 3, v1
    v_mul_u32_u24 v25, 205, v24
    v_mul_u32_u24 v29, 205, v28
    v_mul_u32_u24 v33, 205, v32
    v_lshl_add_u32 v5, v6, 3, v5
    s_lshl_b32 s35, s28, 5
    v_lshrrev_b32 v25, 11, v25
    v_lshlrev_b32 v24, 4, v24
    v_lshrrev_b32 v29, 11, v29
    v_lshlrev_b32 v28, 4, v28
    v_lshrrev_b32 v33, 11, v33
    v_lshlrev_b32 v32, 4, v32
    s_mul_i32 s37, s28, 2816
    v_mul_u32_u24 v6, 176, v2
    s_add_u32 s35, s35, 110400
    s_mul_i32 s54, s29, 327680
    s_mul_i32 s36, s31, 160
    s_add_u32 s37, s37, 69120
    v_lshl_add_u32 v26, v25, 4, v24
    v_lshl_add_u32 v30, v29, 4, v28
    v_lshl_add_u32 v34, v33, 4, v32
    s_add_u32 s54, s54, s36
    v_lshl_add_u32 v6, v3, 4, v6
    s_mul_i32 s36, s28, 40960
    v_mul_u32_u24 v25, 2400, v25
    v_mul_u32_u24 v29, 2400, v29
    v_mul_u32_u24 v33, 2400, v33
    s_add_u32 s54, s54, s36
    v_add_u32 v8, s35, v5
    v_add_u32 v9, s37, v6
    v_add_u32 v36, s37, v26
    v_add_u32 v12, v25, v24
    v_add_u32 v37, s37, v30
    v_add_u32 v13, v29, v28
    v_add_u32 v38, s37, v34
    v_add_u32 v14, v33, v32
    s_add_u32 s54, s54, 1280
    s_waitcnt lgkmcnt(0)
    s_barrier
    s_cmp_gt_u32 s28, 7
    s_cbranch_scc1 B_bump
    ds_read_b64_tr_b16 v[40:41], v8 offset:0
    ds_read_b64_tr_b16 v[42:43], v8 offset:1152
    ds_read_b64_tr_b16 v[44:45], v8 offset:9216
    ds_read_b64_tr_b16 v[46:47], v8 offset:10368
    ds_read_b64_tr_b16 v[48:49], v8 offset:18432
    ds_read_b64_tr_b16 v[50:51], v8 offset:19584
    s_waitcnt lgkmcnt(4)
    ds_write_b128 v9, v[40:43] offset:0
    s_waitcnt lgkmcnt(3)
    ds_write_b128 v9, v[44:47] offset:64
    s_mov_b32 exec_lo, 0xffffffff
    s_mov_b32 exec_hi, 0x0
    s_waitcnt lgkmcnt(2)
    ds_write_b128 v9, v[48:51] offset:128
    ds_read_b128 v[60:63], v38
    s_mov_b64 exec, -1
    ds_read_b128 v[56:59], v37
    ds_read_b128 v[52:55], v36
    s_waitcnt lgkmcnt(0)
    buffer_store_dwordx4 v[52:55], v12, s[20:23], s54 offen nt
    buffer_store_dwordx4 v[56:59], v13, s[20:23], s54 offen nt
    s_mov_b32 exec_lo, 0xffffffff
    s_mov_b32 exec_hi, 0x0
    buffer_store_dwordx4 v[60:63], v14, s[20:23], s54 offen nt
    s_mov_b64 exec, -1
    s_nop 0
    s_branch B_end
B_bump:
    s_cmp_lg_u32 s28, 10
    s_cbranch_scc1 B_end
    s_cmp_lg_u32 s29, 0
    s_cbranch_scc1 B_end
    s_lshl_b32 s15, s31, 8
    s_add_u32 s15, s15, 256
    v_mov_b32 v4, s30
    v_mov_b32 v5, 0
    s_mov_b32 exec_lo, 0x1
    s_mov_b32 exec_hi, 0x0
    buffer_store_dword v4, v5, s[8:11], s15 offen
    s_mov_b64 exec, -1
B_end:
L_exit:
    s_endpgm

.p2align 8
.type L_table,@object
L_table:
.long 0x0,0x0,0x400000,0xc00080,0x800000,0x1800100,0xc00000,0x2400180
.long 0x1000000,0x3000200,0x1400000,0x3c00280,0x1800000,0x4800300,0x1c00000,0x400380
.long 0x2000000,0x1000400,0x2400000,0x1c00480,0x2800000,0x2800000,0x2c00000,0x3400080
.long 0x3000000,0x4000100,0x3400000,0x4c00180,0xffffffff,0xffffffff,0xffffffff,0xffffffff
.long 0x0,0x0,0x1400100,0x1c00180,0x2800200,0x3800300,0x3c00300,0x400480
.long 0x400,0x2000100,0x1400000,0x3c00280,0x2800100,0x800400,0x3c00200,0x2400080
.long 0x300,0x4000200,0x1400400,0xc00380,0x2800000,0x2800000,0x3c00100,0x4400180
.long 0x200,0x1000300,0x1400300,0x2c00480,0xffffffff,0xffffffff,0xffffffff,0xffffffff
.long 0x0,0x0,0x2400200,0x2c00280,0x4800400,0x800000,0x1c00100,0x3400280
.long 0x4000300,0x1000000,0x1400000,0x3c00280,0x3800200,0x1800000,0xc00400,0x4400280
.long 0x3000100,0x2000000,0x400300,0x4c00280,0x2800000,0x2800000,0x4c00200,0x400280
.long 0x2000400,0x3000000,0x4400100,0xc00280,0xffffffff,0xffffffff,0xffffffff,0xffffffff
.long 0x0,0x0,0x3400300,0x3c00380,0x1800100,0x2800200,0x4c00400,0x1400080
.long 0x3000200,0x400,0x1400000,0x3c00280,0x4800300,0x2800100,0x2c00100,0x1400480
.long 0x1000400,0x300,0x4400200,0x3c00180,0x2800000,0x2800000,0xc00300,0x1400380
.long 0x4000100,0x200,0x2400400,0x3c00080,0xffffffff,0xffffffff,0xffffffff,0xffffffff
.long 0x0,0x0,0x4400400,0x4c00480,0x3800300,0x4800400,0x2c00200,0x4400380
.long 0x2000100,0x4000300,0x1400000,0x3c00280,0x800400,0x3800200,0x4c00300,0x3400180
.long 0x4000200,0x3000100,0x3400100,0x2c00080,0x2800000,0x2800000,0x1c00400,0x2400480
.long 0x1000300,0x2000400,0x400200,0x1c00380,0xffffffff,0xffffffff,0xffffffff,0xffffffff
.long 0xffffffff,0xffffffff,0xffffffff,0xffffffff,0xffffffff,0xffffffff,0xffffffff,0xffffffff
.long 0xffffffff,0xffffffff,0xffffffff,0xffffffff,0xffffffff,0xffffffff,0xffffffff,0xffffffff
.long 0xffffffff,0xffffffff,0xffffffff,0xffffffff,0xffffffff,0xffffffff,0xffffffff,0xffffffff
.long 0xffffffff,0xffffffff,0xffffffff,0xffffffff,0xffffffff,0xffffffff,0xffffffff,0xffffffff
.long 0xffffffff,0xffffffff,0xffffffff,0xffffffff,0xffffffff,0xffffffff,0xffffffff,0xffffffff
.long 0xffffffff,0xffffffff,0xffffffff,0xffffffff,0xffffffff,0xffffffff,0xffffffff,0xffffffff
.long 0xffffffff,0xffffffff,0xffffffff,0xffffffff,0xffffffff,0xffffffff,0xffffffff,0xffffffff
.long 0xffffffff,0xffffffff,0xffffffff,0xffffffff,0xffffffff,0xffffffff,0xffffffff,0xffffffff
.long 0xffffffff,0xffffffff,0xffffffff,0xffffffff,0xffffffff,0xffffffff,0xffffffff,0xffffffff
.long 0xffffffff,0xffffffff,0xffffffff,0xffffffff,0xffffffff,0xffffffff,0xffffffff,0xffffffff
.long 0xffffffff,0xffffffff,0xffffffff,0xffffffff,0xffffffff,0xffffffff,0xffffffff,0xffffffff
.long 0xffffffff,0xffffffff,0xffffffff,0xffffffff,0xffffffff,0xffffffff,0xffffffff,0xffffffff
.long 0xffffffff,0xffffffff,0xffffffff,0xffffffff,0xffffffff,0xffffffff,0xffffffff,0xffffffff
.long 0xffffffff,0xffffffff,0xffffffff,0xffffffff,0xffffffff,0xffffffff,0xffffffff,0xffffffff
.long 0xffffffff,0xffffffff,0xffffffff,0xffffffff,0xffffffff,0xffffffff,0xffffffff,0xffffffff
.long 0xffffffff,0xffffffff,0xffffffff,0xffffffff,0xffffffff,0xffffffff,0xffffffff,0xffffffff
.long 0x0,0x0,0x4400400,0x4c00480,0x3800300,0x4800400,0x2c00200,0x4400380
.long 0x2000100,0x4000300,0x1400000,0x3c00280,0x800400,0x3800200,0x4c00300,0x3400180
.long 0x4000200,0x3000100,0x3400100,0x2c00080,0x2800000,0x2800000,0x1c00400,0x2400480
.long 0x1000300,0x2000400,0x400200,0x1c00380,0xffffffff,0xffffffff,0xffffffff,0xffffffff
.long 0xffffffff,0xffffffff,0xffffffff,0xffffffff,0xffffffff,0xffffffff,0xffffffff,0xffffffff
.long 0xffffffff,0xffffffff,0xffffffff,0xffffffff,0xffffffff,0xffffffff,0xffffffff,0xffffffff
.long 0xffffffff,0xffffffff,0xffffffff,0xffffffff,0xffffffff,0xffffffff,0xffffffff,0xffffffff
.long 0xffffffff,0xffffffff,0xffffffff,0xffffffff,0xffffffff,0xffffffff,0xffffffff,0xffffffff
.long 0xffffffff,0xffffffff,0xffffffff,0xffffffff,0xffffffff,0xffffffff,0xffffffff,0xffffffff
.long 0xffffffff,0xffffffff,0xffffffff,0xffffffff,0xffffffff,0xffffffff,0xffffffff,0xffffffff
.long 0xffffffff,0xffffffff,0xffffffff,0xffffffff,0xffffffff,0xffffffff,0xffffffff,0xffffffff
.long 0xffffffff,0xffffffff,0xffffffff,0xffffffff,0xffffffff,0xffffffff,0xffffffff,0xffffffff
.long 0x3800000,0x800200,0x3c00000,0x1400280,0x4000000,0x2000300,0x4400000,0x2c00380
.long 0x4800000,0x3800400,0x4c00000,0x4400480,0x0,0x0,0xffffffff,0xffffffff
.long 0xffffffff,0xffffffff,0xffffffff,0xffffffff,0xffffffff,0xffffffff,0xffffffff,0xffffffff
.long 0xffffffff,0xffffffff,0xffffffff,0xffffffff,0xffffffff,0xffffffff,0xffffffff,0xffffffff
.long 0x2800400,0x4800100,0x3c00000,0x1400280,0x100,0x3000400,0x1400200,0x4c00080
.long 0x2800300,0x1800200,0x3c00400,0x3400380,0x0,0x0,0xffffffff,0xffffffff
.long 0xffffffff,0xffffffff,0xffffffff,0xffffffff,0xffffffff,0xffffffff,0xffffffff,0xffffffff
.long 0xffffffff,0xffffffff,0xffffffff,0xffffffff,0xffffffff,0xffffffff,0xffffffff,0xffffffff
.long 0x1800300,0x3800000,0x3c00000,0x1400280,0x1000200,0x4000000,0x3400400,0x1c00280
.long 0x800100,0x4800000,0x2c00300,0x2400280,0x0,0x0,0xffffffff,0xffffffff
.long 0xffffffff,0xffffffff,0xffffffff,0xffffffff,0xffffffff,0xffffffff,0xffffffff,0xffffffff
.long 0xffffffff,0xffffffff,0xffffffff,0xffffffff,0xffffffff,0xffffffff,0xffffffff,0xffffffff
.long 0x800200,0x2800400,0x3c00000,0x1400280,0x2000300,0x100,0x400100,0x3c00480
.long 0x3800400,0x2800300,0x1c00200,0x1400180,0x0,0x0,0xffffffff,0xffffffff
.long 0xffffffff,0xffffffff,0xffffffff,0xffffffff,0xffffffff,0xffffffff,0xffffffff,0xffffffff
.long 0xffffffff,0xffffffff,0xffffffff,0xffffffff,0xffffffff,0xffffffff,0xffffffff,0xffffffff
.long 0xffffffff,0xffffffff,0xffffffff,0xffffffff,0xffffffff,0xffffffff,0xffffffff,0xffffffff
.long 0xffffffff,0xffffffff,0xffffffff,0xffffffff,0xffffffff,0xffffffff,0x3800000,0x800200
.long 0x3c00000,0x1400280,0x4000000,0x2000300,0x4400000,0x2c00380,0x4800000,0x3800400
.long 0x4c00000,0x4400480,0x0,0x0,0xffffffff,0xffffffff,0xffffffff,0xffffffff
.long 0xffffffff,0xffffffff,0xffffffff,0xffffffff,0xffffffff,0xffffffff,0xffffffff,0xffffffff
.long 0xffffffff,0xffffffff,0xffffffff,0xffffffff,0xffffffff,0xffffffff,0x2800400,0x4800100
.long 0x3c00000,0x1400280,0x100,0x3000400,0x1400200,0x4c00080,0x2800300,0x1800200
.long 0x3c00400,0x3400380,0x0,0x0,0xffffffff,0xffffffff,0xffffffff,0xffffffff
.long 0xffffffff,0xffffffff,0xffffffff,0xffffffff,0xffffffff,0xffffffff,0xffffffff,0xffffffff
.long 0xffffffff,0xffffffff,0xffffffff,0xffffffff,0xffffffff,0xffffffff,0x1800300,0x3800000
.long 0x3c00000,0x1400280,0x1000200,0x4000000,0x3400400,0x1c00280,0x800100,0x4800000
.long 0x2c00300,0x2400280,0x0,0x0,0xffffffff,0xffffffff,0xffffffff,0xffffffff
.long 0xffffffff,0xffffffff,0xffffffff,0xffffffff,0xffffffff,0xffffffff,0xffffffff,0xffffffff
.long 0xffffffff,0xffffffff,0xffffffff,0xffffffff,0xffffffff,0xffffffff,0x800200,0x2800400
.long 0x3c00000,0x1400280,0x2000300,0x100,0x400100,0x3c00480,0x3800400,0x2800300
.long 0x1c00200,0x1400180,0x0,0x0,0xffffffff,0xffffffff,0xffffffff,0xffffffff
.long 0x4800100,0x1800300,0x3c00000,0x1400280,0x3000400,0x1000200,0x2400300,0xc00180
.long 0x1800200,0x800100,0xc00100,0x400080,0x0,0x0,0xffffffff,0xffffffff
.long 0xffffffff,0xffffffff,0xffffffff,0xffffffff,0xffffffff,0xffffffff,0xffffffff,0xffffffff
.long 0xffffffff,0xffffffff,0xffffffff,0xffffffff,0xffffffff,0xffffffff,0xffffffff,0xffffffff
.long 0xffffffff,0xffffffff,0xffffffff,0xffffffff,0xffffffff,0xffffffff,0xffffffff,0xffffffff
.long 0xffffffff,0xffffffff,0xffffffff,0xffffffff,0xffffffff,0xffffffff,0x4800100,0x1800300
.long 0x3c00000,0x1400280,0x3000400,0x1000200,0x2400300,0xc00180,0x1800200,0x800100
.long 0xc00100,0x400080,0x0,0x0,0xffffffff,0xffffffff,0xffffffff,0xffffffff
.long 0xffffffff,0xffffffff,0xffffffff,0xffffffff,0xffffffff,0xffffffff,0xffffffff,0xffffffff
.long 0xffffffff,0xffffffff,0xffffffff,0xffffffff,0xffffffff,0xffffffff,0xffffffff,0xffffffff
.long 0xffffffff,0xffffffff,0xffffffff,0xffffffff,0xffffffff,0xffffffff,0xffffffff,0xffffffff
.long 0xffffffff,0xffffffff,0xffffffff,0xffffffff,0xffffffff,0xffffffff,0xffffffff,0xffffffff
.long 0xffffffff,0xffffffff,0xffffffff,0xffffffff,0xffffffff,0xffffffff,0xffffffff,0xffffffff
.long 0xffffffff,0xffffffff,0xffffffff,0xffffffff,0xffffffff,0xffffffff,0xffffffff,0xffffffff
.long 0xffffffff,0xffffffff,0xffffffff,0xffffffff,0xffffffff,0xffffffff,0xffffffff,0xffffffff
.long 0xffffffff,0xffffffff,0xffffffff,0xffffffff,0xffffffff,0xffffffff,0xffffffff,0xffffffff
.long 0x0,0x0,0x40000,0xc0008,0x80000,0x180010,0xc0000,0x240018
.long 0x100000,0x300020,0x140000,0x3c0028,0x180000,0x480030,0x1c0000,0x540038
.long 0x200000,0x600040,0x240000,0x6c0048,0x280000,0x780050,0x2c0000,0x840058
.long 0x300000,0x900060,0x340000,0x9c0068,0xffffffff,0xffffffff,0xffffffff,0xffffffff
.long 0x0,0x0,0x140010,0x1c0018,0x280020,0x380030,0x3c0030,0x540048
.long 0x500040,0x700060,0x640050,0x8c0078,0x780060,0xa80090,0x8c0070,0xc400a8
.long 0xa00080,0xe000c0,0xb40090,0xfc00d8,0xc800a0,0x11800f0,0xdc00b0,0x1340108
.long 0xf000c0,0x1500120,0x10400d0,0x16c0138,0xffffffff,0xffffffff,0xffffffff,0xffffffff
.long 0x0,0x0,0x240020,0x2c0028,0x480040,0x580050,0x6c0060,0x840078
.long 0x900080,0xb000a0,0xb400a0,0xdc00c8,0xd800c0,0x10800f0,0xfc00e0,0x1340118
.long 0x1200100,0x1600140,0x1440120,0x18c0168,0x1680140,0x1b80190,0x18c0160,0x1e401b8
.long 0x1b00180,0x21001e0,0x1d401a0,0x23c0208,0xffffffff,0xffffffff,0xffffffff,0xffffffff
.long 0x0,0x0,0x340030,0x3c0038,0x680060,0x780070,0x9c0090,0xb400a8
.long 0xd000c0,0xf000e0,0x10400f0,0x12c0118,0x1380120,0x1680150,0x16c0150,0x1a40188
.long 0x1a00180,0x1e001c0,0x1d401b0,0x21c01f8,0x20801e0,0x2580230,0x23c0210,0x2940268
.long 0x2700240,0x2d002a0,0x2a40270,0x30c02d8,0xffffffff,0xffffffff,0xffffffff,0xffffffff
.long 0x380000,0xa80070,0x3c0000,0xb40078,0x400000,0xc00080,0x440000,0xcc0088
.long 0x480000,0xd80090,0x4c0000,0xe40098,0x500000,0xf000a0,0x380000,0xa80070
.long 0x3c0000,0xb40078,0x400000,0xc00080,0x440000,0xcc0088,0x480000,0xd80090
.long 0x4c0000,0xe40098,0x500000,0xf000a0,0xffffffff,0xffffffff,0xffffffff,0xffffffff
.long 0x11800e0,0x1880150,0x12c00f0,0x1a40168,0x1400100,0x1c00180,0x1540110,0x1dc0198
.long 0x1680120,0x1f801b0,0x17c0130,0x21401c8,0x1900140,0x23001e0,0x11800e0,0x1880150
.long 0x12c00f0,0x1a40168,0x1400100,0x1c00180,0x1540110,0x1dc0198,0x1680120,0x1f801b0
.long 0x17c0130,0x21401c8,0x1900140,0x23001e0,0xffffffff,0xffffffff,0xffffffff,0xffffffff
.long 0x1f801c0,0x2680230,0x21c01e0,0x2940258,0x2400200,0x2c00280,0x2640220,0x2ec02a8
.long 0x2880240,0x31802d0,0x2ac0260,0x34402f8,0x2d00280,0x3700320,0x1f801c0,0x2680230
.long 0x21c01e0,0x2940258,0x2400200,0x2c00280,0x2640220,0x2ec02a8,0x2880240,0x31802d0
.long 0x2ac0260,0x34402f8,0x2d00280,0x3700320,0xffffffff,0xffffffff,0xffffffff,0xffffffff
.long 0x2d802a0,0x3480310,0x30c02d0,0x3840348,0x3400300,0x3c00380,0x3740330,0x3fc03b8
.long 0x3a80360,0x43803f0,0x3dc0390,0x4740428,0x41003c0,0x4b00460,0x2d802a0,0x3480310
.long 0x30c02d0,0x3840348,0x3400300,0x3c00380,0x3740330,0x3fc03b8,0x3a80360,0x43803f0
.long 0x3dc0390,0x4740428,0x41003c0,0x4b00460,0xffffffff,0xffffffff,0xffffffff,0xffffffff
.long 0x0,0x0,0x500000,0xf000a0,0xa00000,0x1e00140,0xf00000,0x2d001e0
.long 0x1400000,0x3c00280,0x1900000,0x4b00320,0x1e00000,0xa003c0,0x2300000,0x1900460
.long 0x2800000,0x2800000,0x2d00000,0x37000a0,0x3200000,0x4600140,0x3700000,0x5001e0
.long 0x3c00000,0x1400280,0x4100000,0x2300320,0x4600000,0x32003c0,0x4b00000,0x4100460
.long 0x0,0x0,0x1900140,0x23001e0,0x3200280,0x46003c0,0x4b003c0,0x19000a0
.long 0x1400000,0x3c00280,0x2d00140,0xf00460,0x4600280,0x3200140,0xf003c0,0x500320
.long 0x2800000,0x2800000,0x4100140,0x4b001e0,0xa00280,0x1e003c0,0x23003c0,0x41000a0
.long 0x3c00000,0x1400280,0x500140,0x3700460,0x1e00280,0xa00140,0x37003c0,0x2d00320
.long 0x0,0x0,0x2d00280,0x3700320,0xa00000,0x1e00140,0x3700280,0x500460
.long 0x1400000,0x3c00280,0x4100280,0x23000a0,0x1e00000,0xa003c0,0x4b00280,0x41001e0
.long 0x2800000,0x2800000,0x500280,0xf00320,0x3200000,0x4600140,0xf00280,0x2d00460
.long 0x3c00000,0x1400280,0x1900280,0x4b000a0,0x4600000,0x32003c0,0x2300280,0x19001e0
.long 0x0,0x0,0x41003c0,0x4b00460,0x3200280,0x46003c0,0x2300140,0x4100320
.long 0x1400000,0x3c00280,0x5003c0,0x37001e0,0x4600280,0x3200140,0x3700140,0x2d000a0
.long 0x2800000,0x2800000,0x19003c0,0x2300460,0xa00280,0x1e003c0,0x4b00140,0x1900320
.long 0x3c00000,0x1400280,0x2d003c0,0xf001e0,0x1e00280,0xa00140,0xf00140,0x5000a0
.long 0x0,0x0,0xa00000,0x1e00140,0x3c003c0,0x3c003c0,0x46003c0,0xa00000
.long 0x1400000,0x3c00280,0x1e00000,0xa003c0,0x3c0,0x2800140,0xa003c0,0x4600280
.long 0x2800000,0x2800000,0x3200000,0x4600140,0x14003c0,0x14003c0,0x1e003c0,0x3200000
.long 0x3c00000,0x1400280,0x4600000,0x32003c0,0x28003c0,0x140,0x32003c0,0x1e00280
.long 0x0,0x0,0x3200280,0x46003c0,0x3c003c0,0x3c003c0,0x1e00140,0x3200280
.long 0x1400000,0x3c00280,0x4600280,0x3200140,0x3c0,0x2800140,0x3200140,0x1e00000
.long 0x2800000,0x2800000,0xa00280,0x1e003c0,0x14003c0,0x14003c0,0x4600140,0xa00280
.long 0x3c00000,0x1400280,0x1e00280,0xa00140,0x28003c0,0x140,0xa00140,0x4600000
.long 0x3c003c0,0x3c003c0,0x46003c0,0xa00000,0x0,0x0,0xa00000,0x1e00140
.long 0x3c0,0x2800140,0xa003c0,0x4600280,0x1400000,0x3c00280,0x1e00000,0xa003c0
.long 0x14003c0,0x14003c0,0x1e003c0,0x3200000,0x2800000,0x2800000,0x3200000,0x4600140
.long 0x28003c0,0x140,0x32003c0,0x1e00280,0x3c00000,0x1400280,0x4600000,0x32003c0
.long 0x3c003c0,0x3c003c0,0x1e00140,0x3200280,0x0,0x0,0x3200280,0x46003c0
.long 0x3c0,0x2800140,0x3200140,0x1e00000,0x1400000,0x3c00280,0x4600280,0x3200140
.long 0x14003c0,0x14003c0,0x4600140,0xa00280,0x2800000,0x2800000,0xa00280,0x1e003c0
.long 0x28003c0,0x140,0xa00140,0x4600000,0x3c00000,0x1400280,0x1e00280,0xa00140
.long 0x0,0x1400140,0x4600000,0xa00140,0x3c00000,0x140,0x3200000,0x4600140
.long 0x2800000,0x3c00140,0x1e00000,0x3200140,0x1400000,0x2800140,0xa00000,0x1e00140
.long 0x1400140,0x0,0xa00140,0x4600000,0x140,0x3c00000,0x4600140,0x3200000
.long 0x3c00140,0x2800000,0x3200140,0x1e00000,0x2800140,0x1400000,0x1e00140,0xa00000
.long 0x0,0x1400140,0x32003c0,0x4600000,0x1400280,0x28003c0,0x4600140,0xa00280
.long 0x2800000,0x3c00140,0xa003c0,0x1e00000,0x3c00280,0x3c0,0x1e00140,0x3200280
.long 0x1400140,0x0,0x4600000,0x32003c0,0x28003c0,0x1400280,0xa00280,0x4600140
.long 0x3c00140,0x2800000,0x1e00000,0xa003c0,0x3c0,0x3c00280,0x3200280,0x1e00140
.long 0x0,0x1400140,0x1e00280,0x32003c0,0x3c00000,0x140,0xa00280,0x1e003c0
.long 0x2800000,0x3c00140,0x4600280,0xa003c0,0x1400000,0x2800140,0x3200280,0x46003c0
.long 0x1400140,0x0,0x32003c0,0x1e00280,0x140,0x3c00000,0x1e003c0,0xa00280
.long 0x3c00140,0x2800000,0xa003c0,0x4600280,0x2800140,0x1400000,0x46003c0,0x3200280
.long 0x0,0x1400140,0xa00140,0x1e00280,0x1400280,0x28003c0,0x1e003c0,0x3200000
.long 0x2800000,0x3c00140,0x3200140,0x4600280,0x3c00280,0x3c0,0x46003c0,0xa00000
.long 0x1400140,0x0,0x1e00280,0xa00140,0x28003c0,0x1400280,0x3200000,0x1e003c0
.long 0x3c00140,0x2800000,0x4600280,0x3200140,0x3c0,0x3c00280,0xa00000,0x46003c0
.long 0x0,0x0,0x4c00000,0x4400480,0x4800000,0x3800400,0x4400000,0x2c00380
.long 0x4000000,0x2000300,0x3c00000,0x1400280,0x3800000,0x800200,0x3400000,0x4c00180
.long 0x3000000,0x4000100,0x2c00000,0x3400080,0x2800000,0x2800000,0x2400000,0x1c00480
.long 0x2000000,0x1000400,0x1c00000,0x400380,0x1800000,0x4800300,0x1400000,0x3c00280
.long 0x0,0x0,0x3c00400,0x3400380,0x2800300,0x1800200,0x1400200,0x4c00080
.long 0x100,0x3000400,0x3c00000,0x1400280,0x2800400,0x4800100,0x1400300,0x2c00480
.long 0x200,0x1000300,0x3c00100,0x4400180,0x2800000,0x2800000,0x1400400,0xc00380
.long 0x300,0x4000200,0x3c00200,0x2400080,0x2800100,0x800400,0x1400000,0x3c00280
.long 0x0,0x0,0x2c00300,0x2400280,0x800100,0x4800000,0x3400400,0x1c00280
.long 0x1000200,0x4000000,0x3c00000,0x1400280,0x1800300,0x3800000,0x4400100,0xc00280
.long 0x2000400,0x3000000,0x4c00200,0x400280,0x2800000,0x2800000,0x400300,0x4c00280
.long 0x3000100,0x2000000,0xc00400,0x4400280,0x3800200,0x1800000,0x1400000,0x3c00280
.long 0x0,0xffffffff,0x1c00200,0xffffffff,0x3800400,0xffffffff,0x400100,0xffffffff
.long 0x2000300,0xffffffff,0x3c00000,0xffffffff,0x800200,0xffffffff,0x2400400,0xffffffff
.long 0x4000100,0xffffffff,0xc00300,0xffffffff,0x2800000,0xffffffff,0x4400200,0xffffffff
.long 0x1000400,0xffffffff,0x2c00100,0xffffffff,0x4800300,0xffffffff,0x1400000,0xffffffff
.long 0x0,0x0,0x1400180,0xc00100,0x2800300,0x1800200,0x3c00480,0x2400300
.long 0x100,0x3000400,0x1400280,0x3c00000,0x2800400,0x4800100,0x3c00080,0x400200
.long 0x200,0x1000300,0x1400380,0x1c00400,0x2800000,0x2800000,0x3c00180,0x3400100
.long 0x300,0x4000200,0x1400480,0x4c00300,0x2800100,0x800400,0x3c00280,0x1400000
.long 0x0,0xffff0000,0x400080,0xffff0000,0x800100,0xffff0000,0xc00180,0xffff0000
.long 0x1000200,0xffff0000,0x1400280,0xffff0000,0x1800300,0xffff0000,0x1c00380,0xffff0000
.long 0x2000400,0xffff0000,0x2400480,0xffff0000,0x2800000,0xffff0000,0x2c00080,0xffff0000
.long 0x3000100,0xffff0000,0x3400180,0xffff0000,0x3800200,0xffff0000,0x3c00280,0xffff0000
.long 0xffffffff,0xffffffff,0xffffffff,0xffffffff,0xffffffff,0xffffffff,0xffffffff,0xffffffff
.long 0xffffffff,0xffffffff,0xffffffff,0xffffffff,0xffffffff,0xffffffff,0xffffffff,0xffffffff
.long 0xffffffff,0xffffffff,0xffffffff,0xffffffff,0xffffffff,0xffffffff,0xffffffff,0xffffffff
.long 0xffffffff,0xffffffff,0xffffffff,0xffffffff,0xffffffff,0xffffffff,0xffffffff,0xffffffff
.long 0xffffffff,0xffffffff,0xffffffff,0xffffffff,0xffffffff,0xffffffff,0xffffffff,0xffffffff
.long 0xffffffff,0xffffffff,0xffffffff,0xffffffff,0xffffffff,0xffffffff,0xffffffff,0xffffffff
.long 0xffffffff,0xffffffff,0xffffffff,0xffffffff,0xffffffff,0xffffffff,0xffffffff,0xffffffff
.long 0xffffffff,0xffffffff,0xffffffff,0xffffffff,0xffffffff,0xffffffff,0xffffffff,0xffffffff
.long 0xffffffff,0xffffffff,0xffffffff,0xffffffff,0xffffffff,0xffffffff,0xffffffff,0xffffffff
.long 0xffffffff,0xffffffff,0xffffffff,0xffffffff,0xffffffff,0xffffffff,0xffffffff,0xffffffff
.long 0xffffffff,0xffffffff,0xffffffff,0xffffffff,0xffffffff,0xffffffff,0xffffffff,0xffffffff
.long 0xffffffff,0xffffffff,0xffffffff,0xffffffff,0xffffffff,0xffffffff,0xffffffff,0xffffffff
.long 0xffffffff,0xffff,0xffffffff,0x180ffff,0xffffffff,0x300ffff,0xffffffff,0x480ffff
.long 0xffffffff,0x100ffff,0xffffffff,0x280ffff,0xffffffff,0x400ffff,0xffffffff,0x80ffff
.long 0xffffffff,0x200ffff,0xffffffff,0x380ffff,0xffffffff,0xffff,0xffffffff,0x180ffff
.long 0xffffffff,0x300ffff,0xffffffff,0x480ffff,0xffffffff,0x100ffff,0xffffffff,0x280ffff
.long 0x0,0x0,0x1000140,0x8000c0,0x2000280,0x1000180,0x30003c0,0x1800240
.long 0x4000000,0x2000300,0x140,0x28003c0,0x1000280,0x3000480,0x20003c0,0x3800040
.long 0x3000000,0x4000100,0x4000140,0x48001c0,0x280,0x280,0x10003c0,0x800340
.long 0x2000000,0x1000400,0x3000140,0x18004c0,0x4000280,0x2000080,0x3c0,0x2800140
.long 0x0,0xffffffff,0x40,0xffffffff,0x80,0xffffffff,0xc0,0xffffffff
.long 0x100,0xffffffff,0x140,0xffffffff,0x180,0xffffffff,0x1c0,0xffffffff
.long 0x200,0xffffffff,0x240,0xffffffff,0x280,0xffffffff,0x2c0,0xffffffff
.long 0x300,0xffffffff,0x340,0xffffffff,0x380,0xffffffff,0x3c0,0xffffffff
.long 0x1000000,0x3000200,0xc00000,0x2400180,0x800000,0x1800100,0x400000,0xc00080
.long 0xffffffff,0xffffffff,0xffffffff,0xffffffff,0xffffffff,0xffffffff,0xffffffff,0xffffffff
.long 0xffffffff,0xffffffff,0xffffffff,0xffffffff,0xffffffff,0xffffffff,0xffffffff,0xffffffff
.long 0xffffffff,0xffffffff,0xffffffff,0xffffffff,0xffffffff,0xffffffff,0xffffffff,0xffffffff
.long 0x400,0x2000100,0x3c00300,0x400480,0x2800200,0x3800300,0x1400100,0x1c00180
.long 0xffffffff,0xffffffff,0xffffffff,0xffffffff,0xffffffff,0xffffffff,0xffffffff,0xffffffff
.long 0xffffffff,0xffffffff,0xffffffff,0xffffffff,0xffffffff,0xffffffff,0xffffffff,0xffffffff
.long 0xffffffff,0xffffffff,0xffffffff,0xffffffff,0xffffffff,0xffffffff,0xffffffff,0xffffffff
.long 0x4000300,0x1000000,0x1c00100,0x3400280,0x4800400,0x800000,0x2400200,0x2c00280
.long 0xffffffff,0xffffffff,0xffffffff,0xffffffff,0xffffffff,0xffffffff,0xffffffff,0xffffffff
.long 0xffffffff,0xffffffff,0xffffffff,0xffffffff,0xffffffff,0xffffffff,0xffffffff,0xffffffff
.long 0xffffffff,0xffffffff,0xffffffff,0xffffffff,0xffffffff,0xffffffff,0xffffffff,0xffffffff
.long 0x3000200,0xffffffff,0x4c00400,0xffffffff,0x1800100,0xffffffff,0x3400300,0xffffffff
.long 0xffffffff,0xffffffff,0xffffffff,0xffffffff,0xffffffff,0xffffffff,0xffffffff,0xffffffff
.long 0xffffffff,0xffffffff,0xffffffff,0xffffffff,0xffffffff,0xffffffff,0xffffffff,0xffffffff
.long 0xffffffff,0xffffffff,0xffffffff,0xffffffff,0xffffffff,0xffffffff,0xffffffff,0xffffffff
.long 0xffffffff,0xffffffff,0xffffffff,0xffffffff,0xffffffff,0xffffffff,0xffffffff,0xffffffff
.long 0x1000000,0x3000200,0xc00000,0x2400180,0x800000,0x1800100,0x400000,0xc00080
.long 0xffffffff,0xffffffff,0xffffffff,0xffffffff,0xffffffff,0xffffffff,0xffffffff,0xffffffff
.long 0xffffffff,0xffffffff,0xffffffff,0xffffffff,0xffffffff,0xffffffff,0xffffffff,0xffffffff
.long 0xffffffff,0xffffffff,0xffffffff,0xffffffff,0xffffffff,0xffffffff,0xffffffff,0xffffffff
.long 0x400,0x2000100,0x3c00300,0x400480,0x2800200,0x3800300,0x1400100,0x1c00180
.long 0xffffffff,0xffffffff,0xffffffff,0xffffffff,0xffffffff,0xffffffff,0xffffffff,0xffffffff
.long 0xffffffff,0xffffffff,0xffffffff,0xffffffff,0xffffffff,0xffffffff,0xffffffff,0xffffffff
.long 0xffffffff,0xffffffff,0xffffffff,0xffffffff,0xffffffff,0xffffffff,0xffffffff,0xffffffff
.long 0x4000300,0x1000000,0x1c00100,0x3400280,0x4800400,0x800000,0x2400200,0x2c00280
.long 0xffffffff,0xffffffff,0xffffffff,0xffffffff,0xffffffff,0xffffffff,0xffffffff,0xffffffff
.long 0xffffffff,0xffffffff,0xffffffff,0xffffffff,0xffffffff,0xffffffff,0xffffffff,0xffffffff
.long 0xffffffff,0xffffffff,0xffffffff,0xffffffff,0xffffffff,0xffffffff,0xffffffff,0xffffffff
.long 0x3000200,0xffffffff,0x4c00400,0xffffffff,0x1800100,0xffffffff,0x3400300,0xffffffff
.long 0xffffffff,0xffffffff,0xffffffff,0xffffffff,0xffffffff,0xffffffff,0xffffffff,0xffffffff
.long 0xffffffff,0xffffffff,0xffffffff,0xffffffff,0xffffffff,0xffffffff,0xffffffff,0xffffffff
.long 0x400,0x2000100,0x1400080,0x2c00200,0x2800200,0x3800300,0x3c00380,0x4400400
.long 0xffffffff,0xffffffff,0xffffffff,0xffffffff,0xffffffff,0xffffffff,0xffffffff,0xffffffff
.long 0xffffffff,0xffffffff,0xffffffff,0xffffffff,0xffffffff,0xffffffff,0xffffffff,0xffffffff
.long 0xffffffff,0xffffffff,0xffffffff,0xffffffff,0xffffffff,0xffffffff,0xffffffff,0xffffffff
.long 0x4000300,0xffff0000,0x4400380,0xffff0000,0x4800400,0xffff0000,0x4c00480,0xffff0000
.long 0xffffffff,0x400ffff,0xffffffff,0x80ffff,0xffffffff,0x200ffff,0xffffffff,0x380ffff
.long 0xffffffff,0xffffffff,0xffffffff,0xffffffff,0xffffffff,0xffffffff,0xffffffff,0xffffffff
.long 0xffffffff,0xffffffff,0xffffffff,0xffffffff,0xffffffff,0xffffffff,0xffffffff,0xffffffff
.long 0xffffffff,0xffffffff,0xffffffff,0xffffffff,0xffffffff,0xffffffff,0xffffffff,0xffffffff
.long 0x1000000,0x3000200,0x2000140,0x38002c0,0x3000280,0x4000380,0x40003c0,0x4800440
.long 0xffffffff,0xffffffff,0xffffffff,0xffffffff,0xffffffff,0xffffffff,0xffffffff,0xffffffff
.long 0xffffffff,0xffffffff,0xffffffff,0xffffffff,0xffffffff,0xffffffff,0xffffffff,0xffffffff
.long 0xffffffff,0xffffffff,0xffffffff,0xffffffff,0xffffffff,0xffffffff,0xffffffff,0xffffffff
.long 0x400,0xffffffff,0x440,0xffffffff,0x480,0xffffffff,0x4c0,0xffffffff
.long 0xffffffff,0xffffffff,0xffffffff,0xffffffff,0xffffffff,0xffffffff,0xffffffff,0xffffffff
.long 0xffffffff,0xffffffff,0xffffffff,0xffffffff,0xffffffff,0xffffffff,0xffffffff,0xffffffff
.long 0x0,0x0,0x4fc0000,0x4f404f8,0x4f80000,0x4e804f0,0x4f40000,0x4dc04e8
.long 0x4f00000,0x4d004e0,0x4ec0000,0x4c404d8,0x4e80000,0x4b804d0,0x4e40000,0x4ac04c8
.long 0x4e00000,0x4a004c0,0x4dc0000,0x49404b8,0x4d80000,0x48804b0,0x4d40000,0x47c04a8
.long 0x4d00000,0x47004a0,0x4cc0000,0x4640498,0x4c80000,0x4580490,0x4c40000,0x44c0488
.long 0x0,0x0,0x4ec04f0,0x4e404e8,0x4d804e0,0x4c804d0,0x4c404d0,0x4ac04b8
.long 0x4b004c0,0x49004a0,0x49c04b0,0x4740488,0x48804a0,0x4580470,0x4740490,0x43c0458
.long 0x4600480,0x4200440,0x44c0470,0x4040428,0x4380460,0x3e80410,0x4240450,0x3cc03f8
.long 0x4100440,0x3b003e0,0x3fc0430,0x39403c8,0x3e80420,0x37803b0,0x3d40410,0x35c0398
.long 0x0,0x0,0x4dc04e0,0x4d404d8,0x4b804c0,0x4a804b0,0x49404a0,0x47c0488
.long 0x4700480,0x4500460,0x44c0460,0x4240438,0x4280440,0x3f80410,0x4040420,0x3cc03e8
.long 0x3e00400,0x3a003c0,0x3bc03e0,0x3740398,0x39803c0,0x3480370,0x37403a0,0x31c0348
.long 0x3500380,0x2f00320,0x32c0360,0x2c402f8,0x3080340,0x29802d0,0x2e40320,0x26c02a8
.long 0x0,0xffffffff,0x4cc04d0,0xffffffff,0x49804a0,0xffffffff,0x4640470,0xffffffff
.long 0x4300440,0xffffffff,0x3fc0410,0xffffffff,0x3c803e0,0xffffffff,0x39403b0,0xffffffff
.long 0x3600380,0xffffffff,0x32c0350,0xffffffff,0x2f80320,0xffffffff,0x2c402f0,0xffffffff
.long 0x29002c0,0xffffffff,0x25c0290,0xffffffff,0x2280260,0xffffffff,0x1f40230,0xffffffff
.long 0x0,0x0,0x4c404c8,0x4bc04c0,0x4880490,0x4780480,0x44c0458,0x4340440
.long 0x4100420,0x3f00400,0x3d403e8,0x3ac03c0,0x39803b0,0x3680380,0x35c0378,0x3240340
.long 0x3200340,0x2e00300,0x2e40308,0x29c02c0,0x2a802d0,0x2580280,0x26c0298,0x2140240
.long 0x2300260,0x1d00200,0x1f40228,0x18c01c0,0x1b801f0,0x1480180,0x17c01b8,0x1040140
.long 0x0,0x0,0x4b404b8,0x4c804b0,0x4680470,0x4900460,0x41c0428,0x4580410
.long 0x3d003e0,0x42003c0,0x3840398,0x3e80370,0x3380350,0x3b00320,0x2ec0308,0x37802d0
.long 0x2a002c0,0x3400280,0x2540278,0x3080230,0x2080230,0x2d001e0,0x1bc01e8,0x2980190
.long 0x17001a0,0x2600140,0x1240158,0x22800f0,0xd80110,0x1f000a0,0x8c00c8,0x1b80050
.long 0x0,0x0,0x4c004c4,0x4b804bc,0x4800488,0x4700478,0x440044c,0x4280434
.long 0x4000410,0x3e003f0,0x3c003d4,0x39803ac,0x3800398,0x3500368,0x340035c,0x3080324
.long 0x3000320,0x2c002e0,0x2c002e4,0x278029c,0x28002a8,0x2300258,0x240026c,0x1e80214
.long 0x2000230,0x1a001d0,0x1c001f4,0x158018c,0x18001b8,0x1100148,0x140017c,0xc80104
.long 0x0,0xffffffff,0x4b004b4,0xffffffff,0x4600468,0xffffffff,0x410041c,0xffffffff
.long 0x3c003d0,0xffffffff,0x3700384,0xffffffff,0x3200338,0xffffffff,0x2d002ec,0xffffffff
.long 0x28002a0,0xffffffff,0x2300254,0xffffffff,0x1e00208,0xffffffff,0x19001bc,0xffffffff
.long 0x1400170,0xffffffff,0xf00124,0xffffffff,0xa000d8,0xffffffff,0x50008c,0xffffffff
.long 0x0,0x0,0x0,0x3f803f80,0x0,0x0,0x0,0x3f800000
.long 0x0,0x0,0x0,0x0,0x0,0x0,0x0,0x0
.long 0x0,0x0,0x0,0x0,0x0,0x0,0x0,0x0
.long 0x0,0x0,0x0,0x0,0x0,0x0,0x0,0x0
.long 0x0,0x0,0x0,0x0,0x0,0x0,0x0,0x0
.long 0x0,0x0,0x0,0x0,0x0,0x0,0x0,0x0
.long 0x0,0x0,0x0,0x0,0x0,0x0,0x0,0x0
.long 0x0,0x0,0x0,0x0,0x0,0x0,0x0,0x0
.long 0x3f803f80,0x3f80,0x0,0x0,0x3f803f80,0x3f803f80,0x0,0x0
.long 0x3f803f80,0x3f803f80,0x3f80,0x0,0x3f800000,0x3f803f80,0x3f803f80,0x0
.long 0x0,0x3f803f80,0x3f803f80,0x3f80,0x0,0x3f800000,0x3f803f80,0x3f803f80
.long 0x0,0x0,0x3f803f80,0x3f803f80,0x0,0x0,0x3f800000,0x3f803f80
.long 0x0,0x0,0x0,0x3f803f80,0x0,0x0,0x0,0x3f800000
.long 0x0,0x0,0x0,0x0,0x0,0x0,0x0,0x0
.long 0x0,0x0,0x0,0x0,0x0,0x0,0x0,0x0
.long 0x0,0x0,0x0,0x0,0x0,0x0,0x0,0x0
.long 0x0,0x0,0x0,0x0,0x0,0x0,0x0,0x0
.long 0x0,0x0,0x0,0x0,0x0,0x0,0x0,0x0
.long 0x0,0x0,0x0,0x0,0x0,0x0,0x0,0x0
.long 0x3f80,0x0,0x0,0x0,0x3f803f80,0x0,0x0,0x0
.long 0x3f803f80,0x3f80,0x0,0x0,0x3f803f80,0x3f803f80,0x0,0x0
.long 0x3f803f80,0x3f803f80,0x3f80,0x0,0x3f800000,0x3f803f80,0x3f803f80,0x0
.long 0x0,0x3f803f80,0x3f803f80,0x3f80,0x0,0x3f800000,0x3f803f80,0x3f803f80
.long 0x0,0x0,0x3f803f80,0x3f803f80,0x0,0x0,0x3f800000,0x3f803f80
.long 0x0,0x0,0x0,0x0,0x0,0x0,0x0,0x0
.long 0x0,0x0,0x0,0x0,0x0,0x0,0x0,0x0
.long 0x0,0x0,0x0,0x0,0x0,0x0,0x0,0x0
.long 0x0,0x0,0x0,0x0,0x0,0x0,0x0,0x0
.long 0x0,0x0,0x0,0x0,0x0,0x0,0x0,0x0
.long 0x0,0x0,0x0,0x0,0x0,0x0,0x0,0x0
.long 0x0,0x0,0x0,0x0,0x0,0x0,0x0,0x0
.long 0x3f80,0x0,0x0,0x0,0x3f803f80,0x0,0x0,0x0
.long 0x0,0x0,0x0,0x0,0x0,0x0,0x0,0x0
.long 0x0,0x0,0x0,0x0,0x0,0x0,0x0,0x0
.long 0x0,0x0,0x0,0x0,0x0,0x0,0x0,0x0
.long 0x0,0x0,0x0,0x0,0x0,0x0,0x0,0x0
.long 0x0,0x0,0x0,0x0,0x0,0x0,0x0,0x0
.long 0x0,0x0,0x0,0x0,0x0,0x0,0x0,0x0
.long 0x0,0x0,0x0,0x0,0x0,0x0,0x0,0x0
.long 0x0,0x0,0x0,0x0,0x0,0x0,0x0,0x0
.long 0x0,0x3f800000,0x3f803f80,0x0,0x0,0x0,0x3f803f80,0x3f80
.long 0x0,0x0,0x3f800000,0x3f803f80,0x0,0x0,0x0,0x3f803f80
.long 0x0,0x0,0x0,0x3f800000,0x0,0x0,0x0,0x0
.long 0x0,0x0,0x0,0x0,0x0,0x0,0x0,0x0
.long 0x0,0x0,0x0,0x0,0x0,0x0,0x0,0x0
.long 0x0,0x0,0x0,0x0,0x0,0x0,0x0,0x0
.long 0x0,0x0,0x0,0x0,0x0,0x0,0x0,0x0
.long 0x0,0x0,0x0,0x0,0x0,0x0,0x0,0x0
.long 0x0,0x0,0x0,0x0,0x0,0x0,0x0,0x0
.long 0x0,0x0,0x0,0x0,0x3f80,0x0,0x0,0x0
.long 0x3f803f80,0x0,0x0,0x0,0x3f803f80,0x3f80,0x0,0x0
.long 0x3f800000,0x3f803f80,0x0,0x0,0x0,0x3f803f80,0x3f80,0x0
.long 0x0,0x3f800000,0x3f803f80,0x0,0x0,0x0,0x3f803f80,0x3f80
.long 0x0,0x0,0x3f800000,0x3f803f80,0x0,0x0,0x0,0x3f803f80
.long 0x0,0x0,0x0,0x3f800000,0x0,0x0,0x0,0x0
.long 0x0,0x0,0x0,0x0,0x0,0x0,0x0,0x0
.long 0x0,0x0,0x0,0x0,0x0,0x0,0x0,0x0
.long 0x0,0x0,0x0,0x0,0x0,0x0,0x0,0x0
.long 0x0,0x0,0x0,0x0,0x0,0x0,0x0,0x0
.long 0x0,0x0,0x0,0x0,0x0,0x0,0x0,0x0
.long 0x0,0x0,0x0,0x0,0x0,0x0,0x0,0x0
.long 0x0,0x0,0x0,0x0,0x3f80,0x0,0x0,0x0
.long 0x3f803f80,0x0,0x0,0x0,0x3f803f80,0x3f80,0x0,0x0
.long 0x3f800000,0x3f803f80,0x0,0x0,0x0,0x3f803f80,0x3f80,0x0
.long 0x0,0x0,0x3f803f80,0x3f803f80,0x0,0x0,0x3f800000,0x3f803f80
.long 0x0,0x0,0x0,0x3f803f80,0x0,0x0,0x0,0x3f800000
.long 0x0,0x0,0x0,0x0,0x0,0x0,0x0,0x0
.long 0x0,0x0,0x0,0x0,0x0,0x0,0x0,0x0
.long 0x0,0x0,0x0,0x0,0x0,0x0,0x0,0x0
.long 0x0,0x0,0x0,0x0,0x0,0x0,0x0,0x0
.long 0x0,0x0,0x0,0x0,0x0,0x0,0x0,0x0
.long 0x0,0x0,0x0,0x0,0x0,0x0,0x0,0x0
.long 0x3f803f80,0x3f803f80,0x3f80,0x0,0x3f803f80,0x3f803f80,0x3f803f80,0x0
.long 0x3f803f80,0x3f803f80,0x3f803f80,0x3f80,0x3f803f80,0x3f803f80,0x3f803f80,0x3f803f80
.long 0x3f803f80,0x3f803f80,0x3f803f80,0x3f803f80,0x3f800000,0x3f803f80,0x3f803f80,0x3f803f80
.long 0x0,0x3f803f80,0x3f803f80,0x3f803f80,0x0,0x3f800000,0x3f803f80,0x3f803f80
.long 0x0,0x0,0x3f803f80,0x3f803f80,0x0,0x0,0x3f800000,0x3f803f80
.long 0x0,0x0,0x0,0x3f803f80,0x0,0x0,0x0,0x3f800000
.long 0x0,0x0,0x0,0x0,0x0,0x0,0x0,0x0
.long 0x0,0x0,0x0,0x0,0x0,0x0,0x0,0x0
.long 0x0,0x0,0x0,0x0,0x0,0x0,0x0,0x0
.long 0x0,0x0,0x0,0x0,0x0,0x0,0x0,0x0
.long 0x3f80,0x0,0x0,0x0,0x3f803f80,0x0,0x0,0x0
.long 0x3f803f80,0x3f80,0x0,0x0,0x3f803f80,0x3f803f80,0x0,0x0
.long 0x3f803f80,0x3f803f80,0x3f80,0x0,0x3f803f80,0x3f803f80,0x3f803f80,0x0
.long 0x3f803f80,0x3f803f80,0x3f803f80,0x3f80,0x3f803f80,0x3f803f80,0x3f803f80,0x3f803f80
.long 0x3f803f80,0x3f803f80,0x3f803f80,0x3f803f80,0x3f800000,0x3f803f80,0x3f803f80,0x3f803f80
.long 0x0,0x3f803f80,0x3f803f80,0x3f803f80,0x0,0x3f800000,0x3f803f80,0x3f803f80
.long 0x0,0x0,0x0,0x0,0x0,0x0,0x0,0x0
.long 0x0,0x0,0x0,0x0,0x0,0x0,0x0,0x0
.long 0x0,0x0,0x0,0x0,0x0,0x0,0x0,0x0
.long 0x0,0x0,0x0,0x0,0x0,0x0,0x0,0x0
.long 0x0,0x0,0x0,0x0,0x0,0x0,0x0,0x0
.long 0x0,0x0,0x0,0x0,0x0,0x0,0x0,0x0
.long 0x3f80,0x0,0x0,0x0,0x3f803f80,0x0,0x0,0x0
.long 0x3f803f80,0x3f80,0x0,0x0,0x3f803f80,0x3f803f80,0x0,0x0
.long 0x0,0x0,0x3f800000,0x3f803f80,0x0,0x0,0x0,0x3f803f80
.long 0x0,0x0,0x0,0x3f800000,0x0,0x0,0x0,0x0
.long 0x0,0x0,0x0,0x0,0x0,0x0,0x0,0x0
.long 0x0,0x0,0x0,0x0,0x0,0x0,0x0,0x0
.long 0x0,0x0,0x0,0x0,0x0,0x0,0x0,0x0
.long 0x0,0x0,0x0,0x0,0x0,0x0,0x0,0x0
.long 0x0,0x0,0x0,0x0,0x0,0x0,0x0,0x0
.long 0x0,0x0,0x0,0x0,0x0,0x0,0x0,0x0
.long 0x3f803f80,0x3f803f80,0x0,0x0,0x3f803f80,0x3f803f80,0x3f80,0x0
.long 0x3f803f80,0x3f803f80,0x3f803f80,0x0,0x3f803f80,0x3f803f80,0x3f803f80,0x3f80
.long 0x3f800000,0x3f803f80,0x3f803f80,0x3f803f80,0x0,0x3f803f80,0x3f803f80,0x3f803f80
.long 0x0,0x3f800000,0x3f803f80,0x3f803f80,0x0,0x0,0x3f803f80,0x3f803f80
.long 0x0,0x0,0x3f800000,0x3f803f80,0x0,0x0,0x0,0x3f803f80
.long 0x0,0x0,0x0,0x3f800000,0x0,0x0,0x0,0x0
.long 0x0,0x0,0x0,0x0,0x0,0x0,0x0,0x0
.long 0x0,0x0,0x0,0x0,0x0,0x0,0x0,0x0
.long 0x0,0x0,0x0,0x0,0x0,0x0,0x0,0x0
.long 0x0,0x0,0x0,0x0,0x0,0x0,0x0,0x0
.long 0x0,0x0,0x0,0x0,0x3f80,0x0,0x0,0x0
.long 0x3f803f80,0x0,0x0,0x0,0x3f803f80,0x3f80,0x0,0x0
.long 0x3f803f80,0x3f803f80,0x0,0x0,0x3f803f80,0x3f803f80,0x3f80,0x0
.long 0x3f803f80,0x3f803f80,0x3f803f80,0x0,0x3f803f80,0x3f803f80,0x3f803f80,0x3f80
.long 0x3f800000,0x3f803f80,0x3f803f80,0x3f803f80,0x0,0x3f803f80,0x3f803f80,0x3f803f80
.long 0x0,0x3f800000,0x3f803f80,0x3f803f80,0x0,0x0,0x3f803f80,0x3f803f80
.long 0x0,0x0,0x0,0x0,0x0,0x0,0x0,0x0
.long 0x0,0x0,0x0,0x0,0x0,0x0,0x0,0x0
.long 0x0,0x0,0x0,0x0,0x0,0x0,0x0,0x0
.long 0x0,0x0,0x0,0x0,0x0,0x0,0x0,0x0
.long 0x0,0x0,0x0,0x0,0x0,0x0,0x0,0x0
.long 0x0,0x0,0x0,0x0,0x0,0x0,0x0,0x0
.long 0x0,0x0,0x0,0x0,0x3f80,0x0,0x0,0x0
.long 0x3f803f80,0x0,0x0,0x0,0x3f803f80,0x3f80,0x0,0x0
.long 0x0,0x0,0x0,0x0,0x0,0x0,0x0,0x0
.long 0x0,0x0,0x0,0x0,0x0,0x0,0x0,0x0
.long 0x0,0x0,0x0,0x0,0x0,0x0,0x0,0x0
.long 0x0,0x0,0x0,0x0,0x0,0x0,0x0,0x0
.long 0x0,0x0,0x0,0x0,0x0,0x0,0x0,0x0
.long 0x0,0x0,0x0,0x0,0x0,0x0,0x0,0x0
.long 0x0,0x0,0x0,0x0,0x0,0x0,0x0,0x0
.long 0x0,0x0,0x0,0x0,0x0,0x0,0x0,0x0
.long 0x0,0x0,0xffffffff,0x0,0x0,0x0,0xffff0000,0xffff
.long 0x0,0x0,0x0,0xffffffff,0x0,0x0,0x0,0xffff0000
.long 0x0,0x0,0x0,0x0,0x0,0x0,0x0,0x0
.long 0x0,0x0,0x0,0x0,0x0,0x0,0x0,0x0
.long 0x0,0x0,0x0,0x0,0x0,0x0,0x0,0x0
.long 0x0,0x0,0x0,0x0,0x0,0x0,0x0,0x0
.long 0x0,0x0,0x0,0x0,0x0,0x0,0x0,0x0
.long 0x0,0x0,0x0,0x0,0x0,0x0,0x0,0x0
.long 0x0,0x0,0x0,0x0,0x0,0x0,0x0,0x0
.long 0x0,0x0,0x0,0x0,0xffff,0x0,0x0,0x0
.long 0xffffffff,0x0,0x0,0x0,0xffff0000,0xffff,0x0,0x0
.long 0x0,0xffffffff,0x0,0x0,0x0,0xffff0000,0xffff,0x0
.long 0x0,0x0,0xffffffff,0x0,0x0,0x0,0xffff0000,0xffff
.long 0x0,0x0,0x0,0xffffffff,0x0,0x0,0x0,0xffff0000
.long 0x0,0x0,0x0,0x0,0x0,0x0,0x0,0x0
.long 0x0,0x0,0x0,0x0,0x0,0x0,0x0,0x0
.long 0x0,0x0,0x0,0x0,0x0,0x0,0x0,0x0
.long 0x0,0x0,0x0,0x0,0x0,0x0,0x0,0x0
.long 0x0,0x0,0x0,0x0,0x0,0x0,0x0,0x0
.long 0x0,0x0,0x0,0x0,0x0,0x0,0x0,0x0
.long 0x0,0x0,0x0,0x0,0x0,0x0,0x0,0x0
.long 0x0,0x0,0x0,0x0,0xffff,0x0,0x0,0x0
.long 0xffffffff,0x0,0x0,0x0,0xffff0000,0xffff,0x0,0x0
.long 0x0,0xffffffff,0x0,0x0,0x0,0xffff0000,0xffff,0x0
L_tend:
.section .rodata,"a"
.p2align 6
.amdhsa_kernel concat_heads__spectral_gfnet__ssm_conv_s4__prompt_kernel
  .amdhsa_next_free_vgpr 168
  .amdhsa_next_free_sgpr 102
  .amdhsa_accum_offset 168
  .amdhsa_group_segment_fixed_size 0
  .amdhsa_kernarg_size 120
  .amdhsa_user_sgpr_count 2
  .amdhsa_user_sgpr_kernarg_segment_ptr 1
  .amdhsa_system_sgpr_workgroup_id_x 1
.end_amdhsa_kernel
```
